```python
import torch

def _softmax(x, axis=-1):
    return torch.softmax(x, dim=axis)
def _gelu(x):
    return torch.nn.functional.gelu(x, approximate="tanh")
def _silu(x):
    return torch.nn.functional.silu(x)
def _sigmoid(x):
    return torch.sigmoid(x)
def _layernorm(x, axis=-1, eps=1e-5):
    m = x.mean(dim=axis, keepdim=True)
    v = x.var(dim=axis, keepdim=True, unbiased=False)
    return (x - m) / torch.sqrt(v + eps)
def _scatter_add(tgt, idx, src, axis=0):
    return tgt.clone().index_add_(axis, idx, src)
def _segment_sum(src, seg, n):
    out = torch.zeros((n,) + src.shape[1:], dtype=src.dtype)
    return out.index_add_(0, seg, src)
def _pad(x, pw):
    flat = tuple(v for pair in reversed(pw) for v in pair)
    return torch.nn.functional.pad(x, flat)

kernel_name = 'concat_heads__mha_block__spectral_fnet__prompt'

def setup_inputs():

    _w = (lambda a: (lambda t: t.to(torch.bfloat16) if t.is_floating_point() else t)(torch.as_tensor(a)))
    def _A_setup():
        B, S, D, H = 1, 2048, 1024, 32
        return {
            "x": _w((lambda *s: torch.randn(*s, dtype=torch.bfloat16) * 0.2)(B, S, D)),
            "wqkv": _w((lambda *s: torch.randn(*s, dtype=torch.bfloat16) * 0.8)(D, 3 * D)),
            "wo": _w((lambda *s: torch.randn(*s, dtype=torch.bfloat16) * 0.2)(D, D)),
        }
    _A_in = _A_setup()

    def _B_setup():
        B, S, D = 1, 2048, 1024
        ns = torch.arange(S)[:, None] * torch.arange(S)[None, :]
        nd = torch.arange(D)[:, None] * torch.arange(D)[None, :]
        Ws_re = torch.cos(-2.0 * torch.pi * ns / S).to(float)
        Ws_im = torch.sin(-2.0 * torch.pi * ns / S).to(float)
        Wd_re = torch.cos(-2.0 * torch.pi * nd / D).to(float)
        Wd_im = torch.sin(-2.0 * torch.pi * nd / D).to(float)
        return {
            "x": _w((lambda *s: torch.randn(*s, dtype=torch.bfloat16) * 0.05)(B, S, D)),
            "dft_seq_re": _w(Ws_re),
            "dft_seq_im": _w(Ws_im),
            "dft_hid_re": _w(Wd_re),
            "dft_hid_im": _w(Wd_im),
        }
    _B_in = _B_setup()

    return {
        "A_x": _A_in["x"],
        "A_wqkv": _A_in["wqkv"],
        "A_wo": _A_in["wo"],
        "B_x": _B_in["x"],
        "B_dft_seq_re": _B_in["dft_seq_re"],
        "B_dft_seq_im": _B_in["dft_seq_im"],
        "B_dft_hid_re": _B_in["dft_hid_re"],
        "B_dft_hid_im": _B_in["dft_hid_im"],
    }

def reference(A_x, A_wqkv, A_wo, B_x, B_dft_seq_re, B_dft_seq_im, B_dft_hid_re, B_dft_hid_im):
    def _A_ref(x, wqkv, wo):
        B, S, D = x.shape
        H = 32
        Dh = D // H
        qkv = (lambda x, *d: x.permute(*d))((x @ wqkv).reshape(B, S, 3, H, Dh), 2, 0, 3, 1, 4)
        q, k, v = qkv[0], qkv[1], qkv[2]
        scores = torch.einsum("bhqd,bhkd->bhqk", q, k) * (Dh ** -0.5)
        p = _softmax(scores, axis=-1)
        o = torch.einsum("bhqk,bhkd->bhqd", p, v)
        return (lambda x, *d: x.permute(*d))(o, 0, 2, 1, 3).reshape(B, S, D) @ wo

    def _B_ref(x, dft_seq_re, dft_seq_im, dft_hid_re, dft_hid_im):
        a = torch.einsum("bsd,ed->bse", x, dft_hid_re)
        b = torch.einsum("bsd,ed->bse", x, dft_hid_im)
        y = torch.einsum("ts,bse->bte", dft_seq_re, a) - torch.einsum("ts,bse->bte", dft_seq_im, b)
        return y

    a = _A_ref(A_x, A_wqkv, A_wo)
    b = _B_ref(B_x, B_dft_seq_re, B_dft_seq_im, B_dft_hid_re, B_dft_hid_im)
    return torch.concatenate([a, b], axis=-1)
```

```asm
; @launch grid=(256,1,1) block=(512,1,1) lds=163840
.amdgcn_target "amdgcn-amd-amdhsa--gfx950"
.text
.globl concat_heads__mha_block__spectral_fnet__prompt_kernel
.p2align 8
.type concat_heads__mha_block__spectral_fnet__prompt_kernel,@function
concat_heads__mha_block__spectral_fnet__prompt_kernel:
  s_cmp_ge_u32 s2, 256
  s_cbranch_scc1 concat_heads__mha_block__spectral_fnet__prompt_kernel_done
  s_load_dwordx4 s[4:7], s[0:1], 0
  s_load_dwordx2 s[8:9], s[0:1], 80
  s_load_dwordx2 s[38:39], s[0:1], 24
  s_load_dwordx2 s[48:49], s[0:1], 16
  s_load_dwordx2 s[36:37], s[0:1], 64
  s_load_dwordx4 s[40:43], s[0:1], 32
  s_and_b32 s20, s2, 7
  s_lshr_b32 s21, s2, 3
  s_and_b32 s22, s20, 1
  s_lshl_b32 s22, s22, 3
  s_and_b32 s23, s21, 7
  s_add_u32 s22, s22, s23
  s_lshr_b32 s23, s20, 1
  s_lshl_b32 s23, s23, 2
  s_lshr_b32 s24, s21, 3
  s_add_u32 s23, s23, s24
  s_lshr_b32 s81, s2, 5
  s_lshl_b32 s81, s81, 3
  s_add_u32 s80, s20, s81
  s_bfe_u32 s81, s2, 0x20003
  v_lshrrev_b32 v1, 6, v0
  v_and_b32 v0, 63, v0
  v_readfirstlane_b32 s25, v1
  s_cmp_ge_u32 s25, 4
  s_cbranch_scc1 concat_heads__mha_block__spectral_fnet__prompt_kernel_ld_setup
  s_branch concat_heads__mha_block__spectral_fnet__prompt_kernel_consumer
concat_heads__mha_block__spectral_fnet__prompt_kernel_ld_setup:
  s_sub_u32 s26, s25, 4
  v_lshrrev_b32 v10, 3, v0
  s_lshl_b32 s28, s22, 7
  s_lshl_b32 s29, s26, 5
  s_add_u32 s28, s28, s29
  v_add_u32 v10, s28, v10
  v_lshlrev_b32 v10, 11, v10
  v_and_b32 v11, 7, v0
  v_lshrrev_b32 v12, 4, v0
  v_xor_b32 v13, v11, v12
  v_xor_b32 v14, 4, v13
  v_lshlrev_b32 v13, 4, v13
  v_lshlrev_b32 v14, 4, v14
  v_add_u32 v152, v10, v13
  v_add_u32 v153, v10, v14
  v_add_u32 v153, 16384, v153
  v_add_u32 v154, v10, v13
  v_add_u32 v154, 32768, v154
  v_add_u32 v155, v10, v14
  v_add_u32 v155, 49152, v155
  v_lshrrev_b32 v10, 3, v0
  v_mul_u32_u24 v10, 6144, v10
  v_bfe_u32 v12, v0, 4, 1
  v_lshlrev_b32 v12, 2, v12
  v_xor_b32 v12, v11, v12
  v_lshlrev_b32 v12, 4, v12
  v_add_u32 v10, v10, v12
  s_lshl_b32 s28, s23, 7
  v_add_u32 v10, s28, v10
  s_mul_i32 s28, s26, 6
  s_add_u32 s28, s28, 0
  s_lshr_b32 s29, s28, 3
  s_and_b32 s30, s28, 7
  s_lshl_b32 s29, s29, 11
  s_mul_i32 s30, s30, 49152
  s_add_u32 s29, s29, s30
  v_add_u32 v156, s29, v10
  s_mul_i32 s28, s26, 6
  s_add_u32 s28, s28, 1
  s_lshr_b32 s29, s28, 3
  s_and_b32 s30, s28, 7
  s_lshl_b32 s29, s29, 11
  s_mul_i32 s30, s30, 49152
  s_add_u32 s29, s29, s30
  v_add_u32 v157, s29, v10
  s_mul_i32 s28, s26, 6
  s_add_u32 s28, s28, 2
  s_lshr_b32 s29, s28, 3
  s_and_b32 s30, s28, 7
  s_lshl_b32 s29, s29, 11
  s_mul_i32 s30, s30, 49152
  s_add_u32 s29, s29, s30
  v_add_u32 v158, s29, v10
  s_mul_i32 s28, s26, 6
  s_add_u32 s28, s28, 3
  s_lshr_b32 s29, s28, 3
  s_and_b32 s30, s28, 7
  s_lshl_b32 s29, s29, 11
  s_mul_i32 s30, s30, 49152
  s_add_u32 s29, s29, s30
  v_add_u32 v159, s29, v10
  s_mul_i32 s28, s26, 6
  s_add_u32 s28, s28, 4
  s_lshr_b32 s29, s28, 3
  s_and_b32 s30, s28, 7
  s_lshl_b32 s29, s29, 11
  s_mul_i32 s30, s30, 49152
  s_add_u32 s29, s29, s30
  v_add_u32 v8, s29, v10
  s_mul_i32 s28, s26, 6
  s_add_u32 s28, s28, 5
  s_lshr_b32 s29, s28, 3
  s_and_b32 s30, s28, 7
  s_lshl_b32 s29, s29, 11
  s_mul_i32 s30, s30, 49152
  s_add_u32 s29, s29, s30
  v_add_u32 v9, s29, v10
  s_lshl_b32 s32, s26, 12
  s_mul_i32 s33, s26, 6144
  s_add_u32 s33, s33, 16384
  s_waitcnt lgkmcnt(0)
  s_mov_b32 s12, s4
  s_mov_b32 s13, s5
  s_mov_b32 s14, 0x400000
  s_mov_b32 s15, 0x00020000
  s_mov_b32 s16, s6
  s_mov_b32 s17, s7
  s_mov_b32 s18, 0x600000
  s_mov_b32 s19, 0x00020000
  s_and_b32 s46, s22, 7
  s_lshl_b32 s46, s46, 1
  s_add_u32 s47, s46, 0
  s_and_b32 s47, s47, 15
  s_lshl_b32 s34, s47, 7
  s_mul_i32 s35, s47, 393216
  s_add_u32 m0, s32, 0
  s_nop 0
  buffer_load_dwordx4 v152, s[12:15], s34 offen  lds
  s_add_u32 m0, s32, 1024
  s_nop 0
  buffer_load_dwordx4 v153, s[12:15], s34 offen  lds
  s_add_u32 m0, s32, 2048
  s_nop 0
  buffer_load_dwordx4 v154, s[12:15], s34 offen  lds
  s_add_u32 m0, s32, 3072
  s_nop 0
  buffer_load_dwordx4 v155, s[12:15], s34 offen  lds
  s_add_u32 m0, s33, 0
  s_nop 0
  buffer_load_dwordx4 v156, s[16:19], s35 offen  lds
  s_add_u32 m0, s33, 1024
  s_nop 0
  buffer_load_dwordx4 v157, s[16:19], s35 offen  lds
  s_add_u32 m0, s33, 2048
  s_nop 0
  buffer_load_dwordx4 v158, s[16:19], s35 offen  lds
  s_add_u32 m0, s33, 3072
  s_nop 0
  buffer_load_dwordx4 v159, s[16:19], s35 offen  lds
  s_add_u32 m0, s33, 4096
  s_nop 0
  buffer_load_dwordx4 v8, s[16:19], s35 offen  lds
  s_add_u32 m0, s33, 5120
  s_nop 0
  buffer_load_dwordx4 v9, s[16:19], s35 offen  lds
  s_add_u32 s47, s46, 1
  s_and_b32 s47, s47, 15
  s_lshl_b32 s34, s47, 7
  s_mul_i32 s35, s47, 393216
  s_add_u32 m0, s32, 40960
  s_nop 0
  buffer_load_dwordx4 v152, s[12:15], s34 offen  lds
  s_add_u32 m0, s32, 41984
  s_nop 0
  buffer_load_dwordx4 v153, s[12:15], s34 offen  lds
  s_add_u32 m0, s32, 43008
  s_nop 0
  buffer_load_dwordx4 v154, s[12:15], s34 offen  lds
  s_add_u32 m0, s32, 44032
  s_nop 0
  buffer_load_dwordx4 v155, s[12:15], s34 offen  lds
  s_add_u32 m0, s33, 40960
  s_nop 0
  buffer_load_dwordx4 v156, s[16:19], s35 offen  lds
  s_add_u32 m0, s33, 41984
  s_nop 0
  buffer_load_dwordx4 v157, s[16:19], s35 offen  lds
  s_add_u32 m0, s33, 43008
  s_nop 0
  buffer_load_dwordx4 v158, s[16:19], s35 offen  lds
  s_add_u32 m0, s33, 44032
  s_nop 0
  buffer_load_dwordx4 v159, s[16:19], s35 offen  lds
  s_add_u32 m0, s33, 45056
  s_nop 0
  buffer_load_dwordx4 v8, s[16:19], s35 offen  lds
  s_add_u32 m0, s33, 46080
  s_nop 0
  buffer_load_dwordx4 v9, s[16:19], s35 offen  lds
  s_add_u32 s92, s8, 0x1800000
  s_addc_u32 s93, s9, 0
  s_mov_b32 s94, 0x4000
  s_mov_b32 s95, 0x00020000
  s_load_dword s89, s[92:93], 0
  s_mov_b32 s72, s38
  s_mov_b32 s73, s39
  s_mov_b32 s74, 0x400000
  s_mov_b32 s75, 0x00020000
  s_add_u32 s76, s8, 0x1000000
  s_addc_u32 s77, s9, 0
  s_mov_b32 s78, 0x800000
  s_mov_b32 s79, 0x00020000
  v_lshrrev_b32 v10, 4, v0
  v_lshlrev_b32 v11, 17, v10
  s_lshl_b32 s82, s80, 11
  s_lshl_b32 s83, s26, 8
  s_add_u32 s82, s82, s83
  v_add_u32 v11, s82, v11
  v_and_b32 v12, 15, v0
  v_lshlrev_b32 v10, 1, v10
  v_xor_b32 v12, v12, v10
  v_xor_b32 v13, 8, v12
  v_lshlrev_b32 v12, 4, v12
  v_lshlrev_b32 v13, 4, v13
  v_add_u32 v84, v11, v12
  v_add_u32 v85, v11, v13
  s_lshl_b32 s84, s26, 13
  v_bfe_u32 v10, v0, 1, 3
  s_lshl_b32 s87, s81, 3
  v_add_u32 v10, s87, v10
  v_cvt_f32_u32 v10, v10
  v_mul_f32 v10, 0xbd000000, v10
  v_lshrrev_b32 v11, 4, v0
  v_lshlrev_b32 v11, 2, v11
  v_cvt_f32_u32 v11, v11
  v_and_b32 v12, 1, v0
  v_cvt_f32_u32 v12, v12
  v_mul_f32 v12, 0xbe800000, v12
  v_add_f32 v48, 0x0, v11
  v_add_f32 v49, 0x3f800000, v11
  v_add_f32 v50, 0x40000000, v11
  v_add_f32 v51, 0x40400000, v11
  v_add_f32 v52, 0x41800000, v11
  v_add_f32 v53, 0x41880000, v11
  v_add_f32 v54, 0x41900000, v11
  v_add_f32 v55, 0x41980000, v11
  v_mul_f32 v48, v48, v10
  v_mul_f32 v49, v49, v10
  v_mul_f32 v50, v50, v10
  v_mul_f32 v51, v51, v10
  v_mul_f32 v52, v52, v10
  v_mul_f32 v53, v53, v10
  v_mul_f32 v54, v54, v10
  v_mul_f32 v55, v55, v10
  v_fract_f32 v48, v48
  v_fract_f32 v49, v49
  v_fract_f32 v50, v50
  v_fract_f32 v51, v51
  v_fract_f32 v52, v52
  v_fract_f32 v53, v53
  v_fract_f32 v54, v54
  v_fract_f32 v55, v55
  v_add_f32 v48, v48, v12
  v_add_f32 v49, v49, v12
  v_add_f32 v50, v50, v12
  v_add_f32 v51, v51, v12
  v_add_f32 v52, v52, v12
  v_add_f32 v53, v53, v12
  v_add_f32 v54, v54, v12
  v_add_f32 v55, v55, v12
  v_cos_f32 v48, v48
  v_cos_f32 v49, v49
  v_cos_f32 v50, v50
  v_cos_f32 v51, v51
  v_cos_f32 v52, v52
  v_cos_f32 v53, v53
  v_cos_f32 v54, v54
  v_cos_f32 v55, v55
  s_nop 0
  v_cvt_pk_bf16_f32 v80, v48, v49
  v_cvt_pk_bf16_f32 v81, v50, v51
  v_cvt_pk_bf16_f32 v82, v52, v53
  v_cvt_pk_bf16_f32 v83, v54, v55
  s_waitcnt vmcnt(10) lgkmcnt(0)
  s_mul_i32 s89, s89, 0x9E3779B1
  s_add_u32 s89, s89, 0x7F4A7C15
  s_barrier
  s_add_u32 s47, s46, 2
  s_and_b32 s47, s47, 15
  s_lshl_b32 s34, s47, 7
  s_mul_i32 s35, s47, 393216
  s_add_u32 m0, s32, 81920
  s_nop 0
  buffer_load_dwordx4 v152, s[12:15], s34 offen  lds
  s_add_u32 m0, s32, 82944
  s_nop 0
  buffer_load_dwordx4 v153, s[12:15], s34 offen  lds
  s_add_u32 m0, s32, 83968
  s_nop 0
  buffer_load_dwordx4 v154, s[12:15], s34 offen  lds
  s_add_u32 m0, s32, 84992
  s_nop 0
  buffer_load_dwordx4 v155, s[12:15], s34 offen  lds
  s_add_u32 m0, s33, 81920
  s_nop 0
  buffer_load_dwordx4 v156, s[16:19], s35 offen  lds
  s_add_u32 m0, s33, 82944
  s_nop 0
  buffer_load_dwordx4 v157, s[16:19], s35 offen  lds
  s_add_u32 m0, s33, 83968
  s_nop 0
  buffer_load_dwordx4 v158, s[16:19], s35 offen  lds
  s_add_u32 m0, s33, 84992
  s_nop 0
  buffer_load_dwordx4 v159, s[16:19], s35 offen  lds
  s_add_u32 m0, s33, 86016
  s_nop 0
  buffer_load_dwordx4 v8, s[16:19], s35 offen  lds
  s_add_u32 m0, s33, 87040
  s_nop 0
  buffer_load_dwordx4 v9, s[16:19], s35 offen  lds
  s_add_u32 s47, s46, 3
  s_and_b32 s47, s47, 15
  s_lshl_b32 s34, s47, 7
  s_mul_i32 s35, s47, 393216
  s_add_u32 m0, s32, 122880
  s_nop 0
  buffer_load_dwordx4 v152, s[12:15], s34 offen  lds
  s_add_u32 m0, s32, 123904
  s_nop 0
  buffer_load_dwordx4 v153, s[12:15], s34 offen  lds
  s_waitcnt vmcnt(12)
  s_barrier
  s_add_u32 m0, s32, 124928
  s_nop 0
  buffer_load_dwordx4 v154, s[12:15], s34 offen  lds
  s_add_u32 m0, s32, 125952
  s_nop 0
  buffer_load_dwordx4 v155, s[12:15], s34 offen  lds
  s_add_u32 m0, s33, 122880
  s_nop 0
  buffer_load_dwordx4 v156, s[16:19], s35 offen  lds
  s_add_u32 m0, s33, 123904
  s_nop 0
  buffer_load_dwordx4 v157, s[16:19], s35 offen  lds
  s_add_u32 m0, s33, 124928
  s_nop 0
  buffer_load_dwordx4 v158, s[16:19], s35 offen  lds
  s_add_u32 m0, s33, 125952
  s_nop 0
  buffer_load_dwordx4 v159, s[16:19], s35 offen  lds
  s_add_u32 m0, s33, 126976
  s_nop 0
  buffer_load_dwordx4 v8, s[16:19], s35 offen  lds
  s_add_u32 m0, s33, 128000
  s_nop 0
  buffer_load_dwordx4 v9, s[16:19], s35 offen  lds
  s_add_u32 s47, s46, 4
  s_and_b32 s47, s47, 15
  s_lshl_b32 s34, s47, 7
  s_mul_i32 s35, s47, 393216
  s_add_u32 m0, s32, 0
  s_nop 0
  buffer_load_dwordx4 v152, s[12:15], s34 offen  lds
  s_add_u32 m0, s32, 1024
  s_nop 0
  buffer_load_dwordx4 v153, s[12:15], s34 offen  lds
  s_add_u32 m0, s32, 2048
  s_nop 0
  buffer_load_dwordx4 v154, s[12:15], s34 offen  lds
  s_add_u32 m0, s32, 3072
  s_nop 0
  buffer_load_dwordx4 v155, s[12:15], s34 offen  lds
  s_waitcnt vmcnt(14)
  s_barrier
  s_add_u32 m0, s33, 0
  s_nop 0
  buffer_load_dwordx4 v156, s[16:19], s35 offen  lds
  s_add_u32 m0, s33, 1024
  s_nop 0
  buffer_load_dwordx4 v157, s[16:19], s35 offen  lds
  s_add_u32 m0, s33, 2048
  s_nop 0
  buffer_load_dwordx4 v158, s[16:19], s35 offen  lds
  s_add_u32 m0, s33, 3072
  s_nop 0
  buffer_load_dwordx4 v159, s[16:19], s35 offen  lds
  s_add_u32 m0, s33, 4096
  s_nop 0
  buffer_load_dwordx4 v8, s[16:19], s35 offen  lds
  s_add_u32 m0, s33, 5120
  s_nop 0
  buffer_load_dwordx4 v9, s[16:19], s35 offen  lds
  s_add_u32 s47, s46, 5
  s_and_b32 s47, s47, 15
  s_lshl_b32 s34, s47, 7
  s_mul_i32 s35, s47, 393216
  s_add_u32 m0, s32, 40960
  s_nop 0
  buffer_load_dwordx4 v152, s[12:15], s34 offen  lds
  s_add_u32 m0, s32, 41984
  s_nop 0
  buffer_load_dwordx4 v153, s[12:15], s34 offen  lds
  s_add_u32 m0, s32, 43008
  s_nop 0
  buffer_load_dwordx4 v154, s[12:15], s34 offen  lds
  s_add_u32 m0, s32, 44032
  s_nop 0
  buffer_load_dwordx4 v155, s[12:15], s34 offen  lds
  s_add_u32 m0, s33, 40960
  s_nop 0
  buffer_load_dwordx4 v156, s[16:19], s35 offen  lds
  s_add_u32 m0, s33, 41984
  s_nop 0
  buffer_load_dwordx4 v157, s[16:19], s35 offen  lds
  s_waitcnt vmcnt(16)
  s_barrier
  s_add_u32 m0, s33, 43008
  s_nop 0
  buffer_load_dwordx4 v158, s[16:19], s35 offen  lds
  s_add_u32 m0, s33, 44032
  s_nop 0
  buffer_load_dwordx4 v159, s[16:19], s35 offen  lds
  s_add_u32 m0, s33, 45056
  s_nop 0
  buffer_load_dwordx4 v8, s[16:19], s35 offen  lds
  s_add_u32 m0, s33, 46080
  s_nop 0
  buffer_load_dwordx4 v9, s[16:19], s35 offen  lds
  s_add_u32 s47, s46, 6
  s_and_b32 s47, s47, 15
  s_lshl_b32 s34, s47, 7
  s_mul_i32 s35, s47, 393216
  s_add_u32 m0, s32, 81920
  s_nop 0
  buffer_load_dwordx4 v152, s[12:15], s34 offen  lds
  s_add_u32 m0, s32, 82944
  s_nop 0
  buffer_load_dwordx4 v153, s[12:15], s34 offen  lds
  s_add_u32 m0, s32, 83968
  s_nop 0
  buffer_load_dwordx4 v154, s[12:15], s34 offen  lds
  s_add_u32 m0, s32, 84992
  s_nop 0
  buffer_load_dwordx4 v155, s[12:15], s34 offen  lds
  s_add_u32 m0, s33, 81920
  s_nop 0
  buffer_load_dwordx4 v156, s[16:19], s35 offen  lds
  s_add_u32 m0, s33, 82944
  s_nop 0
  buffer_load_dwordx4 v157, s[16:19], s35 offen  lds
  s_add_u32 m0, s33, 83968
  s_nop 0
  buffer_load_dwordx4 v158, s[16:19], s35 offen  lds
  s_add_u32 m0, s33, 84992
  s_nop 0
  buffer_load_dwordx4 v159, s[16:19], s35 offen  lds
  s_waitcnt vmcnt(18)
  s_barrier
  s_add_u32 m0, s33, 86016
  s_nop 0
  buffer_load_dwordx4 v8, s[16:19], s35 offen  lds
  s_add_u32 m0, s33, 87040
  s_nop 0
  buffer_load_dwordx4 v9, s[16:19], s35 offen  lds
  s_add_u32 s47, s46, 7
  s_and_b32 s47, s47, 15
  s_lshl_b32 s34, s47, 7
  s_mul_i32 s35, s47, 393216
  s_add_u32 m0, s32, 122880
  s_nop 0
  buffer_load_dwordx4 v152, s[12:15], s34 offen  lds
  s_add_u32 m0, s32, 123904
  s_nop 0
  buffer_load_dwordx4 v153, s[12:15], s34 offen  lds
  s_add_u32 m0, s32, 124928
  s_nop 0
  buffer_load_dwordx4 v154, s[12:15], s34 offen  lds
  s_add_u32 m0, s32, 125952
  s_nop 0
  buffer_load_dwordx4 v155, s[12:15], s34 offen  lds
  s_add_u32 m0, s33, 122880
  s_nop 0
  buffer_load_dwordx4 v156, s[16:19], s35 offen  lds
  s_add_u32 m0, s33, 123904
  s_nop 0
  buffer_load_dwordx4 v157, s[16:19], s35 offen  lds
  s_add_u32 m0, s33, 124928
  s_nop 0
  buffer_load_dwordx4 v158, s[16:19], s35 offen  lds
  s_add_u32 m0, s33, 125952
  s_nop 0
  buffer_load_dwordx4 v159, s[16:19], s35 offen  lds
  s_add_u32 m0, s33, 126976
  s_nop 0
  buffer_load_dwordx4 v8, s[16:19], s35 offen  lds
  s_add_u32 m0, s33, 128000
  s_nop 0
  buffer_load_dwordx4 v9, s[16:19], s35 offen  lds
  s_waitcnt vmcnt(20)
  s_barrier
  s_add_u32 s47, s46, 8
  s_and_b32 s47, s47, 15
  s_lshl_b32 s34, s47, 7
  s_mul_i32 s35, s47, 393216
  s_add_u32 m0, s32, 0
  s_nop 0
  buffer_load_dwordx4 v152, s[12:15], s34 offen  lds
  s_add_u32 m0, s32, 1024
  s_nop 0
  buffer_load_dwordx4 v153, s[12:15], s34 offen  lds
  s_add_u32 m0, s32, 2048
  s_nop 0
  buffer_load_dwordx4 v154, s[12:15], s34 offen  lds
  s_add_u32 m0, s32, 3072
  s_nop 0
  buffer_load_dwordx4 v155, s[12:15], s34 offen  lds
  s_add_u32 m0, s33, 0
  s_nop 0
  buffer_load_dwordx4 v156, s[16:19], s35 offen  lds
  s_add_u32 m0, s33, 1024
  s_nop 0
  buffer_load_dwordx4 v157, s[16:19], s35 offen  lds
  s_add_u32 m0, s33, 2048
  s_nop 0
  buffer_load_dwordx4 v158, s[16:19], s35 offen  lds
  s_add_u32 m0, s33, 3072
  s_nop 0
  buffer_load_dwordx4 v159, s[16:19], s35 offen  lds
  s_add_u32 m0, s33, 4096
  s_nop 0
  buffer_load_dwordx4 v8, s[16:19], s35 offen  lds
  s_add_u32 m0, s33, 5120
  s_nop 0
  buffer_load_dwordx4 v9, s[16:19], s35 offen  lds
  s_waitcnt vmcnt(20)
  s_barrier
  s_add_u32 s47, s46, 9
  s_and_b32 s47, s47, 15
  s_lshl_b32 s34, s47, 7
  s_mul_i32 s35, s47, 393216
  s_add_u32 m0, s32, 40960
  s_nop 0
  buffer_load_dwordx4 v152, s[12:15], s34 offen  lds
  s_add_u32 m0, s32, 41984
  s_nop 0
  buffer_load_dwordx4 v153, s[12:15], s34 offen  lds
  s_add_u32 m0, s32, 43008
  s_nop 0
  buffer_load_dwordx4 v154, s[12:15], s34 offen  lds
  s_add_u32 m0, s32, 44032
  s_nop 0
  buffer_load_dwordx4 v155, s[12:15], s34 offen  lds
  s_add_u32 m0, s33, 40960
  s_nop 0
  buffer_load_dwordx4 v156, s[16:19], s35 offen  lds
  s_add_u32 m0, s33, 41984
  s_nop 0
  buffer_load_dwordx4 v157, s[16:19], s35 offen  lds
  s_add_u32 m0, s33, 43008
  s_nop 0
  buffer_load_dwordx4 v158, s[16:19], s35 offen  lds
  s_add_u32 m0, s33, 44032
  s_nop 0
  buffer_load_dwordx4 v159, s[16:19], s35 offen  lds
  s_add_u32 m0, s33, 45056
  s_nop 0
  buffer_load_dwordx4 v8, s[16:19], s35 offen  lds
  s_add_u32 m0, s33, 46080
  s_nop 0
  buffer_load_dwordx4 v9, s[16:19], s35 offen  lds
  v_lshrrev_b32 v10, 4, v0
  v_lshlrev_b32 v10, 2, v10
  v_bfe_u32 v11, v0, 2, 2
  v_add_u32 v10, v10, v11
  v_and_b32 v11, 7, v10
  v_lshlrev_b32 v11, 1, v11
  v_bfe_u32 v12, v0, 1, 1
  v_xor_b32 v11, v11, v12
  v_lshlrev_b32 v11, 4, v11
  v_lshlrev_b32 v10, 8, v10
  v_add_u32 v10, v10, v11
  v_and_b32 v11, 1, v0
  v_lshlrev_b32 v11, 3, v11
  v_add_u32 v10, v10, v11
  v_add_u32 v86, s84, v10
  v_and_b32 v10, 15, v0
  v_lshlrev_b32 v11, 1, v10
  v_lshrrev_b32 v12, 4, v0
  v_xor_b32 v11, v11, v12
  v_lshlrev_b32 v11, 3, v11
  v_lshlrev_b32 v10, 8, v10
  v_add_u32 v10, v10, v11
  v_add_u32 v87, s84, v10
  s_waitcnt vmcnt(20)
  s_barrier
  s_add_u32 s47, s46, 10
  s_and_b32 s47, s47, 15
  s_lshl_b32 s34, s47, 7
  s_mul_i32 s35, s47, 393216
  s_add_u32 m0, s32, 81920
  s_nop 0
  buffer_load_dwordx4 v152, s[12:15], s34 offen  lds
  s_add_u32 m0, s32, 82944
  s_nop 0
  buffer_load_dwordx4 v153, s[12:15], s34 offen  lds
  s_add_u32 m0, s32, 83968
  s_nop 0
  buffer_load_dwordx4 v154, s[12:15], s34 offen  lds
  s_add_u32 m0, s32, 84992
  s_nop 0
  buffer_load_dwordx4 v155, s[12:15], s34 offen  lds
  s_add_u32 m0, s33, 81920
  s_nop 0
  buffer_load_dwordx4 v156, s[16:19], s35 offen  lds
  s_add_u32 m0, s33, 82944
  s_nop 0
  buffer_load_dwordx4 v157, s[16:19], s35 offen  lds
  s_add_u32 m0, s33, 83968
  s_nop 0
  buffer_load_dwordx4 v158, s[16:19], s35 offen  lds
  s_add_u32 m0, s33, 84992
  s_nop 0
  buffer_load_dwordx4 v159, s[16:19], s35 offen  lds
  s_add_u32 m0, s33, 86016
  s_nop 0
  buffer_load_dwordx4 v8, s[16:19], s35 offen  lds
  s_add_u32 m0, s33, 87040
  s_nop 0
  buffer_load_dwordx4 v9, s[16:19], s35 offen  lds
  s_waitcnt vmcnt(20)
  s_barrier
  s_add_u32 s47, s46, 11
  s_and_b32 s47, s47, 15
  s_lshl_b32 s34, s47, 7
  s_mul_i32 s35, s47, 393216
  s_add_u32 m0, s32, 122880
  s_nop 0
  buffer_load_dwordx4 v152, s[12:15], s34 offen  lds
  s_add_u32 m0, s32, 123904
  s_nop 0
  buffer_load_dwordx4 v153, s[12:15], s34 offen  lds
  s_add_u32 m0, s32, 124928
  s_nop 0
  buffer_load_dwordx4 v154, s[12:15], s34 offen  lds
  s_add_u32 m0, s32, 125952
  s_nop 0
  buffer_load_dwordx4 v155, s[12:15], s34 offen  lds
  s_add_u32 m0, s33, 122880
  s_nop 0
  buffer_load_dwordx4 v156, s[16:19], s35 offen  lds
  s_add_u32 m0, s33, 123904
  s_nop 0
  buffer_load_dwordx4 v157, s[16:19], s35 offen  lds
  s_add_u32 m0, s33, 124928
  s_nop 0
  buffer_load_dwordx4 v158, s[16:19], s35 offen  lds
  s_add_u32 m0, s33, 125952
  s_nop 0
  buffer_load_dwordx4 v159, s[16:19], s35 offen  lds
  s_add_u32 m0, s33, 126976
  s_nop 0
  buffer_load_dwordx4 v8, s[16:19], s35 offen  lds
  s_add_u32 m0, s33, 128000
  s_nop 0
  buffer_load_dwordx4 v9, s[16:19], s35 offen  lds
  v_lshrrev_b32 v240, 5, v0
  v_lshlrev_b32 v240, 13, v240
  v_bfe_u32 v241, v0, 2, 2
  v_lshlrev_b32 v241, 3, v241
  v_bfe_u32 v224, v0, 4, 1
  v_lshlrev_b32 v224, 2, v224
  v_add_u32 v241, v241, v224
  v_and_b32 v224, 3, v0
  v_add_u32 v241, v241, v224
  s_lshl_b32 s87, s25, 2
  v_xor_b32 v224, s87, v241
  v_lshlrev_b32 v224, 3, v224
  v_add_u32 v224, v240, v224
  s_lshl_b32 s88, s25, 9
  v_add_u32 v243, s88, v224
  s_add_u32 s87, s87, 2
  v_xor_b32 v224, s87, v241
  v_lshlrev_b32 v224, 3, v224
  v_add_u32 v224, v240, v224
  s_add_u32 s88, s88, 256
  v_add_u32 v244, s88, v224
  s_lshl_b32 s87, s81, 3
  s_add_u32 s87, s87, s25
  s_lshl_b32 s87, s87, 18
  s_lshl_b32 s88, s80, 11
  s_add_u32 s87, s87, s88
  v_and_b32 v240, 31, v0
  v_lshlrev_b32 v240, 5, v240
  v_lshrrev_b32 v241, 5, v0
  v_lshlrev_b32 v241, 4, v241
  v_add_u32 v240, v240, v241
  v_add_u32 v245, s87, v240
  s_waitcnt vmcnt(20)
  s_barrier
  s_add_u32 s47, s46, 12
  s_and_b32 s47, s47, 15
  s_lshl_b32 s34, s47, 7
  s_mul_i32 s35, s47, 393216
  s_add_u32 m0, s32, 0
  s_nop 0
  buffer_load_dwordx4 v152, s[12:15], s34 offen  lds
  s_add_u32 m0, s32, 1024
  s_nop 0
  buffer_load_dwordx4 v153, s[12:15], s34 offen  lds
  s_add_u32 m0, s32, 2048
  s_nop 0
  buffer_load_dwordx4 v154, s[12:15], s34 offen  lds
  s_add_u32 m0, s32, 3072
  s_nop 0
  buffer_load_dwordx4 v155, s[12:15], s34 offen  lds
  s_add_u32 m0, s33, 0
  s_nop 0
  buffer_load_dwordx4 v156, s[16:19], s35 offen  lds
  s_add_u32 m0, s33, 1024
  s_nop 0
  buffer_load_dwordx4 v157, s[16:19], s35 offen  lds
  s_add_u32 m0, s33, 2048
  s_nop 0
  buffer_load_dwordx4 v158, s[16:19], s35 offen  lds
  s_add_u32 m0, s33, 3072
  s_nop 0
  buffer_load_dwordx4 v159, s[16:19], s35 offen  lds
  s_add_u32 m0, s33, 4096
  s_nop 0
  buffer_load_dwordx4 v8, s[16:19], s35 offen  lds
  s_add_u32 m0, s33, 5120
  s_nop 0
  buffer_load_dwordx4 v9, s[16:19], s35 offen  lds
  s_waitcnt vmcnt(20)
  s_barrier
  s_add_u32 s47, s46, 13
  s_and_b32 s47, s47, 15
  s_lshl_b32 s34, s47, 7
  s_mul_i32 s35, s47, 393216
  s_add_u32 m0, s32, 40960
  s_nop 0
  buffer_load_dwordx4 v152, s[12:15], s34 offen  lds
  s_add_u32 m0, s32, 41984
  s_nop 0
  buffer_load_dwordx4 v153, s[12:15], s34 offen  lds
  s_add_u32 m0, s32, 43008
  s_nop 0
  buffer_load_dwordx4 v154, s[12:15], s34 offen  lds
  s_add_u32 m0, s32, 44032
  s_nop 0
  buffer_load_dwordx4 v155, s[12:15], s34 offen  lds
  s_add_u32 m0, s33, 40960
  s_nop 0
  buffer_load_dwordx4 v156, s[16:19], s35 offen  lds
  s_add_u32 m0, s33, 41984
  s_nop 0
  buffer_load_dwordx4 v157, s[16:19], s35 offen  lds
  s_add_u32 m0, s33, 43008
  s_nop 0
  buffer_load_dwordx4 v158, s[16:19], s35 offen  lds
  s_add_u32 m0, s33, 44032
  s_nop 0
  buffer_load_dwordx4 v159, s[16:19], s35 offen  lds
  s_add_u32 m0, s33, 45056
  s_nop 0
  buffer_load_dwordx4 v8, s[16:19], s35 offen  lds
  s_add_u32 m0, s33, 46080
  s_nop 0
  buffer_load_dwordx4 v9, s[16:19], s35 offen  lds
  s_waitcnt vmcnt(20)
  s_barrier
  s_add_u32 s47, s46, 14
  s_and_b32 s47, s47, 15
  s_lshl_b32 s34, s47, 7
  s_mul_i32 s35, s47, 393216
  s_add_u32 m0, s32, 81920
  s_nop 0
  buffer_load_dwordx4 v152, s[12:15], s34 offen  lds
  s_add_u32 m0, s32, 82944
  s_nop 0
  buffer_load_dwordx4 v153, s[12:15], s34 offen  lds
  s_add_u32 m0, s32, 83968
  s_nop 0
  buffer_load_dwordx4 v154, s[12:15], s34 offen  lds
  s_add_u32 m0, s32, 84992
  s_nop 0
  buffer_load_dwordx4 v155, s[12:15], s34 offen  lds
  s_add_u32 m0, s33, 81920
  s_nop 0
  buffer_load_dwordx4 v156, s[16:19], s35 offen  lds
  s_add_u32 m0, s33, 82944
  s_nop 0
  buffer_load_dwordx4 v157, s[16:19], s35 offen  lds
  s_add_u32 m0, s33, 83968
  s_nop 0
  buffer_load_dwordx4 v158, s[16:19], s35 offen  lds
  s_add_u32 m0, s33, 84992
  s_nop 0
  buffer_load_dwordx4 v159, s[16:19], s35 offen  lds
  s_add_u32 m0, s33, 86016
  s_nop 0
  buffer_load_dwordx4 v8, s[16:19], s35 offen  lds
  s_add_u32 m0, s33, 87040
  s_nop 0
  buffer_load_dwordx4 v9, s[16:19], s35 offen  lds
  s_waitcnt vmcnt(20)
  s_barrier
  s_add_u32 s47, s46, 15
  s_and_b32 s47, s47, 15
  s_lshl_b32 s34, s47, 7
  s_mul_i32 s35, s47, 393216
  s_add_u32 m0, s32, 122880
  s_nop 0
  buffer_load_dwordx4 v152, s[12:15], s34 offen  lds
  s_add_u32 m0, s32, 123904
  s_nop 0
  buffer_load_dwordx4 v153, s[12:15], s34 offen  lds
  s_add_u32 m0, s32, 124928
  s_nop 0
  buffer_load_dwordx4 v154, s[12:15], s34 offen  lds
  s_add_u32 m0, s32, 125952
  s_nop 0
  buffer_load_dwordx4 v155, s[12:15], s34 offen  lds
  s_add_u32 m0, s33, 122880
  s_nop 0
  buffer_load_dwordx4 v156, s[16:19], s35 offen  lds
  s_add_u32 m0, s33, 123904
  s_nop 0
  buffer_load_dwordx4 v157, s[16:19], s35 offen  lds
  s_add_u32 m0, s33, 124928
  s_nop 0
  buffer_load_dwordx4 v158, s[16:19], s35 offen  lds
  s_add_u32 m0, s33, 125952
  s_nop 0
  buffer_load_dwordx4 v159, s[16:19], s35 offen  lds
  s_add_u32 m0, s33, 126976
  s_nop 0
  buffer_load_dwordx4 v8, s[16:19], s35 offen  lds
  s_add_u32 m0, s33, 128000
  s_nop 0
  buffer_load_dwordx4 v9, s[16:19], s35 offen  lds
  s_waitcnt vmcnt(20)
  s_barrier
  s_add_u32 m0, s84, 0
  s_mov_b32 s86, 0
  buffer_load_dwordx4 v84, s[72:75], s86 offen offset:0 lds
  s_add_u32 m0, s84, 1024
  s_mov_b32 s86, 524288
  buffer_load_dwordx4 v85, s[72:75], s86 offen offset:0 lds
  s_add_u32 m0, s84, 2048
  s_mov_b32 s86, 1048576
  buffer_load_dwordx4 v84, s[72:75], s86 offen offset:0 lds
  s_add_u32 m0, s84, 3072
  s_mov_b32 s86, 1572864
  buffer_load_dwordx4 v85, s[72:75], s86 offen offset:0 lds
  s_add_u32 m0, s84, 4096
  s_mov_b32 s86, 2097152
  buffer_load_dwordx4 v84, s[72:75], s86 offen offset:0 lds
  s_add_u32 m0, s84, 5120
  s_mov_b32 s86, 2621440
  buffer_load_dwordx4 v85, s[72:75], s86 offen offset:0 lds
  s_add_u32 m0, s84, 6144
  s_mov_b32 s86, 3145728
  buffer_load_dwordx4 v84, s[72:75], s86 offen offset:0 lds
  s_add_u32 m0, s84, 7168
  s_mov_b32 s86, 3670016
  buffer_load_dwordx4 v85, s[72:75], s86 offen offset:0 lds
  s_waitcnt vmcnt(18)
  s_barrier
  s_add_u32 m0, s84, 31744
  s_mov_b32 s86, 0
  buffer_load_dwordx4 v84, s[72:75], s86 offen offset:1024 lds
  s_add_u32 m0, s84, 32768
  s_mov_b32 s86, 524288
  buffer_load_dwordx4 v85, s[72:75], s86 offen offset:1024 lds
  s_add_u32 m0, s84, 33792
  s_mov_b32 s86, 1048576
  buffer_load_dwordx4 v84, s[72:75], s86 offen offset:1024 lds
  s_add_u32 m0, s84, 34816
  s_mov_b32 s86, 1572864
  buffer_load_dwordx4 v85, s[72:75], s86 offen offset:1024 lds
  s_add_u32 m0, s84, 35840
  s_mov_b32 s86, 2097152
  buffer_load_dwordx4 v84, s[72:75], s86 offen offset:1024 lds
  s_add_u32 m0, s84, 36864
  s_mov_b32 s86, 2621440
  buffer_load_dwordx4 v85, s[72:75], s86 offen offset:1024 lds
  s_add_u32 m0, s84, 37888
  s_mov_b32 s86, 3145728
  buffer_load_dwordx4 v84, s[72:75], s86 offen offset:1024 lds
  s_add_u32 m0, s84, 38912
  s_mov_b32 s86, 3670016
  buffer_load_dwordx4 v85, s[72:75], s86 offen offset:1024 lds
  s_waitcnt vmcnt(16)
  s_barrier
  s_waitcnt vmcnt(8)
  v_xor_b32 v10, 0, v86
  ds_read_b64_tr_b16 v[16:17], v10
  ds_read_b64_tr_b16 v[18:19], v10 offset:4096
  v_xor_b32 v11, 32, v86
  ds_read_b64_tr_b16 v[20:21], v11
  ds_read_b64_tr_b16 v[22:23], v11 offset:4096
  v_xor_b32 v10, 64, v86
  ds_read_b64_tr_b16 v[24:25], v10
  ds_read_b64_tr_b16 v[26:27], v10 offset:4096
  v_xor_b32 v11, 96, v86
  ds_read_b64_tr_b16 v[28:29], v11
  ds_read_b64_tr_b16 v[30:31], v11 offset:4096
  v_xor_b32 v10, 128, v86
  ds_read_b64_tr_b16 v[32:33], v10
  ds_read_b64_tr_b16 v[34:35], v10 offset:4096
  v_xor_b32 v11, 160, v86
  ds_read_b64_tr_b16 v[36:37], v11
  ds_read_b64_tr_b16 v[38:39], v11 offset:4096
  v_xor_b32 v10, 192, v86
  ds_read_b64_tr_b16 v[40:41], v10
  ds_read_b64_tr_b16 v[42:43], v10 offset:4096
  v_xor_b32 v11, 224, v86
  ds_read_b64_tr_b16 v[44:45], v11
  ds_read_b64_tr_b16 v[46:47], v11 offset:4096
  s_waitcnt lgkmcnt(0)
  v_mfma_f32_16x16x32_bf16 v[48:51], v[16:19], v[80:83], 0
  v_mfma_f32_16x16x32_bf16 v[52:55], v[20:23], v[80:83], 0
  v_mfma_f32_16x16x32_bf16 v[56:59], v[24:27], v[80:83], 0
  v_mfma_f32_16x16x32_bf16 v[60:63], v[28:31], v[80:83], 0
  v_mfma_f32_16x16x32_bf16 v[64:67], v[32:35], v[80:83], 0
  v_mfma_f32_16x16x32_bf16 v[68:71], v[36:39], v[80:83], 0
  v_mfma_f32_16x16x32_bf16 v[72:75], v[40:43], v[80:83], 0
  v_mfma_f32_16x16x32_bf16 v[76:79], v[44:47], v[80:83], 0
  s_nop 7
  v_cvt_pk_bf16_f32 v16, v48, v49
  v_cvt_pk_bf16_f32 v17, v50, v51
  v_xor_b32 v10, 0, v87
  ds_write_b64 v10, v[16:17] offset:0
  v_cvt_pk_bf16_f32 v18, v52, v53
  v_cvt_pk_bf16_f32 v19, v54, v55
  v_xor_b32 v11, 32, v87
  ds_write_b64 v11, v[18:19] offset:0
  v_cvt_pk_bf16_f32 v20, v56, v57
  v_cvt_pk_bf16_f32 v21, v58, v59
  v_xor_b32 v10, 64, v87
  ds_write_b64 v10, v[20:21] offset:0
  v_cvt_pk_bf16_f32 v22, v60, v61
  v_cvt_pk_bf16_f32 v23, v62, v63
  v_xor_b32 v11, 96, v87
  ds_write_b64 v11, v[22:23] offset:0
  v_cvt_pk_bf16_f32 v24, v64, v65
  v_cvt_pk_bf16_f32 v25, v66, v67
  v_xor_b32 v10, 128, v87
  ds_write_b64 v10, v[24:25] offset:0
  v_cvt_pk_bf16_f32 v26, v68, v69
  v_cvt_pk_bf16_f32 v27, v70, v71
  v_xor_b32 v11, 160, v87
  ds_write_b64 v11, v[26:27] offset:0
  v_cvt_pk_bf16_f32 v28, v72, v73
  v_cvt_pk_bf16_f32 v29, v74, v75
  v_xor_b32 v10, 192, v87
  ds_write_b64 v10, v[28:29] offset:0
  v_cvt_pk_bf16_f32 v30, v76, v77
  v_cvt_pk_bf16_f32 v31, v78, v79
  v_xor_b32 v11, 224, v87
  ds_write_b64 v11, v[30:31] offset:0
  s_waitcnt lgkmcnt(0)
  s_waitcnt vmcnt(0)
  v_xor_b32 v10, 0, v86
  v_add_u32 v10, 32768, v10
  ds_read_b64_tr_b16 v[16:17], v10
  ds_read_b64_tr_b16 v[18:19], v10 offset:4096
  v_xor_b32 v11, 32, v86
  v_add_u32 v11, 32768, v11
  ds_read_b64_tr_b16 v[20:21], v11
  ds_read_b64_tr_b16 v[22:23], v11 offset:4096
  v_xor_b32 v10, 64, v86
  v_add_u32 v10, 32768, v10
  ds_read_b64_tr_b16 v[24:25], v10
  ds_read_b64_tr_b16 v[26:27], v10 offset:4096
  v_xor_b32 v11, 96, v86
  v_add_u32 v11, 32768, v11
  ds_read_b64_tr_b16 v[28:29], v11
  ds_read_b64_tr_b16 v[30:31], v11 offset:4096
  v_xor_b32 v10, 128, v86
  v_add_u32 v10, 32768, v10
  ds_read_b64_tr_b16 v[32:33], v10
  ds_read_b64_tr_b16 v[34:35], v10 offset:4096
  v_xor_b32 v11, 160, v86
  v_add_u32 v11, 32768, v11
  ds_read_b64_tr_b16 v[36:37], v11
  ds_read_b64_tr_b16 v[38:39], v11 offset:4096
  v_xor_b32 v10, 192, v86
  v_add_u32 v10, 32768, v10
  ds_read_b64_tr_b16 v[40:41], v10
  ds_read_b64_tr_b16 v[42:43], v10 offset:4096
  v_xor_b32 v11, 224, v86
  v_add_u32 v11, 32768, v11
  ds_read_b64_tr_b16 v[44:45], v11
  ds_read_b64_tr_b16 v[46:47], v11 offset:4096
  s_waitcnt lgkmcnt(0)
  v_mfma_f32_16x16x32_bf16 v[48:51], v[16:19], v[80:83], 0
  v_mfma_f32_16x16x32_bf16 v[52:55], v[20:23], v[80:83], 0
  v_mfma_f32_16x16x32_bf16 v[56:59], v[24:27], v[80:83], 0
  v_mfma_f32_16x16x32_bf16 v[60:63], v[28:31], v[80:83], 0
  v_mfma_f32_16x16x32_bf16 v[64:67], v[32:35], v[80:83], 0
  v_mfma_f32_16x16x32_bf16 v[68:71], v[36:39], v[80:83], 0
  v_mfma_f32_16x16x32_bf16 v[72:75], v[40:43], v[80:83], 0
  v_mfma_f32_16x16x32_bf16 v[76:79], v[44:47], v[80:83], 0
  s_nop 7
  v_cvt_pk_bf16_f32 v16, v48, v49
  v_cvt_pk_bf16_f32 v17, v50, v51
  v_xor_b32 v10, 0, v87
  ds_write_b64 v10, v[16:17] offset:32768
  v_cvt_pk_bf16_f32 v18, v52, v53
  v_cvt_pk_bf16_f32 v19, v54, v55
  v_xor_b32 v11, 32, v87
  ds_write_b64 v11, v[18:19] offset:32768
  v_cvt_pk_bf16_f32 v20, v56, v57
  v_cvt_pk_bf16_f32 v21, v58, v59
  v_xor_b32 v10, 64, v87
  ds_write_b64 v10, v[20:21] offset:32768
  v_cvt_pk_bf16_f32 v22, v60, v61
  v_cvt_pk_bf16_f32 v23, v62, v63
  v_xor_b32 v11, 96, v87
  ds_write_b64 v11, v[22:23] offset:32768
  v_cvt_pk_bf16_f32 v24, v64, v65
  v_cvt_pk_bf16_f32 v25, v66, v67
  v_xor_b32 v10, 128, v87
  ds_write_b64 v10, v[24:25] offset:32768
  v_cvt_pk_bf16_f32 v26, v68, v69
  v_cvt_pk_bf16_f32 v27, v70, v71
  v_xor_b32 v11, 160, v87
  ds_write_b64 v11, v[26:27] offset:32768
  v_cvt_pk_bf16_f32 v28, v72, v73
  v_cvt_pk_bf16_f32 v29, v74, v75
  v_xor_b32 v10, 192, v87
  ds_write_b64 v10, v[28:29] offset:32768
  v_cvt_pk_bf16_f32 v30, v76, v77
  v_cvt_pk_bf16_f32 v31, v78, v79
  v_xor_b32 v11, 224, v87
  ds_write_b64 v11, v[30:31] offset:32768
  s_waitcnt lgkmcnt(0)
  s_barrier
  v_lshlrev_b32 v10, 4, v0
  v_add_u32 v10, 81920, v10
  ds_read_b128 v[160:163], v10 offset:0
  ds_read_b128 v[164:167], v10 offset:1024
  ds_read_b128 v[168:171], v10 offset:2048
  ds_read_b128 v[172:175], v10 offset:3072
  ds_read_b128 v[192:195], v10 offset:4096
  ds_read_b128 v[196:199], v10 offset:5120
  ds_read_b128 v[200:203], v10 offset:6144
  ds_read_b128 v[204:207], v10 offset:7168
  ds_read_b128 v[208:211], v10 offset:8192
  ds_read_b128 v[212:215], v10 offset:9216
  ds_read_b128 v[216:219], v10 offset:10240
  ds_read_b128 v[220:223], v10 offset:11264
  ds_read_b64_tr_b16 v[16:17], v243 offset:0
  ds_read_b64_tr_b16 v[18:19], v243 offset:16384
  ds_read_b64_tr_b16 v[20:21], v243 offset:32768
  ds_read_b64_tr_b16 v[22:23], v243 offset:49152
  ds_read_b64_tr_b16 v[24:25], v244 offset:0
  ds_read_b64_tr_b16 v[26:27], v244 offset:16384
  ds_read_b64_tr_b16 v[28:29], v244 offset:32768
  ds_read_b64_tr_b16 v[30:31], v244 offset:49152
  s_waitcnt lgkmcnt(0)
  s_barrier
  s_mov_b32 s22, s25
  s_and_b32 s44, s2, 7
  s_bfe_u32 s45, s2, 0x20003
  s_lshr_b32 s21, s2, 5
  s_lshl_b32 s20, s44, 2
  s_add_u32 s20, s20, s45
  v_lshlrev_b32 v5, 4, v0
  s_lshl_b32 s23, s21, 3
  s_add_u32 s23, s23, s22
  s_lshl_b32 s24, s20, 6
  s_add_u32 s24, s24, s23
  s_lshl_b32 s24, s24, 11
  s_lshl_b32 s25, s20, 18
  s_add_u32 s25, s25, 0x400000
  s_and_b32 s46, s22, 3
  s_lshr_b32 s52, s22, 2
  s_lshl_b32 s26, s46, 12
  v_add_u32 v4, s26, v5
  s_mov_b32 s12, s8
  s_mov_b32 s13, s9
  s_mov_b32 s14, 0x1000000
  s_mov_b32 s15, 0x00020000
  s_mov_b32 s16, s48
  s_mov_b32 s17, s49
  s_mov_b32 s18, 0x200000
  s_mov_b32 s19, 0x00020000
  s_add_u32 s56, s8, 0x1000000
  s_addc_u32 s57, s9, 0
  s_mov_b32 s58, 0x800000
  s_mov_b32 s59, 0x00020000
  v_lshrrev_b32 v6, 4, v0
  v_lshlrev_b32 v7, 2, v6
  v_and_b32 v1, 15, v0
  v_xor_b32 v1, v1, v7
  v_lshlrev_b32 v1, 4, v1
  v_lshlrev_b32 v6, 11, v6
  v_add_u32 v1, v1, v6
  s_lshr_b32 s28, s46, 1
  s_lshl_b32 s28, s28, 20
  s_and_b32 s29, s46, 1
  s_lshl_b32 s29, s29, 15
  s_add_u32 s28, s28, s29
  s_lshl_b32 s29, s21, 8
  s_add_u32 s28, s28, s29
  v_add_u32 v1, s28, v1
  s_add_u32 s47, s26, 65536
  v_bfe_u32 v6, v0, 2, 2
  v_lshrrev_b32 v7, 5, v0
  v_lshlrev_b32 v7, 2, v7
  v_add_u32 v7, v7, v6
  v_lshlrev_b32 v2, 8, v7
  v_xor_b32 v6, s46, v6
  v_lshlrev_b32 v6, 6, v6
  v_add_u32 v2, v2, v6
  v_bfe_u32 v6, v0, 4, 1
  v_lshlrev_b32 v6, 5, v6
  v_add_u32 v2, v2, v6
  v_and_b32 v6, 1, v0
  v_lshlrev_b32 v6, 4, v6
  v_add_u32 v2, v2, v6
  v_bfe_u32 v6, v0, 1, 1
  v_lshlrev_b32 v6, 3, v6
  v_add_u32 v2, v2, v6
  s_lshl_b32 s28, s52, 13
  s_add_u32 s28, s28, 65536
  v_add_u32 v2, s28, v2
  s_lshl_b32 s48, s45, 3
  s_add_u32 s48, s48, s44
  v_lshrrev_b32 v6, 4, v0
  v_and_b32 v7, 15, v0
  v_lshlrev_b32 v3, 1, v6
  v_xor_b32 v7, v7, v3
  v_lshrrev_b32 v3, 3, v7
  v_lshlrev_b32 v3, 10, v3
  v_and_b32 v7, 7, v7
  v_lshlrev_b32 v7, 4, v7
  v_add_u32 v7, v7, v3
  v_lshlrev_b32 v6, 11, v6
  v_add_u32 v6, v6, v7
  s_lshl_b32 s28, s48, 18
  s_lshl_b32 s29, s46, 16
  s_add_u32 s28, s28, s29
  s_lshl_b32 s29, s21, 7
  s_add_u32 s28, s28, s29
  v_add_u32 v3, s28, v6
  s_lshl_b32 s49, s46, 13
  s_add_u32 s49, s49, 131072
  v_and_b32 v6, 7, v0
  v_bfe_u32 v7, v0, 4, 1
  v_lshlrev_b32 v7, 2, v7
  v_cmp_eq_u32 vcc, v6, v7
  v_mov_b32 v6, 0x3f803f80
  s_nop 1
  v_cndmask_b32 v92, 0, v6, vcc
  v_cndmask_b32 v93, 0, v6, vcc
  v_cndmask_b32 v94, 0, v6, vcc
  v_cndmask_b32 v95, 0, v6, vcc
  s_mov_b32 s27, 0
  v_xor_b32 v176, 0x80008000, v168
  v_xor_b32 v184, 0x80008000, v160
  v_xor_b32 v177, 0x80008000, v169
  v_xor_b32 v185, 0x80008000, v161
  v_xor_b32 v178, 0x80008000, v170
  v_xor_b32 v186, 0x80008000, v162
  v_xor_b32 v179, 0x80008000, v171
  v_xor_b32 v187, 0x80008000, v163
  v_xor_b32 v180, 0x80008000, v172
  v_xor_b32 v188, 0x80008000, v164
  v_xor_b32 v181, 0x80008000, v173
  v_xor_b32 v189, 0x80008000, v165
  v_xor_b32 v182, 0x80008000, v174
  v_xor_b32 v190, 0x80008000, v166
  v_xor_b32 v183, 0x80008000, v175
  v_xor_b32 v191, 0x80008000, v167
  v_mfma_f32_32x32x16_bf16 v[32:47], v[16:19], v[160:163], 0
  v_mfma_f32_32x32x16_bf16 v[48:63], v[16:19], v[168:171], 0
  v_mfma_f32_32x32x16_bf16 v[32:47], v[20:23], v[164:167], v[32:47]
  v_mfma_f32_32x32x16_bf16 v[48:63], v[20:23], v[172:175], v[48:63]
  v_mfma_f32_32x32x16_bf16 v[32:47], v[24:27], v[176:179], v[32:47]
  v_mfma_f32_32x32x16_bf16 v[48:63], v[24:27], v[160:163], v[48:63]
  v_mfma_f32_32x32x16_bf16 v[32:47], v[28:31], v[180:183], v[32:47]
  v_mfma_f32_32x32x16_bf16 v[48:63], v[28:31], v[164:167], v[48:63]
  s_nop 15
  v_pk_mul_f32 v[16:17], v[48:49], v[208:209]
  v_pk_mul_f32 v[208:209], v[32:33], v[208:209]
  v_pk_fma_f32 v[32:33], v[32:33], v[192:193], v[16:17] neg_lo:[0,0,1] neg_hi:[0,0,1]
  v_pk_fma_f32 v[48:49], v[48:49], v[192:193], v[208:209]
  v_pk_mul_f32 v[18:19], v[50:51], v[210:211]
  v_pk_mul_f32 v[210:211], v[34:35], v[210:211]
  v_pk_fma_f32 v[34:35], v[34:35], v[194:195], v[18:19] neg_lo:[0,0,1] neg_hi:[0,0,1]
  v_pk_fma_f32 v[50:51], v[50:51], v[194:195], v[210:211]
  v_pk_mul_f32 v[16:17], v[52:53], v[212:213]
  v_pk_mul_f32 v[212:213], v[36:37], v[212:213]
  v_pk_fma_f32 v[36:37], v[36:37], v[196:197], v[16:17] neg_lo:[0,0,1] neg_hi:[0,0,1]
  v_pk_fma_f32 v[52:53], v[52:53], v[196:197], v[212:213]
  v_pk_mul_f32 v[18:19], v[54:55], v[214:215]
  v_pk_mul_f32 v[214:215], v[38:39], v[214:215]
  v_pk_fma_f32 v[38:39], v[38:39], v[198:199], v[18:19] neg_lo:[0,0,1] neg_hi:[0,0,1]
  v_pk_fma_f32 v[54:55], v[54:55], v[198:199], v[214:215]
  v_pk_mul_f32 v[16:17], v[56:57], v[216:217]
  v_pk_mul_f32 v[216:217], v[40:41], v[216:217]
  v_pk_fma_f32 v[40:41], v[40:41], v[200:201], v[16:17] neg_lo:[0,0,1] neg_hi:[0,0,1]
  v_pk_fma_f32 v[56:57], v[56:57], v[200:201], v[216:217]
  v_pk_mul_f32 v[18:19], v[58:59], v[218:219]
  v_pk_mul_f32 v[218:219], v[42:43], v[218:219]
  v_pk_fma_f32 v[42:43], v[42:43], v[202:203], v[18:19] neg_lo:[0,0,1] neg_hi:[0,0,1]
  v_pk_fma_f32 v[58:59], v[58:59], v[202:203], v[218:219]
  v_pk_mul_f32 v[16:17], v[60:61], v[220:221]
  v_pk_mul_f32 v[220:221], v[44:45], v[220:221]
  v_pk_fma_f32 v[44:45], v[44:45], v[204:205], v[16:17] neg_lo:[0,0,1] neg_hi:[0,0,1]
  v_pk_fma_f32 v[60:61], v[60:61], v[204:205], v[220:221]
  v_pk_mul_f32 v[18:19], v[62:63], v[222:223]
  v_pk_mul_f32 v[222:223], v[46:47], v[222:223]
  v_pk_fma_f32 v[46:47], v[46:47], v[206:207], v[18:19] neg_lo:[0,0,1] neg_hi:[0,0,1]
  v_pk_fma_f32 v[62:63], v[62:63], v[206:207], v[222:223]
  v_cvt_pk_bf16_f32 v64, v32, v33
  v_cvt_pk_bf16_f32 v72, v48, v49
  v_cvt_pk_bf16_f32 v65, v34, v35
  v_cvt_pk_bf16_f32 v73, v50, v51
  v_cvt_pk_bf16_f32 v66, v36, v37
  v_cvt_pk_bf16_f32 v74, v52, v53
  v_cvt_pk_bf16_f32 v67, v38, v39
  v_cvt_pk_bf16_f32 v75, v54, v55
  v_cvt_pk_bf16_f32 v68, v40, v41
  v_cvt_pk_bf16_f32 v76, v56, v57
  v_cvt_pk_bf16_f32 v69, v42, v43
  v_cvt_pk_bf16_f32 v77, v58, v59
  v_cvt_pk_bf16_f32 v70, v44, v45
  v_cvt_pk_bf16_f32 v78, v60, v61
  v_cvt_pk_bf16_f32 v71, v46, v47
  v_cvt_pk_bf16_f32 v79, v62, v63
  s_nop 1
  v_mfma_f32_32x32x16_bf16 v[32:47], v[64:67], v[160:163], 0
  v_mfma_f32_32x32x16_bf16 v[48:63], v[64:67], v[176:179], 0
  v_mfma_f32_32x32x16_bf16 v[32:47], v[68:71], v[164:167], v[32:47]
  v_mfma_f32_32x32x16_bf16 v[48:63], v[68:71], v[180:183], v[48:63]
  v_mfma_f32_32x32x16_bf16 v[32:47], v[72:75], v[176:179], v[32:47]
  v_mfma_f32_32x32x16_bf16 v[48:63], v[72:75], v[184:187], v[48:63]
  v_mfma_f32_32x32x16_bf16 v[32:47], v[76:79], v[180:183], v[32:47]
  v_mfma_f32_32x32x16_bf16 v[48:63], v[76:79], v[188:191], v[48:63]
  s_nop 15
  v_cvt_pk_bf16_f32 v224, v32, v33
  v_cvt_pk_bf16_f32 v225, v34, v35
  v_cvt_pk_bf16_f32 v226, v36, v37
  v_cvt_pk_bf16_f32 v227, v38, v39
  v_cvt_pk_bf16_f32 v228, v40, v41
  v_cvt_pk_bf16_f32 v229, v42, v43
  v_cvt_pk_bf16_f32 v230, v44, v45
  v_cvt_pk_bf16_f32 v231, v46, v47
  v_cvt_pk_bf16_f32 v232, v48, v49
  v_cvt_pk_bf16_f32 v233, v50, v51
  v_cvt_pk_bf16_f32 v234, v52, v53
  v_cvt_pk_bf16_f32 v235, v54, v55
  v_cvt_pk_bf16_f32 v236, v56, v57
  v_cvt_pk_bf16_f32 v237, v58, v59
  v_cvt_pk_bf16_f32 v238, v60, v61
  v_cvt_pk_bf16_f32 v239, v62, v63
  s_branch concat_heads__mha_block__spectral_fnet__prompt_kernel_p2in
concat_heads__mha_block__spectral_fnet__prompt_kernel_consumer:
  s_waitcnt lgkmcnt(0)
  s_add_u32 s92, s8, 0x1800000
  s_addc_u32 s93, s9, 0
  s_mov_b32 s94, 0x4000
  s_mov_b32 s95, 0x00020000
  s_load_dword s89, s[92:93], 0
  s_mov_b32 s12, s4
  s_mov_b32 s13, s5
  s_mov_b32 s14, 0x400000
  s_mov_b32 s15, 0x00020000
  s_mov_b32 s16, s6
  s_mov_b32 s17, s7
  s_mov_b32 s18, 0x600000
  s_mov_b32 s19, 0x00020000
  s_add_u32 s76, s8, 0x1000000
  s_addc_u32 s77, s9, 0
  s_mov_b32 s78, 0x800000
  s_mov_b32 s79, 0x00020000
  s_mov_b32 s72, s38
  s_mov_b32 s73, s39
  s_mov_b32 s74, 0x400000
  s_mov_b32 s75, 0x00020000
  s_lshr_b32 s26, s25, 1
  s_and_b32 s27, s25, 1
  v_and_b32 v8, 31, v0
  s_lshl_b32 s28, s26, 6
  v_add_u32 v8, s28, v8
  v_lshlrev_b32 v8, 7, v8
  v_lshrrev_b32 v9, 5, v0
  v_bfe_u32 v10, v0, 1, 3
  v_xor_b32 v9, v9, v10
  v_xor_b32 v11, 0, v9
  v_lshlrev_b32 v11, 4, v11
  v_add_u32 v3, v8, v11
  v_xor_b32 v11, 2, v9
  v_lshlrev_b32 v11, 4, v11
  v_add_u32 v4, v8, v11
  v_xor_b32 v11, 4, v9
  v_lshlrev_b32 v11, 4, v11
  v_add_u32 v5, v8, v11
  v_xor_b32 v11, 6, v9
  v_lshlrev_b32 v11, 4, v11
  v_add_u32 v6, v8, v11
  v_lshrrev_b32 v8, 5, v0
  v_lshlrev_b32 v8, 3, v8
  v_bfe_u32 v9, v0, 2, 2
  v_add_u32 v8, v8, v9
  v_lshlrev_b32 v8, 7, v8
  v_bfe_u32 v9, v0, 4, 1
  v_lshlrev_b32 v9, 1, v9
  v_bfe_u32 v10, v0, 1, 1
  v_add_u32 v9, v9, v10
  s_lshl_b32 s28, s27, 2
  v_add_u32 v9, s28, v9
  v_bfe_u32 v10, v0, 3, 1
  v_lshlrev_b32 v10, 2, v10
  v_xor_b32 v9, v9, v10
  v_lshlrev_b32 v9, 4, v9
  v_add_u32 v8, v8, v9
  v_and_b32 v9, 1, v0
  v_lshlrev_b32 v9, 3, v9
  v_add_u32 v8, v8, v9
  v_add_u32 v7, 16384, v8
  s_cmp_lg_u32 s25, 0
  s_cbranch_scc1 concat_heads__mha_block__spectral_fnet__prompt_kernel_spf_x
  s_lshr_b32 s28, s6, 7
  s_sub_u32 s28, 3, s28
  s_and_b32 s28, s28, 7
  s_lshl_b32 s28, s28, 7
  s_mul_i32 s29, s2, 24
  v_min_u32 v250, 23, v0
  v_add_u32 v250, s29, v250
  v_lshrrev_b32 v251, 1, v250
  v_lshlrev_b32 v251, 11, v251
  v_and_b32 v250, 1, v250
  v_lshlrev_b32 v250, 10, v250
  v_add_u32 v250, v250, v251
  buffer_load_dword v252, v250, s[16:19], s28 offen
concat_heads__mha_block__spectral_fnet__prompt_kernel_spf_x:
  s_cmp_lg_u32 s25, 1
  s_cbranch_scc1 concat_heads__mha_block__spectral_fnet__prompt_kernel_spf_d
  s_lshr_b32 s28, s4, 7
  s_sub_u32 s28, 3, s28
  s_and_b32 s28, s28, 7
  s_lshl_b32 s28, s28, 7
  s_lshl_b32 s29, s2, 4
  v_min_u32 v250, 15, v0
  v_add_u32 v250, s29, v250
  v_lshrrev_b32 v251, 1, v250
  v_lshlrev_b32 v251, 11, v251
  v_and_b32 v250, 1, v250
  v_lshlrev_b32 v250, 10, v250
  v_add_u32 v250, v250, v251
  buffer_load_dword v252, v250, s[12:15], s28 offen
concat_heads__mha_block__spectral_fnet__prompt_kernel_spf_d:
  s_barrier
  ds_read_b128 v[16:19], v3 offset:0
  ds_read_b128 v[20:23], v3 offset:4096
  ds_read_b64_tr_b16 v[24:25], v7 offset:0
  ds_read_b64_tr_b16 v[26:27], v7 offset:512
  ds_read_b64_tr_b16 v[28:29], v7 offset:8192
  ds_read_b64_tr_b16 v[30:31], v7 offset:8704
  ds_read_b64_tr_b16 v[32:33], v7 offset:16384
  ds_read_b64_tr_b16 v[34:35], v7 offset:16896
  v_lshlrev_b32 v250, 7, v0
  s_lshl_b32 s28, s2, 14
  s_and_b32 s29, s25, 1
  s_lshl_b32 s29, s29, 13
  s_add_u32 s28, s28, s29
  s_mul_i32 s30, s2, 24576
  s_add_u32 s31, s30, s29
  s_add_u32 s30, s30, 16384
  s_cmp_ge_u32 s25, 2
  s_cbranch_scc1 concat_heads__mha_block__spectral_fnet__prompt_kernel_pf_w
  buffer_load_dword v251, v250, s[12:15], s28 offen
  buffer_load_dword v252, v250, s[16:19], s30 offen
  s_branch concat_heads__mha_block__spectral_fnet__prompt_kernel_pf_done
concat_heads__mha_block__spectral_fnet__prompt_kernel_pf_w:
  buffer_load_dword v251, v250, s[16:19], s31 offen
  buffer_load_dword v252, v250, s[16:19], s31 offen
concat_heads__mha_block__spectral_fnet__prompt_kernel_pf_done:
  s_waitcnt lgkmcnt(0)
  v_mfma_f32_32x32x16_bf16 v[64:79], v[24:27], v[16:19], 0
  ds_read_b128 v[36:39], v4 offset:0
  ds_read_b128 v[40:43], v4 offset:4096
  v_mfma_f32_32x32x16_bf16 v[112:127], v[24:27], v[20:23], 0
  ds_read_b64_tr_b16 v[44:45], v7 offset:2048
  ds_read_b64_tr_b16 v[46:47], v7 offset:2560
  v_mfma_f32_32x32x16_bf16 v[80:95], v[28:31], v[16:19], 0
  ds_read_b64_tr_b16 v[48:49], v7 offset:10240
  ds_read_b64_tr_b16 v[50:51], v7 offset:10752
  v_mfma_f32_32x32x16_bf16 v[128:143], v[28:31], v[20:23], 0
  ds_read_b64_tr_b16 v[52:53], v7 offset:18432
  ds_read_b64_tr_b16 v[54:55], v7 offset:18944
  v_mfma_f32_32x32x16_bf16 v[96:111], v[16:19], v[32:35], 0
  v_mfma_f32_32x32x16_bf16 v[144:159], v[20:23], v[32:35], 0
  s_waitcnt lgkmcnt(0)
  v_mfma_f32_32x32x16_bf16 v[64:79], v[44:47], v[36:39], v[64:79]
  ds_read_b128 v[16:19], v5 offset:0
  ds_read_b128 v[20:23], v5 offset:4096
  v_mfma_f32_32x32x16_bf16 v[112:127], v[44:47], v[40:43], v[112:127]
  ds_read_b64_tr_b16 v[24:25], v7 offset:4096
  ds_read_b64_tr_b16 v[26:27], v7 offset:4608
  v_mfma_f32_32x32x16_bf16 v[80:95], v[48:51], v[36:39], v[80:95]
  ds_read_b64_tr_b16 v[28:29], v7 offset:12288
  ds_read_b64_tr_b16 v[30:31], v7 offset:12800
  v_mfma_f32_32x32x16_bf16 v[128:143], v[48:51], v[40:43], v[128:143]
  ds_read_b64_tr_b16 v[32:33], v7 offset:20480
  ds_read_b64_tr_b16 v[34:35], v7 offset:20992
  v_mfma_f32_32x32x16_bf16 v[96:111], v[36:39], v[52:55], v[96:111]
  v_mfma_f32_32x32x16_bf16 v[144:159], v[40:43], v[52:55], v[144:159]
  s_waitcnt lgkmcnt(0)
  v_mfma_f32_32x32x16_bf16 v[64:79], v[24:27], v[16:19], v[64:79]
  ds_read_b128 v[36:39], v6 offset:0
  ds_read_b128 v[40:43], v6 offset:4096
  v_mfma_f32_32x32x16_bf16 v[112:127], v[24:27], v[20:23], v[112:127]
  ds_read_b64_tr_b16 v[44:45], v7 offset:6144
  ds_read_b64_tr_b16 v[46:47], v7 offset:6656
  v_mfma_f32_32x32x16_bf16 v[80:95], v[28:31], v[16:19], v[80:95]
  ds_read_b64_tr_b16 v[48:49], v7 offset:14336
  ds_read_b64_tr_b16 v[50:51], v7 offset:14848
  v_mfma_f32_32x32x16_bf16 v[128:143], v[28:31], v[20:23], v[128:143]
  ds_read_b64_tr_b16 v[52:53], v7 offset:22528
  ds_read_b64_tr_b16 v[54:55], v7 offset:23040
  v_mfma_f32_32x32x16_bf16 v[96:111], v[16:19], v[32:35], v[96:111]
  v_mfma_f32_32x32x16_bf16 v[144:159], v[20:23], v[32:35], v[144:159]
  s_waitcnt lgkmcnt(0)
  s_barrier
  v_add_u32 v3, 0xa000, v3
  v_add_u32 v4, 0xa000, v4
  v_add_u32 v5, 0xa000, v5
  v_add_u32 v6, 0xa000, v6
  v_add_u32 v7, 0xa000, v7
  v_mfma_f32_32x32x16_bf16 v[64:79], v[44:47], v[36:39], v[64:79]
  ds_read_b128 v[16:19], v3 offset:0
  ds_read_b128 v[20:23], v3 offset:4096
  v_mfma_f32_32x32x16_bf16 v[112:127], v[44:47], v[40:43], v[112:127]
  ds_read_b64_tr_b16 v[24:25], v7 offset:0
  ds_read_b64_tr_b16 v[26:27], v7 offset:512
  v_mfma_f32_32x32x16_bf16 v[80:95], v[48:51], v[36:39], v[80:95]
  ds_read_b64_tr_b16 v[28:29], v7 offset:8192
  ds_read_b64_tr_b16 v[30:31], v7 offset:8704
  v_mfma_f32_32x32x16_bf16 v[128:143], v[48:51], v[40:43], v[128:143]
  ds_read_b64_tr_b16 v[32:33], v7 offset:16384
  ds_read_b64_tr_b16 v[34:35], v7 offset:16896
  v_mfma_f32_32x32x16_bf16 v[96:111], v[36:39], v[52:55], v[96:111]
  v_mfma_f32_32x32x16_bf16 v[144:159], v[40:43], v[52:55], v[144:159]
  s_mul_i32 s89, s89, 0x9E3779B1
  s_add_u32 s89, s89, 0x7F4A7C15
  s_waitcnt lgkmcnt(0)
  v_mfma_f32_32x32x16_bf16 v[64:79], v[24:27], v[16:19], v[64:79]
  ds_read_b128 v[36:39], v4 offset:0
  ds_read_b128 v[40:43], v4 offset:4096
  v_and_b32 v240, 31, v0
  v_mfma_f32_32x32x16_bf16 v[112:127], v[24:27], v[20:23], v[112:127]
  ds_read_b64_tr_b16 v[44:45], v7 offset:2048
  ds_read_b64_tr_b16 v[46:47], v7 offset:2560
  v_cvt_f32_u32 v240, v240
  v_mfma_f32_32x32x16_bf16 v[80:95], v[28:31], v[16:19], v[80:95]
  ds_read_b64_tr_b16 v[48:49], v7 offset:10240
  ds_read_b64_tr_b16 v[50:51], v7 offset:10752
  v_mul_f32 v242, 0xba800000, v240
  v_mfma_f32_32x32x16_bf16 v[128:143], v[28:31], v[20:23], v[128:143]
  ds_read_b64_tr_b16 v[52:53], v7 offset:18432
  ds_read_b64_tr_b16 v[54:55], v7 offset:18944
  v_mul_f32 v240, 0xbd000000, v240
  v_mfma_f32_32x32x16_bf16 v[96:111], v[16:19], v[32:35], v[96:111]
  v_lshrrev_b32 v241, 5, v0
  v_mfma_f32_32x32x16_bf16 v[144:159], v[20:23], v[32:35], v[144:159]
  v_lshlrev_b32 v241, 2, v241
  s_waitcnt lgkmcnt(0)
  v_mfma_f32_32x32x16_bf16 v[64:79], v[44:47], v[36:39], v[64:79]
  ds_read_b128 v[16:19], v5 offset:0
  ds_read_b128 v[20:23], v5 offset:4096
  v_cvt_f32_u32 v241, v241
  v_mfma_f32_32x32x16_bf16 v[112:127], v[44:47], v[40:43], v[112:127]
  ds_read_b64_tr_b16 v[24:25], v7 offset:4096
  ds_read_b64_tr_b16 v[26:27], v7 offset:4608
  v_add_f32 v224, 0x0, v241
  v_mfma_f32_32x32x16_bf16 v[80:95], v[48:51], v[36:39], v[80:95]
  ds_read_b64_tr_b16 v[28:29], v7 offset:12288
  ds_read_b64_tr_b16 v[30:31], v7 offset:12800
  v_add_f32 v225, 0x3f800000, v241
  v_mfma_f32_32x32x16_bf16 v[128:143], v[48:51], v[40:43], v[128:143]
  ds_read_b64_tr_b16 v[32:33], v7 offset:20480
  ds_read_b64_tr_b16 v[34:35], v7 offset:20992
  v_add_f32 v226, 0x40000000, v241
  v_mfma_f32_32x32x16_bf16 v[96:111], v[36:39], v[52:55], v[96:111]
  v_add_f32 v227, 0x40400000, v241
  v_mfma_f32_32x32x16_bf16 v[144:159], v[40:43], v[52:55], v[144:159]
  v_add_f32 v228, 0x41000000, v241
  s_waitcnt lgkmcnt(0)
  v_mfma_f32_32x32x16_bf16 v[64:79], v[24:27], v[16:19], v[64:79]
  ds_read_b128 v[36:39], v6 offset:0
  ds_read_b128 v[40:43], v6 offset:4096
  v_add_f32 v229, 0x41100000, v241
  v_mfma_f32_32x32x16_bf16 v[112:127], v[24:27], v[20:23], v[112:127]
  ds_read_b64_tr_b16 v[44:45], v7 offset:6144
  ds_read_b64_tr_b16 v[46:47], v7 offset:6656
  v_add_f32 v230, 0x41200000, v241
  v_mfma_f32_32x32x16_bf16 v[80:95], v[28:31], v[16:19], v[80:95]
  ds_read_b64_tr_b16 v[48:49], v7 offset:14336
  ds_read_b64_tr_b16 v[50:51], v7 offset:14848
  v_add_f32 v231, 0x41300000, v241
  v_mfma_f32_32x32x16_bf16 v[128:143], v[28:31], v[20:23], v[128:143]
  ds_read_b64_tr_b16 v[52:53], v7 offset:22528
  ds_read_b64_tr_b16 v[54:55], v7 offset:23040
  v_mul_f32 v224, v224, v240
  v_mfma_f32_32x32x16_bf16 v[96:111], v[16:19], v[32:35], v[96:111]
  v_mul_f32 v225, v225, v240
  v_mfma_f32_32x32x16_bf16 v[144:159], v[20:23], v[32:35], v[144:159]
  v_mul_f32 v226, v226, v240
  s_waitcnt lgkmcnt(0)
  s_barrier
  v_add_u32 v3, 0xa000, v3
  v_add_u32 v4, 0xa000, v4
  v_add_u32 v5, 0xa000, v5
  v_add_u32 v6, 0xa000, v6
  v_add_u32 v7, 0xa000, v7
  v_mfma_f32_32x32x16_bf16 v[64:79], v[44:47], v[36:39], v[64:79]
  ds_read_b128 v[16:19], v3 offset:0
  ds_read_b128 v[20:23], v3 offset:4096
  v_mul_f32 v227, v227, v240
  v_mfma_f32_32x32x16_bf16 v[112:127], v[44:47], v[40:43], v[112:127]
  ds_read_b64_tr_b16 v[24:25], v7 offset:0
  ds_read_b64_tr_b16 v[26:27], v7 offset:512
  v_mul_f32 v228, v228, v240
  v_mfma_f32_32x32x16_bf16 v[80:95], v[48:51], v[36:39], v[80:95]
  ds_read_b64_tr_b16 v[28:29], v7 offset:8192
  ds_read_b64_tr_b16 v[30:31], v7 offset:8704
  v_mul_f32 v229, v229, v240
  v_mfma_f32_32x32x16_bf16 v[128:143], v[48:51], v[40:43], v[128:143]
  ds_read_b64_tr_b16 v[32:33], v7 offset:16384
  ds_read_b64_tr_b16 v[34:35], v7 offset:16896
  v_mul_f32 v230, v230, v240
  v_mfma_f32_32x32x16_bf16 v[96:111], v[36:39], v[52:55], v[96:111]
  v_mul_f32 v231, v231, v240
  v_mfma_f32_32x32x16_bf16 v[144:159], v[40:43], v[52:55], v[144:159]
  v_fract_f32 v224, v224
  s_waitcnt lgkmcnt(0)
  v_mfma_f32_32x32x16_bf16 v[64:79], v[24:27], v[16:19], v[64:79]
  ds_read_b128 v[36:39], v4 offset:0
  ds_read_b128 v[40:43], v4 offset:4096
  v_fract_f32 v225, v225
  v_mfma_f32_32x32x16_bf16 v[112:127], v[24:27], v[20:23], v[112:127]
  ds_read_b64_tr_b16 v[44:45], v7 offset:2048
  ds_read_b64_tr_b16 v[46:47], v7 offset:2560
  v_fract_f32 v226, v226
  v_mfma_f32_32x32x16_bf16 v[80:95], v[28:31], v[16:19], v[80:95]
  ds_read_b64_tr_b16 v[48:49], v7 offset:10240
  ds_read_b64_tr_b16 v[50:51], v7 offset:10752
  v_fract_f32 v227, v227
  v_mfma_f32_32x32x16_bf16 v[128:143], v[28:31], v[20:23], v[128:143]
  ds_read_b64_tr_b16 v[52:53], v7 offset:18432
  ds_read_b64_tr_b16 v[54:55], v7 offset:18944
  v_fract_f32 v228, v228
  v_mfma_f32_32x32x16_bf16 v[96:111], v[16:19], v[32:35], v[96:111]
  v_fract_f32 v229, v229
  v_mfma_f32_32x32x16_bf16 v[144:159], v[20:23], v[32:35], v[144:159]
  v_fract_f32 v230, v230
  s_waitcnt lgkmcnt(0)
  v_mfma_f32_32x32x16_bf16 v[64:79], v[44:47], v[36:39], v[64:79]
  ds_read_b128 v[16:19], v5 offset:0
  ds_read_b128 v[20:23], v5 offset:4096
  v_fract_f32 v231, v231
  v_mfma_f32_32x32x16_bf16 v[112:127], v[44:47], v[40:43], v[112:127]
  ds_read_b64_tr_b16 v[24:25], v7 offset:4096
  ds_read_b64_tr_b16 v[26:27], v7 offset:4608
  v_sin_f32 v232, v224
  v_mfma_f32_32x32x16_bf16 v[80:95], v[48:51], v[36:39], v[80:95]
  ds_read_b64_tr_b16 v[28:29], v7 offset:12288
  ds_read_b64_tr_b16 v[30:31], v7 offset:12800
  v_sin_f32 v233, v225
  v_mfma_f32_32x32x16_bf16 v[128:143], v[48:51], v[40:43], v[128:143]
  ds_read_b64_tr_b16 v[32:33], v7 offset:20480
  ds_read_b64_tr_b16 v[34:35], v7 offset:20992
  v_sin_f32 v234, v226
  v_mfma_f32_32x32x16_bf16 v[96:111], v[36:39], v[52:55], v[96:111]
  v_sin_f32 v235, v227
  v_mfma_f32_32x32x16_bf16 v[144:159], v[40:43], v[52:55], v[144:159]
  v_sin_f32 v236, v228
  s_waitcnt lgkmcnt(0)
  v_mfma_f32_32x32x16_bf16 v[64:79], v[24:27], v[16:19], v[64:79]
  ds_read_b128 v[36:39], v6 offset:0
  ds_read_b128 v[40:43], v6 offset:4096
  v_sin_f32 v237, v229
  v_mfma_f32_32x32x16_bf16 v[112:127], v[24:27], v[20:23], v[112:127]
  ds_read_b64_tr_b16 v[44:45], v7 offset:6144
  ds_read_b64_tr_b16 v[46:47], v7 offset:6656
  v_sin_f32 v238, v230
  v_mfma_f32_32x32x16_bf16 v[80:95], v[28:31], v[16:19], v[80:95]
  ds_read_b64_tr_b16 v[48:49], v7 offset:14336
  ds_read_b64_tr_b16 v[50:51], v7 offset:14848
  v_sin_f32 v239, v231
  v_mfma_f32_32x32x16_bf16 v[128:143], v[28:31], v[20:23], v[128:143]
  ds_read_b64_tr_b16 v[52:53], v7 offset:22528
  ds_read_b64_tr_b16 v[54:55], v7 offset:23040
  v_cos_f32 v224, v224
  v_mfma_f32_32x32x16_bf16 v[96:111], v[16:19], v[32:35], v[96:111]
  v_cos_f32 v225, v225
  v_mfma_f32_32x32x16_bf16 v[144:159], v[20:23], v[32:35], v[144:159]
  v_cos_f32 v226, v226
  s_waitcnt lgkmcnt(0)
  s_barrier
  v_add_u32 v3, 0xa000, v3
  v_add_u32 v4, 0xa000, v4
  v_add_u32 v5, 0xa000, v5
  v_add_u32 v6, 0xa000, v6
  v_add_u32 v7, 0xa000, v7
  v_mfma_f32_32x32x16_bf16 v[64:79], v[44:47], v[36:39], v[64:79]
  ds_read_b128 v[16:19], v3 offset:0
  ds_read_b128 v[20:23], v3 offset:4096
  v_cos_f32 v227, v227
  v_mfma_f32_32x32x16_bf16 v[112:127], v[44:47], v[40:43], v[112:127]
  ds_read_b64_tr_b16 v[24:25], v7 offset:0
  ds_read_b64_tr_b16 v[26:27], v7 offset:512
  v_cos_f32 v228, v228
  v_mfma_f32_32x32x16_bf16 v[80:95], v[48:51], v[36:39], v[80:95]
  ds_read_b64_tr_b16 v[28:29], v7 offset:8192
  ds_read_b64_tr_b16 v[30:31], v7 offset:8704
  v_cos_f32 v229, v229
  v_mfma_f32_32x32x16_bf16 v[128:143], v[48:51], v[40:43], v[128:143]
  ds_read_b64_tr_b16 v[32:33], v7 offset:16384
  ds_read_b64_tr_b16 v[34:35], v7 offset:16896
  v_cos_f32 v230, v230
  v_mfma_f32_32x32x16_bf16 v[96:111], v[36:39], v[52:55], v[96:111]
  v_cos_f32 v231, v231
  v_mfma_f32_32x32x16_bf16 v[144:159], v[40:43], v[52:55], v[144:159]
  v_cvt_pk_bf16_f32 v168, v232, v233
  v_lshrrev_b32 v254, 4, v0
  s_and_b32 s28, s25, 1
  s_lshl_b32 s28, s28, 2
  s_lshl_b32 s29, s81, 3
  s_add_u32 s28, s28, s29
  v_add_u32 v254, s28, v254
  v_lshlrev_b32 v254, 17, v254
  v_and_b32 v255, 15, v0
  v_lshlrev_b32 v255, 7, v255
  v_add_u32 v254, v254, v255
  s_lshl_b32 s28, s80, 11
  buffer_load_dword v255, v254, s[72:75], s28 offen
  s_waitcnt lgkmcnt(0)
  v_mfma_f32_32x32x16_bf16 v[64:79], v[24:27], v[16:19], v[64:79]
  ds_read_b128 v[36:39], v4 offset:0
  ds_read_b128 v[40:43], v4 offset:4096
  v_cvt_pk_bf16_f32 v169, v234, v235
  v_mfma_f32_32x32x16_bf16 v[112:127], v[24:27], v[20:23], v[112:127]
  ds_read_b64_tr_b16 v[44:45], v7 offset:2048
  ds_read_b64_tr_b16 v[46:47], v7 offset:2560
  v_cvt_pk_bf16_f32 v170, v236, v237
  v_mfma_f32_32x32x16_bf16 v[80:95], v[28:31], v[16:19], v[80:95]
  ds_read_b64_tr_b16 v[48:49], v7 offset:10240
  ds_read_b64_tr_b16 v[50:51], v7 offset:10752
  v_cvt_pk_bf16_f32 v171, v238, v239
  v_mfma_f32_32x32x16_bf16 v[128:143], v[28:31], v[20:23], v[128:143]
  ds_read_b64_tr_b16 v[52:53], v7 offset:18432
  ds_read_b64_tr_b16 v[54:55], v7 offset:18944
  v_cvt_pk_bf16_f32 v160, v224, v225
  v_mfma_f32_32x32x16_bf16 v[96:111], v[16:19], v[32:35], v[96:111]
  v_cvt_pk_bf16_f32 v161, v226, v227
  v_mfma_f32_32x32x16_bf16 v[144:159], v[20:23], v[32:35], v[144:159]
  v_cvt_pk_bf16_f32 v162, v228, v229
  s_waitcnt lgkmcnt(0)
  v_mfma_f32_32x32x16_bf16 v[64:79], v[44:47], v[36:39], v[64:79]
  ds_read_b128 v[16:19], v5 offset:0
  ds_read_b128 v[20:23], v5 offset:4096
  v_cvt_pk_bf16_f32 v163, v230, v231
  v_mfma_f32_32x32x16_bf16 v[112:127], v[44:47], v[40:43], v[112:127]
  ds_read_b64_tr_b16 v[24:25], v7 offset:4096
  ds_read_b64_tr_b16 v[26:27], v7 offset:4608
  v_add_f32 v224, 0x41800000, v241
  v_mfma_f32_32x32x16_bf16 v[80:95], v[48:51], v[36:39], v[80:95]
  ds_read_b64_tr_b16 v[28:29], v7 offset:12288
  ds_read_b64_tr_b16 v[30:31], v7 offset:12800
  v_add_f32 v225, 0x41880000, v241
  v_mfma_f32_32x32x16_bf16 v[128:143], v[48:51], v[40:43], v[128:143]
  ds_read_b64_tr_b16 v[32:33], v7 offset:20480
  ds_read_b64_tr_b16 v[34:35], v7 offset:20992
  v_add_f32 v226, 0x41900000, v241
  v_mfma_f32_32x32x16_bf16 v[96:111], v[36:39], v[52:55], v[96:111]
  v_add_f32 v227, 0x41980000, v241
  v_mfma_f32_32x32x16_bf16 v[144:159], v[40:43], v[52:55], v[144:159]
  v_add_f32 v228, 0x41c00000, v241
  s_waitcnt lgkmcnt(0)
  v_mfma_f32_32x32x16_bf16 v[64:79], v[24:27], v[16:19], v[64:79]
  ds_read_b128 v[36:39], v6 offset:0
  ds_read_b128 v[40:43], v6 offset:4096
  v_add_f32 v229, 0x41c80000, v241
  v_mfma_f32_32x32x16_bf16 v[112:127], v[24:27], v[20:23], v[112:127]
  ds_read_b64_tr_b16 v[44:45], v7 offset:6144
  ds_read_b64_tr_b16 v[46:47], v7 offset:6656
  v_add_f32 v230, 0x41d00000, v241
  v_mfma_f32_32x32x16_bf16 v[80:95], v[28:31], v[16:19], v[80:95]
  ds_read_b64_tr_b16 v[48:49], v7 offset:14336
  ds_read_b64_tr_b16 v[50:51], v7 offset:14848
  v_add_f32 v231, 0x41d80000, v241
  v_mfma_f32_32x32x16_bf16 v[128:143], v[28:31], v[20:23], v[128:143]
  ds_read_b64_tr_b16 v[52:53], v7 offset:22528
  ds_read_b64_tr_b16 v[54:55], v7 offset:23040
  v_mul_f32 v224, v224, v240
  v_mfma_f32_32x32x16_bf16 v[96:111], v[16:19], v[32:35], v[96:111]
  v_mul_f32 v225, v225, v240
  v_mfma_f32_32x32x16_bf16 v[144:159], v[20:23], v[32:35], v[144:159]
  v_mul_f32 v226, v226, v240
  s_waitcnt lgkmcnt(0)
  s_barrier
  v_add_u32 v3, 0xfffe2000, v3
  v_add_u32 v4, 0xfffe2000, v4
  v_add_u32 v5, 0xfffe2000, v5
  v_add_u32 v6, 0xfffe2000, v6
  v_add_u32 v7, 0xfffe2000, v7
  v_mfma_f32_32x32x16_bf16 v[64:79], v[44:47], v[36:39], v[64:79]
  ds_read_b128 v[16:19], v3 offset:0
  ds_read_b128 v[20:23], v3 offset:4096
  v_mul_f32 v227, v227, v240
  v_mfma_f32_32x32x16_bf16 v[112:127], v[44:47], v[40:43], v[112:127]
  ds_read_b64_tr_b16 v[24:25], v7 offset:0
  ds_read_b64_tr_b16 v[26:27], v7 offset:512
  v_mul_f32 v228, v228, v240
  v_mfma_f32_32x32x16_bf16 v[80:95], v[48:51], v[36:39], v[80:95]
  ds_read_b64_tr_b16 v[28:29], v7 offset:8192
  ds_read_b64_tr_b16 v[30:31], v7 offset:8704
  v_mul_f32 v229, v229, v240
  v_mfma_f32_32x32x16_bf16 v[128:143], v[48:51], v[40:43], v[128:143]
  ds_read_b64_tr_b16 v[32:33], v7 offset:16384
  ds_read_b64_tr_b16 v[34:35], v7 offset:16896
  v_mul_f32 v230, v230, v240
  v_mfma_f32_32x32x16_bf16 v[96:111], v[36:39], v[52:55], v[96:111]
  v_mul_f32 v231, v231, v240
  v_mfma_f32_32x32x16_bf16 v[144:159], v[40:43], v[52:55], v[144:159]
  v_fract_f32 v224, v224
  s_waitcnt lgkmcnt(0)
  v_mfma_f32_32x32x16_bf16 v[64:79], v[24:27], v[16:19], v[64:79]
  ds_read_b128 v[36:39], v4 offset:0
  ds_read_b128 v[40:43], v4 offset:4096
  v_fract_f32 v225, v225
  v_mfma_f32_32x32x16_bf16 v[112:127], v[24:27], v[20:23], v[112:127]
  ds_read_b64_tr_b16 v[44:45], v7 offset:2048
  ds_read_b64_tr_b16 v[46:47], v7 offset:2560
  v_fract_f32 v226, v226
  v_mfma_f32_32x32x16_bf16 v[80:95], v[28:31], v[16:19], v[80:95]
  ds_read_b64_tr_b16 v[48:49], v7 offset:10240
  ds_read_b64_tr_b16 v[50:51], v7 offset:10752
  v_fract_f32 v227, v227
  v_mfma_f32_32x32x16_bf16 v[128:143], v[28:31], v[20:23], v[128:143]
  ds_read_b64_tr_b16 v[52:53], v7 offset:18432
  ds_read_b64_tr_b16 v[54:55], v7 offset:18944
  v_fract_f32 v228, v228
  v_mfma_f32_32x32x16_bf16 v[96:111], v[16:19], v[32:35], v[96:111]
  v_fract_f32 v229, v229
  v_mfma_f32_32x32x16_bf16 v[144:159], v[20:23], v[32:35], v[144:159]
  v_fract_f32 v230, v230
  s_waitcnt lgkmcnt(0)
  v_mfma_f32_32x32x16_bf16 v[64:79], v[44:47], v[36:39], v[64:79]
  ds_read_b128 v[16:19], v5 offset:0
  ds_read_b128 v[20:23], v5 offset:4096
  v_fract_f32 v231, v231
  v_mfma_f32_32x32x16_bf16 v[112:127], v[44:47], v[40:43], v[112:127]
  ds_read_b64_tr_b16 v[24:25], v7 offset:4096
  ds_read_b64_tr_b16 v[26:27], v7 offset:4608
  v_sin_f32 v232, v224
  v_mfma_f32_32x32x16_bf16 v[80:95], v[48:51], v[36:39], v[80:95]
  ds_read_b64_tr_b16 v[28:29], v7 offset:12288
  ds_read_b64_tr_b16 v[30:31], v7 offset:12800
  v_sin_f32 v233, v225
  v_mfma_f32_32x32x16_bf16 v[128:143], v[48:51], v[40:43], v[128:143]
  ds_read_b64_tr_b16 v[32:33], v7 offset:20480
  ds_read_b64_tr_b16 v[34:35], v7 offset:20992
  v_sin_f32 v234, v226
  v_mfma_f32_32x32x16_bf16 v[96:111], v[36:39], v[52:55], v[96:111]
  v_sin_f32 v235, v227
  v_mfma_f32_32x32x16_bf16 v[144:159], v[40:43], v[52:55], v[144:159]
  v_sin_f32 v236, v228
  s_waitcnt lgkmcnt(0)
  v_mfma_f32_32x32x16_bf16 v[64:79], v[24:27], v[16:19], v[64:79]
  ds_read_b128 v[36:39], v6 offset:0
  ds_read_b128 v[40:43], v6 offset:4096
  v_sin_f32 v237, v229
  v_mfma_f32_32x32x16_bf16 v[112:127], v[24:27], v[20:23], v[112:127]
  ds_read_b64_tr_b16 v[44:45], v7 offset:6144
  ds_read_b64_tr_b16 v[46:47], v7 offset:6656
  v_sin_f32 v238, v230
  v_mfma_f32_32x32x16_bf16 v[80:95], v[28:31], v[16:19], v[80:95]
  ds_read_b64_tr_b16 v[48:49], v7 offset:14336
  ds_read_b64_tr_b16 v[50:51], v7 offset:14848
  v_sin_f32 v239, v231
  v_mfma_f32_32x32x16_bf16 v[128:143], v[28:31], v[20:23], v[128:143]
  ds_read_b64_tr_b16 v[52:53], v7 offset:22528
  ds_read_b64_tr_b16 v[54:55], v7 offset:23040
  v_cos_f32 v224, v224
  v_mfma_f32_32x32x16_bf16 v[96:111], v[16:19], v[32:35], v[96:111]
  v_cos_f32 v225, v225
  v_mfma_f32_32x32x16_bf16 v[144:159], v[20:23], v[32:35], v[144:159]
  v_cos_f32 v226, v226
  s_waitcnt lgkmcnt(0)
  s_barrier
  v_add_u32 v3, 0xa000, v3
  v_add_u32 v4, 0xa000, v4
  v_add_u32 v5, 0xa000, v5
  v_add_u32 v6, 0xa000, v6
  v_add_u32 v7, 0xa000, v7
  v_mfma_f32_32x32x16_bf16 v[64:79], v[44:47], v[36:39], v[64:79]
  ds_read_b128 v[16:19], v3 offset:0
  ds_read_b128 v[20:23], v3 offset:4096
  v_cos_f32 v227, v227
  v_mfma_f32_32x32x16_bf16 v[112:127], v[44:47], v[40:43], v[112:127]
  ds_read_b64_tr_b16 v[24:25], v7 offset:0
  ds_read_b64_tr_b16 v[26:27], v7 offset:512
  v_cos_f32 v228, v228
  v_mfma_f32_32x32x16_bf16 v[80:95], v[48:51], v[36:39], v[80:95]
  ds_read_b64_tr_b16 v[28:29], v7 offset:8192
  ds_read_b64_tr_b16 v[30:31], v7 offset:8704
  v_cos_f32 v229, v229
  v_mfma_f32_32x32x16_bf16 v[128:143], v[48:51], v[40:43], v[128:143]
  ds_read_b64_tr_b16 v[32:33], v7 offset:16384
  ds_read_b64_tr_b16 v[34:35], v7 offset:16896
  v_cos_f32 v230, v230
  v_mfma_f32_32x32x16_bf16 v[96:111], v[36:39], v[52:55], v[96:111]
  v_cos_f32 v231, v231
  v_mfma_f32_32x32x16_bf16 v[144:159], v[40:43], v[52:55], v[144:159]
  v_cvt_pk_bf16_f32 v172, v232, v233
  s_waitcnt lgkmcnt(0)
  v_mfma_f32_32x32x16_bf16 v[64:79], v[24:27], v[16:19], v[64:79]
  ds_read_b128 v[36:39], v4 offset:0
  ds_read_b128 v[40:43], v4 offset:4096
  v_cvt_pk_bf16_f32 v173, v234, v235
  v_mfma_f32_32x32x16_bf16 v[112:127], v[24:27], v[20:23], v[112:127]
  ds_read_b64_tr_b16 v[44:45], v7 offset:2048
  ds_read_b64_tr_b16 v[46:47], v7 offset:2560
  v_cvt_pk_bf16_f32 v174, v236, v237
  v_mfma_f32_32x32x16_bf16 v[80:95], v[28:31], v[16:19], v[80:95]
  ds_read_b64_tr_b16 v[48:49], v7 offset:10240
  ds_read_b64_tr_b16 v[50:51], v7 offset:10752
  v_cvt_pk_bf16_f32 v175, v238, v239
  v_mfma_f32_32x32x16_bf16 v[128:143], v[28:31], v[20:23], v[128:143]
  ds_read_b64_tr_b16 v[52:53], v7 offset:18432
  ds_read_b64_tr_b16 v[54:55], v7 offset:18944
  v_cvt_pk_bf16_f32 v164, v224, v225
  v_mfma_f32_32x32x16_bf16 v[96:111], v[16:19], v[32:35], v[96:111]
  v_cvt_pk_bf16_f32 v165, v226, v227
  v_mfma_f32_32x32x16_bf16 v[144:159], v[20:23], v[32:35], v[144:159]
  v_cvt_pk_bf16_f32 v166, v228, v229
  s_waitcnt lgkmcnt(0)
  v_mfma_f32_32x32x16_bf16 v[64:79], v[44:47], v[36:39], v[64:79]
  ds_read_b128 v[16:19], v5 offset:0
  ds_read_b128 v[20:23], v5 offset:4096
  v_cvt_pk_bf16_f32 v167, v230, v231
  v_mfma_f32_32x32x16_bf16 v[112:127], v[44:47], v[40:43], v[112:127]
  ds_read_b64_tr_b16 v[24:25], v7 offset:4096
  ds_read_b64_tr_b16 v[26:27], v7 offset:4608
  v_add_f32 v192, 0x0, v241
  v_mfma_f32_32x32x16_bf16 v[80:95], v[48:51], v[36:39], v[80:95]
  ds_read_b64_tr_b16 v[28:29], v7 offset:12288
  ds_read_b64_tr_b16 v[30:31], v7 offset:12800
  v_add_f32 v193, 0x3f800000, v241
  v_mfma_f32_32x32x16_bf16 v[128:143], v[48:51], v[40:43], v[128:143]
  ds_read_b64_tr_b16 v[32:33], v7 offset:20480
  ds_read_b64_tr_b16 v[34:35], v7 offset:20992
  v_add_f32 v194, 0x40000000, v241
  v_mfma_f32_32x32x16_bf16 v[96:111], v[36:39], v[52:55], v[96:111]
  v_add_f32 v195, 0x40400000, v241
  v_mfma_f32_32x32x16_bf16 v[144:159], v[40:43], v[52:55], v[144:159]
  v_add_f32 v196, 0x41000000, v241
  s_waitcnt lgkmcnt(0)
  v_mfma_f32_32x32x16_bf16 v[64:79], v[24:27], v[16:19], v[64:79]
  ds_read_b128 v[36:39], v6 offset:0
  ds_read_b128 v[40:43], v6 offset:4096
  v_add_f32 v197, 0x41100000, v241
  v_mfma_f32_32x32x16_bf16 v[112:127], v[24:27], v[20:23], v[112:127]
  ds_read_b64_tr_b16 v[44:45], v7 offset:6144
  ds_read_b64_tr_b16 v[46:47], v7 offset:6656
  v_add_f32 v198, 0x41200000, v241
  v_mfma_f32_32x32x16_bf16 v[80:95], v[28:31], v[16:19], v[80:95]
  ds_read_b64_tr_b16 v[48:49], v7 offset:14336
  ds_read_b64_tr_b16 v[50:51], v7 offset:14848
  v_add_f32 v199, 0x41300000, v241
  v_mfma_f32_32x32x16_bf16 v[128:143], v[28:31], v[20:23], v[128:143]
  ds_read_b64_tr_b16 v[52:53], v7 offset:22528
  ds_read_b64_tr_b16 v[54:55], v7 offset:23040
  v_add_f32 v200, 0x41800000, v241
  v_mfma_f32_32x32x16_bf16 v[96:111], v[16:19], v[32:35], v[96:111]
  v_add_f32 v201, 0x41880000, v241
  v_mfma_f32_32x32x16_bf16 v[144:159], v[20:23], v[32:35], v[144:159]
  v_add_f32 v202, 0x41900000, v241
  s_waitcnt lgkmcnt(0)
  s_barrier
  v_add_u32 v3, 0xa000, v3
  v_add_u32 v4, 0xa000, v4
  v_add_u32 v5, 0xa000, v5
  v_add_u32 v6, 0xa000, v6
  v_add_u32 v7, 0xa000, v7
  v_mfma_f32_32x32x16_bf16 v[64:79], v[44:47], v[36:39], v[64:79]
  ds_read_b128 v[16:19], v3 offset:0
  ds_read_b128 v[20:23], v3 offset:4096
  v_add_f32 v203, 0x41980000, v241
  v_mfma_f32_32x32x16_bf16 v[112:127], v[44:47], v[40:43], v[112:127]
  ds_read_b64_tr_b16 v[24:25], v7 offset:0
  ds_read_b64_tr_b16 v[26:27], v7 offset:512
  v_add_f32 v204, 0x41c00000, v241
  v_mfma_f32_32x32x16_bf16 v[80:95], v[48:51], v[36:39], v[80:95]
  ds_read_b64_tr_b16 v[28:29], v7 offset:8192
  ds_read_b64_tr_b16 v[30:31], v7 offset:8704
  v_add_f32 v205, 0x41c80000, v241
  v_mfma_f32_32x32x16_bf16 v[128:143], v[48:51], v[40:43], v[128:143]
  ds_read_b64_tr_b16 v[32:33], v7 offset:16384
  ds_read_b64_tr_b16 v[34:35], v7 offset:16896
  v_add_f32 v206, 0x41d00000, v241
  v_mfma_f32_32x32x16_bf16 v[96:111], v[36:39], v[52:55], v[96:111]
  v_add_f32 v207, 0x41d80000, v241
  v_mfma_f32_32x32x16_bf16 v[144:159], v[40:43], v[52:55], v[144:159]
  v_mul_f32 v192, v192, v242
  v_lshlrev_b32 v250, 7, v0
  s_cmp_eq_u32 s25, 0
  s_cbranch_scc0 concat_heads__mha_block__spectral_fnet__prompt_kernel_w2a
  s_mov_b32 s44, s48
  s_mov_b32 s45, s49
  s_mov_b32 s46, 0x200000
  s_mov_b32 s47, 0x00020000
  s_lshl_b32 s28, s2, 13
  buffer_load_dword v251, v250, s[44:47], s28 offen
concat_heads__mha_block__spectral_fnet__prompt_kernel_w2a:
  s_cmp_eq_u32 s25, 1
  s_cbranch_scc0 concat_heads__mha_block__spectral_fnet__prompt_kernel_w2b
  v_and_b32 v250, 7, v0
  v_lshlrev_b32 v250, 12, v250
  s_lshl_b32 s28, s2, 15
  s_mov_b32 s44, s40
  s_mov_b32 s45, s41
  s_mov_b32 s46, 0x800000
  s_mov_b32 s47, 0x00020000
  buffer_load_dword v251, v250, s[44:47], s28 offen
  s_mov_b32 s44, s42
  s_mov_b32 s45, s43
  s_mov_b32 s46, 0x800000
  s_mov_b32 s47, 0x00020000
  buffer_load_dword v252, v250, s[44:47], s28 offen
concat_heads__mha_block__spectral_fnet__prompt_kernel_w2b:
  s_waitcnt lgkmcnt(0)
  v_mfma_f32_32x32x16_bf16 v[64:79], v[24:27], v[16:19], v[64:79]
  ds_read_b128 v[36:39], v4 offset:0
  ds_read_b128 v[40:43], v4 offset:4096
  v_mul_f32 v193, v193, v242
  v_mfma_f32_32x32x16_bf16 v[112:127], v[24:27], v[20:23], v[112:127]
  ds_read_b64_tr_b16 v[44:45], v7 offset:2048
  ds_read_b64_tr_b16 v[46:47], v7 offset:2560
  v_mul_f32 v194, v194, v242
  v_mfma_f32_32x32x16_bf16 v[80:95], v[28:31], v[16:19], v[80:95]
  ds_read_b64_tr_b16 v[48:49], v7 offset:10240
  ds_read_b64_tr_b16 v[50:51], v7 offset:10752
  v_mul_f32 v195, v195, v242
  v_mfma_f32_32x32x16_bf16 v[128:143], v[28:31], v[20:23], v[128:143]
  ds_read_b64_tr_b16 v[52:53], v7 offset:18432
  ds_read_b64_tr_b16 v[54:55], v7 offset:18944
  v_mul_f32 v196, v196, v242
  v_mfma_f32_32x32x16_bf16 v[96:111], v[16:19], v[32:35], v[96:111]
  v_mul_f32 v197, v197, v242
  v_mfma_f32_32x32x16_bf16 v[144:159], v[20:23], v[32:35], v[144:159]
  v_mul_f32 v198, v198, v242
  s_waitcnt lgkmcnt(0)
  v_mfma_f32_32x32x16_bf16 v[64:79], v[44:47], v[36:39], v[64:79]
  ds_read_b128 v[16:19], v5 offset:0
  ds_read_b128 v[20:23], v5 offset:4096
  v_mul_f32 v199, v199, v242
  v_mfma_f32_32x32x16_bf16 v[112:127], v[44:47], v[40:43], v[112:127]
  ds_read_b64_tr_b16 v[24:25], v7 offset:4096
  ds_read_b64_tr_b16 v[26:27], v7 offset:4608
  v_mul_f32 v200, v200, v242
  v_mfma_f32_32x32x16_bf16 v[80:95], v[48:51], v[36:39], v[80:95]
  ds_read_b64_tr_b16 v[28:29], v7 offset:12288
  ds_read_b64_tr_b16 v[30:31], v7 offset:12800
  v_mul_f32 v201, v201, v242
  v_mfma_f32_32x32x16_bf16 v[128:143], v[48:51], v[40:43], v[128:143]
  ds_read_b64_tr_b16 v[32:33], v7 offset:20480
  ds_read_b64_tr_b16 v[34:35], v7 offset:20992
  v_mul_f32 v202, v202, v242
  v_mfma_f32_32x32x16_bf16 v[96:111], v[36:39], v[52:55], v[96:111]
  v_mul_f32 v203, v203, v242
  v_mfma_f32_32x32x16_bf16 v[144:159], v[40:43], v[52:55], v[144:159]
  v_mul_f32 v204, v204, v242
  s_waitcnt lgkmcnt(0)
  v_mfma_f32_32x32x16_bf16 v[64:79], v[24:27], v[16:19], v[64:79]
  ds_read_b128 v[36:39], v6 offset:0
  ds_read_b128 v[40:43], v6 offset:4096
  v_mul_f32 v205, v205, v242
  v_mfma_f32_32x32x16_bf16 v[112:127], v[24:27], v[20:23], v[112:127]
  ds_read_b64_tr_b16 v[44:45], v7 offset:6144
  ds_read_b64_tr_b16 v[46:47], v7 offset:6656
  v_mul_f32 v206, v206, v242
  v_mfma_f32_32x32x16_bf16 v[80:95], v[28:31], v[16:19], v[80:95]
  ds_read_b64_tr_b16 v[48:49], v7 offset:14336
  ds_read_b64_tr_b16 v[50:51], v7 offset:14848
  v_mul_f32 v207, v207, v242
  v_mfma_f32_32x32x16_bf16 v[128:143], v[28:31], v[20:23], v[128:143]
  ds_read_b64_tr_b16 v[52:53], v7 offset:22528
  ds_read_b64_tr_b16 v[54:55], v7 offset:23040
  v_sin_f32 v208, v192
  v_mfma_f32_32x32x16_bf16 v[96:111], v[16:19], v[32:35], v[96:111]
  v_sin_f32 v209, v193
  v_mfma_f32_32x32x16_bf16 v[144:159], v[20:23], v[32:35], v[144:159]
  v_sin_f32 v210, v194
  s_waitcnt lgkmcnt(0)
  s_barrier
  v_add_u32 v3, 0xa000, v3
  v_add_u32 v4, 0xa000, v4
  v_add_u32 v5, 0xa000, v5
  v_add_u32 v6, 0xa000, v6
  v_add_u32 v7, 0xa000, v7
  v_mfma_f32_32x32x16_bf16 v[64:79], v[44:47], v[36:39], v[64:79]
  ds_read_b128 v[16:19], v3 offset:0
  ds_read_b128 v[20:23], v3 offset:4096
  v_sin_f32 v211, v195
  v_mfma_f32_32x32x16_bf16 v[112:127], v[44:47], v[40:43], v[112:127]
  ds_read_b64_tr_b16 v[24:25], v7 offset:0
  ds_read_b64_tr_b16 v[26:27], v7 offset:512
  v_sin_f32 v212, v196
  v_mfma_f32_32x32x16_bf16 v[80:95], v[48:51], v[36:39], v[80:95]
  ds_read_b64_tr_b16 v[28:29], v7 offset:8192
  ds_read_b64_tr_b16 v[30:31], v7 offset:8704
  v_sin_f32 v213, v197
  v_mfma_f32_32x32x16_bf16 v[128:143], v[48:51], v[40:43], v[128:143]
  ds_read_b64_tr_b16 v[32:33], v7 offset:16384
  ds_read_b64_tr_b16 v[34:35], v7 offset:16896
  v_sin_f32 v214, v198
  v_mfma_f32_32x32x16_bf16 v[96:111], v[36:39], v[52:55], v[96:111]
  v_sin_f32 v215, v199
  v_mfma_f32_32x32x16_bf16 v[144:159], v[40:43], v[52:55], v[144:159]
  v_sin_f32 v216, v200
  s_waitcnt lgkmcnt(0)
  v_mfma_f32_32x32x16_bf16 v[64:79], v[24:27], v[16:19], v[64:79]
  ds_read_b128 v[36:39], v4 offset:0
  ds_read_b128 v[40:43], v4 offset:4096
  v_sin_f32 v217, v201
  v_mfma_f32_32x32x16_bf16 v[112:127], v[24:27], v[20:23], v[112:127]
  ds_read_b64_tr_b16 v[44:45], v7 offset:2048
  ds_read_b64_tr_b16 v[46:47], v7 offset:2560
  v_sin_f32 v218, v202
  v_mfma_f32_32x32x16_bf16 v[80:95], v[28:31], v[16:19], v[80:95]
  ds_read_b64_tr_b16 v[48:49], v7 offset:10240
  ds_read_b64_tr_b16 v[50:51], v7 offset:10752
  v_sin_f32 v219, v203
  v_mfma_f32_32x32x16_bf16 v[128:143], v[28:31], v[20:23], v[128:143]
  ds_read_b64_tr_b16 v[52:53], v7 offset:18432
  ds_read_b64_tr_b16 v[54:55], v7 offset:18944
  v_sin_f32 v220, v204
  v_mfma_f32_32x32x16_bf16 v[96:111], v[16:19], v[32:35], v[96:111]
  v_sin_f32 v221, v205
  v_mfma_f32_32x32x16_bf16 v[144:159], v[20:23], v[32:35], v[144:159]
  v_sin_f32 v222, v206
  s_waitcnt lgkmcnt(0)
  v_mfma_f32_32x32x16_bf16 v[64:79], v[44:47], v[36:39], v[64:79]
  ds_read_b128 v[16:19], v5 offset:0
  ds_read_b128 v[20:23], v5 offset:4096
  v_sin_f32 v223, v207
  v_mfma_f32_32x32x16_bf16 v[112:127], v[44:47], v[40:43], v[112:127]
  ds_read_b64_tr_b16 v[24:25], v7 offset:4096
  ds_read_b64_tr_b16 v[26:27], v7 offset:4608
  v_cos_f32 v192, v192
  v_mfma_f32_32x32x16_bf16 v[80:95], v[48:51], v[36:39], v[80:95]
  ds_read_b64_tr_b16 v[28:29], v7 offset:12288
  ds_read_b64_tr_b16 v[30:31], v7 offset:12800
  v_cos_f32 v193, v193
  v_mfma_f32_32x32x16_bf16 v[128:143], v[48:51], v[40:43], v[128:143]
  ds_read_b64_tr_b16 v[32:33], v7 offset:20480
  ds_read_b64_tr_b16 v[34:35], v7 offset:20992
  v_cos_f32 v194, v194
  v_mfma_f32_32x32x16_bf16 v[96:111], v[36:39], v[52:55], v[96:111]
  v_cos_f32 v195, v195
  v_mfma_f32_32x32x16_bf16 v[144:159], v[40:43], v[52:55], v[144:159]
  v_cos_f32 v196, v196
  s_waitcnt lgkmcnt(0)
  v_mfma_f32_32x32x16_bf16 v[64:79], v[24:27], v[16:19], v[64:79]
  ds_read_b128 v[36:39], v6 offset:0
  ds_read_b128 v[40:43], v6 offset:4096
  v_cos_f32 v197, v197
  v_mfma_f32_32x32x16_bf16 v[112:127], v[24:27], v[20:23], v[112:127]
  ds_read_b64_tr_b16 v[44:45], v7 offset:6144
  ds_read_b64_tr_b16 v[46:47], v7 offset:6656
  v_cos_f32 v198, v198
  v_mfma_f32_32x32x16_bf16 v[80:95], v[28:31], v[16:19], v[80:95]
  ds_read_b64_tr_b16 v[48:49], v7 offset:14336
  ds_read_b64_tr_b16 v[50:51], v7 offset:14848
  v_cos_f32 v199, v199
  v_mfma_f32_32x32x16_bf16 v[128:143], v[28:31], v[20:23], v[128:143]
  ds_read_b64_tr_b16 v[52:53], v7 offset:22528
  ds_read_b64_tr_b16 v[54:55], v7 offset:23040
  v_cos_f32 v200, v200
  v_mfma_f32_32x32x16_bf16 v[96:111], v[16:19], v[32:35], v[96:111]
  v_cos_f32 v201, v201
  v_mfma_f32_32x32x16_bf16 v[144:159], v[20:23], v[32:35], v[144:159]
  v_cos_f32 v202, v202
  s_waitcnt lgkmcnt(0)
  s_barrier
  v_add_u32 v3, 0xfffe2000, v3
  v_add_u32 v4, 0xfffe2000, v4
  v_add_u32 v5, 0xfffe2000, v5
  v_add_u32 v6, 0xfffe2000, v6
  v_add_u32 v7, 0xfffe2000, v7
  v_mfma_f32_32x32x16_bf16 v[64:79], v[44:47], v[36:39], v[64:79]
  ds_read_b128 v[16:19], v3 offset:0
  ds_read_b128 v[20:23], v3 offset:4096
  v_cos_f32 v203, v203
  v_mfma_f32_32x32x16_bf16 v[112:127], v[44:47], v[40:43], v[112:127]
  ds_read_b64_tr_b16 v[24:25], v7 offset:0
  ds_read_b64_tr_b16 v[26:27], v7 offset:512
  v_cos_f32 v204, v204
  v_mfma_f32_32x32x16_bf16 v[80:95], v[48:51], v[36:39], v[80:95]
  ds_read_b64_tr_b16 v[28:29], v7 offset:8192
  ds_read_b64_tr_b16 v[30:31], v7 offset:8704
  v_cos_f32 v205, v205
  v_mfma_f32_32x32x16_bf16 v[128:143], v[48:51], v[40:43], v[128:143]
  ds_read_b64_tr_b16 v[32:33], v7 offset:16384
  ds_read_b64_tr_b16 v[34:35], v7 offset:16896
  v_cos_f32 v206, v206
  v_mfma_f32_32x32x16_bf16 v[96:111], v[36:39], v[52:55], v[96:111]
  v_cos_f32 v207, v207
  v_mfma_f32_32x32x16_bf16 v[144:159], v[40:43], v[52:55], v[144:159]
  v_xor_b32 v176, 0x80008000, v168
  s_cmp_lg_u32 s25, 2
  s_cbranch_scc1 concat_heads__mha_block__spectral_fnet__prompt_kernel_cpf2
  s_getpc_b64 s[56:57]
concat_heads__mha_block__spectral_fnet__prompt_kernel_pcx:
  s_sub_u32 s56, s56, concat_heads__mha_block__spectral_fnet__prompt_kernel_pcx-concat_heads__mha_block__spectral_fnet__prompt_kernel
  s_subb_u32 s57, s57, 0
  v_and_b32 v254, 15, v0
  s_lshl_b32 s55, s21, 4
  v_add_u32 v254, s55, v254
  v_lshlrev_b32 v254, 7, v254
  s_mov_b32 s55, concat_heads__mha_block__spectral_fnet__prompt_kernel_done-concat_heads__mha_block__spectral_fnet__prompt_kernel
  v_min_u32 v254, s55, v254
  global_load_dword v255, v254, s[56:57]
concat_heads__mha_block__spectral_fnet__prompt_kernel_cpf2:
  s_waitcnt lgkmcnt(0)
  v_mfma_f32_32x32x16_bf16 v[64:79], v[24:27], v[16:19], v[64:79]
  ds_read_b128 v[36:39], v4 offset:0
  ds_read_b128 v[40:43], v4 offset:4096
  v_xor_b32 v184, 0x80008000, v160
  v_mfma_f32_32x32x16_bf16 v[112:127], v[24:27], v[20:23], v[112:127]
  ds_read_b64_tr_b16 v[44:45], v7 offset:2048
  ds_read_b64_tr_b16 v[46:47], v7 offset:2560
  v_xor_b32 v177, 0x80008000, v169
  v_mfma_f32_32x32x16_bf16 v[80:95], v[28:31], v[16:19], v[80:95]
  ds_read_b64_tr_b16 v[48:49], v7 offset:10240
  ds_read_b64_tr_b16 v[50:51], v7 offset:10752
  v_xor_b32 v185, 0x80008000, v161
  v_mfma_f32_32x32x16_bf16 v[128:143], v[28:31], v[20:23], v[128:143]
  ds_read_b64_tr_b16 v[52:53], v7 offset:18432
  ds_read_b64_tr_b16 v[54:55], v7 offset:18944
  v_xor_b32 v178, 0x80008000, v170
  v_mfma_f32_32x32x16_bf16 v[96:111], v[16:19], v[32:35], v[96:111]
  v_xor_b32 v186, 0x80008000, v162
  v_mfma_f32_32x32x16_bf16 v[144:159], v[20:23], v[32:35], v[144:159]
  v_xor_b32 v179, 0x80008000, v171
  s_waitcnt lgkmcnt(0)
  v_mfma_f32_32x32x16_bf16 v[64:79], v[44:47], v[36:39], v[64:79]
  ds_read_b128 v[16:19], v5 offset:0
  ds_read_b128 v[20:23], v5 offset:4096
  v_xor_b32 v187, 0x80008000, v163
  v_mfma_f32_32x32x16_bf16 v[112:127], v[44:47], v[40:43], v[112:127]
  ds_read_b64_tr_b16 v[24:25], v7 offset:4096
  ds_read_b64_tr_b16 v[26:27], v7 offset:4608
  v_xor_b32 v180, 0x80008000, v172
  v_mfma_f32_32x32x16_bf16 v[80:95], v[48:51], v[36:39], v[80:95]
  ds_read_b64_tr_b16 v[28:29], v7 offset:12288
  ds_read_b64_tr_b16 v[30:31], v7 offset:12800
  v_xor_b32 v188, 0x80008000, v164
  v_mfma_f32_32x32x16_bf16 v[128:143], v[48:51], v[40:43], v[128:143]
  ds_read_b64_tr_b16 v[32:33], v7 offset:20480
  ds_read_b64_tr_b16 v[34:35], v7 offset:20992
  v_xor_b32 v181, 0x80008000, v173
  v_mfma_f32_32x32x16_bf16 v[96:111], v[36:39], v[52:55], v[96:111]
  v_xor_b32 v189, 0x80008000, v165
  v_mfma_f32_32x32x16_bf16 v[144:159], v[40:43], v[52:55], v[144:159]
  v_xor_b32 v182, 0x80008000, v174
  s_waitcnt lgkmcnt(0)
  v_mfma_f32_32x32x16_bf16 v[64:79], v[24:27], v[16:19], v[64:79]
  ds_read_b128 v[36:39], v6 offset:0
  ds_read_b128 v[40:43], v6 offset:4096
  v_xor_b32 v190, 0x80008000, v166
  v_mfma_f32_32x32x16_bf16 v[112:127], v[24:27], v[20:23], v[112:127]
  ds_read_b64_tr_b16 v[44:45], v7 offset:6144
  ds_read_b64_tr_b16 v[46:47], v7 offset:6656
  v_xor_b32 v183, 0x80008000, v175
  v_mfma_f32_32x32x16_bf16 v[80:95], v[28:31], v[16:19], v[80:95]
  ds_read_b64_tr_b16 v[48:49], v7 offset:14336
  ds_read_b64_tr_b16 v[50:51], v7 offset:14848
  v_xor_b32 v191, 0x80008000, v167
  v_mfma_f32_32x32x16_bf16 v[128:143], v[28:31], v[20:23], v[128:143]
  ds_read_b64_tr_b16 v[52:53], v7 offset:22528
  ds_read_b64_tr_b16 v[54:55], v7 offset:23040
  v_lshrrev_b32 v240, 5, v0
  v_mfma_f32_32x32x16_bf16 v[96:111], v[16:19], v[32:35], v[96:111]
  v_lshlrev_b32 v240, 13, v240
  v_mfma_f32_32x32x16_bf16 v[144:159], v[20:23], v[32:35], v[144:159]
  v_bfe_u32 v241, v0, 2, 2
  s_waitcnt lgkmcnt(0)
  s_barrier
  v_add_u32 v3, 0xa000, v3
  v_add_u32 v4, 0xa000, v4
  v_add_u32 v5, 0xa000, v5
  v_add_u32 v6, 0xa000, v6
  v_add_u32 v7, 0xa000, v7
  v_mfma_f32_32x32x16_bf16 v[64:79], v[44:47], v[36:39], v[64:79]
  ds_read_b128 v[16:19], v3 offset:0
  ds_read_b128 v[20:23], v3 offset:4096
  v_lshlrev_b32 v241, 3, v241
  v_mfma_f32_32x32x16_bf16 v[112:127], v[44:47], v[40:43], v[112:127]
  ds_read_b64_tr_b16 v[24:25], v7 offset:0
  ds_read_b64_tr_b16 v[26:27], v7 offset:512
  v_bfe_u32 v224, v0, 4, 1
  v_mfma_f32_32x32x16_bf16 v[80:95], v[48:51], v[36:39], v[80:95]
  ds_read_b64_tr_b16 v[28:29], v7 offset:8192
  ds_read_b64_tr_b16 v[30:31], v7 offset:8704
  v_lshlrev_b32 v224, 2, v224
  v_mfma_f32_32x32x16_bf16 v[128:143], v[48:51], v[40:43], v[128:143]
  ds_read_b64_tr_b16 v[32:33], v7 offset:16384
  ds_read_b64_tr_b16 v[34:35], v7 offset:16896
  v_add_u32 v241, v241, v224
  v_mfma_f32_32x32x16_bf16 v[96:111], v[36:39], v[52:55], v[96:111]
  v_and_b32 v224, 3, v0
  v_mfma_f32_32x32x16_bf16 v[144:159], v[40:43], v[52:55], v[144:159]
  v_add_u32 v241, v241, v224
  s_waitcnt lgkmcnt(0)
  v_mfma_f32_32x32x16_bf16 v[64:79], v[24:27], v[16:19], v[64:79]
  ds_read_b128 v[36:39], v4 offset:0
  ds_read_b128 v[40:43], v4 offset:4096
  s_lshl_b32 s87, s25, 2
  v_xor_b32 v224, s87, v241
  v_mfma_f32_32x32x16_bf16 v[112:127], v[24:27], v[20:23], v[112:127]
  ds_read_b64_tr_b16 v[44:45], v7 offset:2048
  ds_read_b64_tr_b16 v[46:47], v7 offset:2560
  v_lshlrev_b32 v224, 3, v224
  v_mfma_f32_32x32x16_bf16 v[80:95], v[28:31], v[16:19], v[80:95]
  ds_read_b64_tr_b16 v[48:49], v7 offset:10240
  ds_read_b64_tr_b16 v[50:51], v7 offset:10752
  v_add_u32 v224, v240, v224
  v_mfma_f32_32x32x16_bf16 v[128:143], v[28:31], v[20:23], v[128:143]
  ds_read_b64_tr_b16 v[52:53], v7 offset:18432
  ds_read_b64_tr_b16 v[54:55], v7 offset:18944
  s_lshl_b32 s88, s25, 9
  v_add_u32 v243, s88, v224
  v_mfma_f32_32x32x16_bf16 v[96:111], v[16:19], v[32:35], v[96:111]
  s_add_u32 s87, s87, 2
  v_xor_b32 v224, s87, v241
  v_mfma_f32_32x32x16_bf16 v[144:159], v[20:23], v[32:35], v[144:159]
  v_lshlrev_b32 v224, 3, v224
  s_waitcnt lgkmcnt(0)
  v_mfma_f32_32x32x16_bf16 v[64:79], v[44:47], v[36:39], v[64:79]
  ds_read_b128 v[16:19], v5 offset:0
  ds_read_b128 v[20:23], v5 offset:4096
  v_add_u32 v224, v240, v224
  v_mfma_f32_32x32x16_bf16 v[112:127], v[44:47], v[40:43], v[112:127]
  ds_read_b64_tr_b16 v[24:25], v7 offset:4096
  ds_read_b64_tr_b16 v[26:27], v7 offset:4608
  s_add_u32 s88, s88, 256
  v_add_u32 v244, s88, v224
  v_mfma_f32_32x32x16_bf16 v[80:95], v[48:51], v[36:39], v[80:95]
  ds_read_b64_tr_b16 v[28:29], v7 offset:12288
  ds_read_b64_tr_b16 v[30:31], v7 offset:12800
  s_lshl_b32 s87, s81, 3
  s_add_u32 s87, s87, s25
  s_lshl_b32 s87, s87, 18
  s_lshl_b32 s88, s80, 11
  s_add_u32 s87, s87, s88
  v_and_b32 v240, 31, v0
  v_mfma_f32_32x32x16_bf16 v[128:143], v[48:51], v[40:43], v[128:143]
  ds_read_b64_tr_b16 v[32:33], v7 offset:20480
  ds_read_b64_tr_b16 v[34:35], v7 offset:20992
  v_lshlrev_b32 v240, 5, v240
  v_mfma_f32_32x32x16_bf16 v[96:111], v[36:39], v[52:55], v[96:111]
  v_lshrrev_b32 v241, 5, v0
  v_mfma_f32_32x32x16_bf16 v[144:159], v[40:43], v[52:55], v[144:159]
  v_lshlrev_b32 v241, 4, v241
  s_waitcnt lgkmcnt(0)
  v_mfma_f32_32x32x16_bf16 v[64:79], v[24:27], v[16:19], v[64:79]
  ds_read_b128 v[36:39], v6 offset:0
  ds_read_b128 v[40:43], v6 offset:4096
  v_add_u32 v240, v240, v241
  v_mfma_f32_32x32x16_bf16 v[112:127], v[24:27], v[20:23], v[112:127]
  ds_read_b64_tr_b16 v[44:45], v7 offset:6144
  ds_read_b64_tr_b16 v[46:47], v7 offset:6656
  v_add_u32 v245, s87, v240
  v_mfma_f32_32x32x16_bf16 v[80:95], v[28:31], v[16:19], v[80:95]
  ds_read_b64_tr_b16 v[48:49], v7 offset:14336
  ds_read_b64_tr_b16 v[50:51], v7 offset:14848
  v_mfma_f32_32x32x16_bf16 v[128:143], v[28:31], v[20:23], v[128:143]
  ds_read_b64_tr_b16 v[52:53], v7 offset:22528
  ds_read_b64_tr_b16 v[54:55], v7 offset:23040
  v_mfma_f32_32x32x16_bf16 v[96:111], v[16:19], v[32:35], v[96:111]
  v_mfma_f32_32x32x16_bf16 v[144:159], v[20:23], v[32:35], v[144:159]
  s_waitcnt lgkmcnt(0)
  s_barrier
  v_add_u32 v3, 0xa000, v3
  v_add_u32 v4, 0xa000, v4
  v_add_u32 v5, 0xa000, v5
  v_add_u32 v6, 0xa000, v6
  v_add_u32 v7, 0xa000, v7
  v_mfma_f32_32x32x16_bf16 v[64:79], v[44:47], v[36:39], v[64:79]
  ds_read_b128 v[16:19], v3 offset:0
  ds_read_b128 v[20:23], v3 offset:4096
  v_mfma_f32_32x32x16_bf16 v[112:127], v[44:47], v[40:43], v[112:127]
  ds_read_b64_tr_b16 v[24:25], v7 offset:0
  ds_read_b64_tr_b16 v[26:27], v7 offset:512
  v_mfma_f32_32x32x16_bf16 v[80:95], v[48:51], v[36:39], v[80:95]
  ds_read_b64_tr_b16 v[28:29], v7 offset:8192
  ds_read_b64_tr_b16 v[30:31], v7 offset:8704
  v_mfma_f32_32x32x16_bf16 v[128:143], v[48:51], v[40:43], v[128:143]
  ds_read_b64_tr_b16 v[32:33], v7 offset:16384
  ds_read_b64_tr_b16 v[34:35], v7 offset:16896
  v_mfma_f32_32x32x16_bf16 v[96:111], v[36:39], v[52:55], v[96:111]
  v_mfma_f32_32x32x16_bf16 v[144:159], v[40:43], v[52:55], v[144:159]
  s_waitcnt lgkmcnt(0)
  v_mfma_f32_32x32x16_bf16 v[64:79], v[24:27], v[16:19], v[64:79]
  ds_read_b128 v[36:39], v4 offset:0
  ds_read_b128 v[40:43], v4 offset:4096
  v_mfma_f32_32x32x16_bf16 v[112:127], v[24:27], v[20:23], v[112:127]
  ds_read_b64_tr_b16 v[44:45], v7 offset:2048
  ds_read_b64_tr_b16 v[46:47], v7 offset:2560
  v_mfma_f32_32x32x16_bf16 v[80:95], v[28:31], v[16:19], v[80:95]
  ds_read_b64_tr_b16 v[48:49], v7 offset:10240
  ds_read_b64_tr_b16 v[50:51], v7 offset:10752
  v_mfma_f32_32x32x16_bf16 v[128:143], v[28:31], v[20:23], v[128:143]
  ds_read_b64_tr_b16 v[52:53], v7 offset:18432
  ds_read_b64_tr_b16 v[54:55], v7 offset:18944
  v_mfma_f32_32x32x16_bf16 v[96:111], v[16:19], v[32:35], v[96:111]
  v_mfma_f32_32x32x16_bf16 v[144:159], v[20:23], v[32:35], v[144:159]
  s_waitcnt lgkmcnt(0)
  v_mfma_f32_32x32x16_bf16 v[64:79], v[44:47], v[36:39], v[64:79]
  ds_read_b128 v[16:19], v5 offset:0
  ds_read_b128 v[20:23], v5 offset:4096
  v_mfma_f32_32x32x16_bf16 v[112:127], v[44:47], v[40:43], v[112:127]
  ds_read_b64_tr_b16 v[24:25], v7 offset:4096
  ds_read_b64_tr_b16 v[26:27], v7 offset:4608
  v_mfma_f32_32x32x16_bf16 v[80:95], v[48:51], v[36:39], v[80:95]
  ds_read_b64_tr_b16 v[28:29], v7 offset:12288
  ds_read_b64_tr_b16 v[30:31], v7 offset:12800
  v_mfma_f32_32x32x16_bf16 v[128:143], v[48:51], v[40:43], v[128:143]
  ds_read_b64_tr_b16 v[32:33], v7 offset:20480
  ds_read_b64_tr_b16 v[34:35], v7 offset:20992
  v_mfma_f32_32x32x16_bf16 v[96:111], v[36:39], v[52:55], v[96:111]
  v_mfma_f32_32x32x16_bf16 v[144:159], v[40:43], v[52:55], v[144:159]
  s_waitcnt lgkmcnt(0)
  v_mfma_f32_32x32x16_bf16 v[64:79], v[24:27], v[16:19], v[64:79]
  ds_read_b128 v[36:39], v6 offset:0
  ds_read_b128 v[40:43], v6 offset:4096
  v_mfma_f32_32x32x16_bf16 v[112:127], v[24:27], v[20:23], v[112:127]
  ds_read_b64_tr_b16 v[44:45], v7 offset:6144
  ds_read_b64_tr_b16 v[46:47], v7 offset:6656
  v_mfma_f32_32x32x16_bf16 v[80:95], v[28:31], v[16:19], v[80:95]
  ds_read_b64_tr_b16 v[48:49], v7 offset:14336
  ds_read_b64_tr_b16 v[50:51], v7 offset:14848
  v_mfma_f32_32x32x16_bf16 v[128:143], v[28:31], v[20:23], v[128:143]
  ds_read_b64_tr_b16 v[52:53], v7 offset:22528
  ds_read_b64_tr_b16 v[54:55], v7 offset:23040
  v_mfma_f32_32x32x16_bf16 v[96:111], v[16:19], v[32:35], v[96:111]
  v_mfma_f32_32x32x16_bf16 v[144:159], v[20:23], v[32:35], v[144:159]
  s_waitcnt lgkmcnt(0)
  s_barrier
  v_add_u32 v3, 0xa000, v3
  v_add_u32 v4, 0xa000, v4
  v_add_u32 v5, 0xa000, v5
  v_add_u32 v6, 0xa000, v6
  v_add_u32 v7, 0xa000, v7
  v_mfma_f32_32x32x16_bf16 v[64:79], v[44:47], v[36:39], v[64:79]
  ds_read_b128 v[16:19], v3 offset:0
  ds_read_b128 v[20:23], v3 offset:4096
  v_mfma_f32_32x32x16_bf16 v[112:127], v[44:47], v[40:43], v[112:127]
  ds_read_b64_tr_b16 v[24:25], v7 offset:0
  ds_read_b64_tr_b16 v[26:27], v7 offset:512
  v_mfma_f32_32x32x16_bf16 v[80:95], v[48:51], v[36:39], v[80:95]
  ds_read_b64_tr_b16 v[28:29], v7 offset:8192
  ds_read_b64_tr_b16 v[30:31], v7 offset:8704
  v_mfma_f32_32x32x16_bf16 v[128:143], v[48:51], v[40:43], v[128:143]
  ds_read_b64_tr_b16 v[32:33], v7 offset:16384
  ds_read_b64_tr_b16 v[34:35], v7 offset:16896
  v_mfma_f32_32x32x16_bf16 v[96:111], v[36:39], v[52:55], v[96:111]
  v_mfma_f32_32x32x16_bf16 v[144:159], v[40:43], v[52:55], v[144:159]
  s_waitcnt lgkmcnt(0)
  v_mfma_f32_32x32x16_bf16 v[64:79], v[24:27], v[16:19], v[64:79]
  ds_read_b128 v[36:39], v4 offset:0
  ds_read_b128 v[40:43], v4 offset:4096
  v_mfma_f32_32x32x16_bf16 v[112:127], v[24:27], v[20:23], v[112:127]
  ds_read_b64_tr_b16 v[44:45], v7 offset:2048
  ds_read_b64_tr_b16 v[46:47], v7 offset:2560
  v_mfma_f32_32x32x16_bf16 v[80:95], v[28:31], v[16:19], v[80:95]
  ds_read_b64_tr_b16 v[48:49], v7 offset:10240
  ds_read_b64_tr_b16 v[50:51], v7 offset:10752
  v_mfma_f32_32x32x16_bf16 v[128:143], v[28:31], v[20:23], v[128:143]
  ds_read_b64_tr_b16 v[52:53], v7 offset:18432
  ds_read_b64_tr_b16 v[54:55], v7 offset:18944
  v_mfma_f32_32x32x16_bf16 v[96:111], v[16:19], v[32:35], v[96:111]
  v_mfma_f32_32x32x16_bf16 v[144:159], v[20:23], v[32:35], v[144:159]
  s_waitcnt lgkmcnt(0)
  v_mfma_f32_32x32x16_bf16 v[64:79], v[44:47], v[36:39], v[64:79]
  ds_read_b128 v[16:19], v5 offset:0
  ds_read_b128 v[20:23], v5 offset:4096
  v_mfma_f32_32x32x16_bf16 v[112:127], v[44:47], v[40:43], v[112:127]
  ds_read_b64_tr_b16 v[24:25], v7 offset:4096
  ds_read_b64_tr_b16 v[26:27], v7 offset:4608
  v_mfma_f32_32x32x16_bf16 v[80:95], v[48:51], v[36:39], v[80:95]
  ds_read_b64_tr_b16 v[28:29], v7 offset:12288
  ds_read_b64_tr_b16 v[30:31], v7 offset:12800
  v_mfma_f32_32x32x16_bf16 v[128:143], v[48:51], v[40:43], v[128:143]
  ds_read_b64_tr_b16 v[32:33], v7 offset:20480
  ds_read_b64_tr_b16 v[34:35], v7 offset:20992
  v_mfma_f32_32x32x16_bf16 v[96:111], v[36:39], v[52:55], v[96:111]
  v_mfma_f32_32x32x16_bf16 v[144:159], v[40:43], v[52:55], v[144:159]
  s_waitcnt lgkmcnt(0)
  v_mfma_f32_32x32x16_bf16 v[64:79], v[24:27], v[16:19], v[64:79]
  ds_read_b128 v[36:39], v6 offset:0
  ds_read_b128 v[40:43], v6 offset:4096
  v_mfma_f32_32x32x16_bf16 v[112:127], v[24:27], v[20:23], v[112:127]
  ds_read_b64_tr_b16 v[44:45], v7 offset:6144
  ds_read_b64_tr_b16 v[46:47], v7 offset:6656
  v_mfma_f32_32x32x16_bf16 v[80:95], v[28:31], v[16:19], v[80:95]
  ds_read_b64_tr_b16 v[48:49], v7 offset:14336
  ds_read_b64_tr_b16 v[50:51], v7 offset:14848
  v_mfma_f32_32x32x16_bf16 v[128:143], v[28:31], v[20:23], v[128:143]
  ds_read_b64_tr_b16 v[52:53], v7 offset:22528
  ds_read_b64_tr_b16 v[54:55], v7 offset:23040
  v_mfma_f32_32x32x16_bf16 v[96:111], v[16:19], v[32:35], v[96:111]
  v_mfma_f32_32x32x16_bf16 v[144:159], v[20:23], v[32:35], v[144:159]
  s_waitcnt lgkmcnt(0)
  s_barrier
  v_add_u32 v3, 0xfffe2000, v3
  v_add_u32 v4, 0xfffe2000, v4
  v_add_u32 v5, 0xfffe2000, v5
  v_add_u32 v6, 0xfffe2000, v6
  v_add_u32 v7, 0xfffe2000, v7
  v_mfma_f32_32x32x16_bf16 v[64:79], v[44:47], v[36:39], v[64:79]
  ds_read_b128 v[16:19], v3 offset:0
  ds_read_b128 v[20:23], v3 offset:4096
  v_mfma_f32_32x32x16_bf16 v[112:127], v[44:47], v[40:43], v[112:127]
  ds_read_b64_tr_b16 v[24:25], v7 offset:0
  ds_read_b64_tr_b16 v[26:27], v7 offset:512
  v_mfma_f32_32x32x16_bf16 v[80:95], v[48:51], v[36:39], v[80:95]
  ds_read_b64_tr_b16 v[28:29], v7 offset:8192
  ds_read_b64_tr_b16 v[30:31], v7 offset:8704
  v_mfma_f32_32x32x16_bf16 v[128:143], v[48:51], v[40:43], v[128:143]
  ds_read_b64_tr_b16 v[32:33], v7 offset:16384
  ds_read_b64_tr_b16 v[34:35], v7 offset:16896
  v_mfma_f32_32x32x16_bf16 v[96:111], v[36:39], v[52:55], v[96:111]
  v_mfma_f32_32x32x16_bf16 v[144:159], v[40:43], v[52:55], v[144:159]
  s_waitcnt lgkmcnt(0)
  v_mfma_f32_32x32x16_bf16 v[64:79], v[24:27], v[16:19], v[64:79]
  ds_read_b128 v[36:39], v4 offset:0
  ds_read_b128 v[40:43], v4 offset:4096
  v_mfma_f32_32x32x16_bf16 v[112:127], v[24:27], v[20:23], v[112:127]
  ds_read_b64_tr_b16 v[44:45], v7 offset:2048
  ds_read_b64_tr_b16 v[46:47], v7 offset:2560
  v_mfma_f32_32x32x16_bf16 v[80:95], v[28:31], v[16:19], v[80:95]
  ds_read_b64_tr_b16 v[48:49], v7 offset:10240
  ds_read_b64_tr_b16 v[50:51], v7 offset:10752
  v_mfma_f32_32x32x16_bf16 v[128:143], v[28:31], v[20:23], v[128:143]
  ds_read_b64_tr_b16 v[52:53], v7 offset:18432
  ds_read_b64_tr_b16 v[54:55], v7 offset:18944
  v_mfma_f32_32x32x16_bf16 v[96:111], v[16:19], v[32:35], v[96:111]
  v_mfma_f32_32x32x16_bf16 v[144:159], v[20:23], v[32:35], v[144:159]
  s_waitcnt lgkmcnt(0)
  v_mfma_f32_32x32x16_bf16 v[64:79], v[44:47], v[36:39], v[64:79]
  ds_read_b128 v[16:19], v5 offset:0
  ds_read_b128 v[20:23], v5 offset:4096
  v_mfma_f32_32x32x16_bf16 v[112:127], v[44:47], v[40:43], v[112:127]
  ds_read_b64_tr_b16 v[24:25], v7 offset:4096
  ds_read_b64_tr_b16 v[26:27], v7 offset:4608
  v_mfma_f32_32x32x16_bf16 v[80:95], v[48:51], v[36:39], v[80:95]
  ds_read_b64_tr_b16 v[28:29], v7 offset:12288
  ds_read_b64_tr_b16 v[30:31], v7 offset:12800
  v_mfma_f32_32x32x16_bf16 v[128:143], v[48:51], v[40:43], v[128:143]
  ds_read_b64_tr_b16 v[32:33], v7 offset:20480
  ds_read_b64_tr_b16 v[34:35], v7 offset:20992
  v_mfma_f32_32x32x16_bf16 v[96:111], v[36:39], v[52:55], v[96:111]
  v_mfma_f32_32x32x16_bf16 v[144:159], v[40:43], v[52:55], v[144:159]
  s_waitcnt lgkmcnt(0)
  v_mfma_f32_32x32x16_bf16 v[64:79], v[24:27], v[16:19], v[64:79]
  ds_read_b128 v[36:39], v6 offset:0
  ds_read_b128 v[40:43], v6 offset:4096
  v_mfma_f32_32x32x16_bf16 v[112:127], v[24:27], v[20:23], v[112:127]
  ds_read_b64_tr_b16 v[44:45], v7 offset:6144
  ds_read_b64_tr_b16 v[46:47], v7 offset:6656
  v_mfma_f32_32x32x16_bf16 v[80:95], v[28:31], v[16:19], v[80:95]
  ds_read_b64_tr_b16 v[48:49], v7 offset:14336
  ds_read_b64_tr_b16 v[50:51], v7 offset:14848
  v_mfma_f32_32x32x16_bf16 v[128:143], v[28:31], v[20:23], v[128:143]
  ds_read_b64_tr_b16 v[52:53], v7 offset:22528
  ds_read_b64_tr_b16 v[54:55], v7 offset:23040
  v_mfma_f32_32x32x16_bf16 v[96:111], v[16:19], v[32:35], v[96:111]
  v_mfma_f32_32x32x16_bf16 v[144:159], v[20:23], v[32:35], v[144:159]
  s_waitcnt lgkmcnt(0)
  s_barrier
  v_add_u32 v3, 0xa000, v3
  v_add_u32 v4, 0xa000, v4
  v_add_u32 v5, 0xa000, v5
  v_add_u32 v6, 0xa000, v6
  v_add_u32 v7, 0xa000, v7
  v_mfma_f32_32x32x16_bf16 v[64:79], v[44:47], v[36:39], v[64:79]
  ds_read_b128 v[16:19], v3 offset:0
  ds_read_b128 v[20:23], v3 offset:4096
  v_mfma_f32_32x32x16_bf16 v[112:127], v[44:47], v[40:43], v[112:127]
  ds_read_b64_tr_b16 v[24:25], v7 offset:0
  ds_read_b64_tr_b16 v[26:27], v7 offset:512
  v_mfma_f32_32x32x16_bf16 v[80:95], v[48:51], v[36:39], v[80:95]
  ds_read_b64_tr_b16 v[28:29], v7 offset:8192
  ds_read_b64_tr_b16 v[30:31], v7 offset:8704
  v_mfma_f32_32x32x16_bf16 v[128:143], v[48:51], v[40:43], v[128:143]
  ds_read_b64_tr_b16 v[32:33], v7 offset:16384
  ds_read_b64_tr_b16 v[34:35], v7 offset:16896
  v_mfma_f32_32x32x16_bf16 v[96:111], v[36:39], v[52:55], v[96:111]
  v_mfma_f32_32x32x16_bf16 v[144:159], v[40:43], v[52:55], v[144:159]
  s_waitcnt lgkmcnt(0)
  v_mfma_f32_32x32x16_bf16 v[64:79], v[24:27], v[16:19], v[64:79]
  ds_read_b128 v[36:39], v4 offset:0
  ds_read_b128 v[40:43], v4 offset:4096
  v_mfma_f32_32x32x16_bf16 v[112:127], v[24:27], v[20:23], v[112:127]
  ds_read_b64_tr_b16 v[44:45], v7 offset:2048
  ds_read_b64_tr_b16 v[46:47], v7 offset:2560
  v_mfma_f32_32x32x16_bf16 v[80:95], v[28:31], v[16:19], v[80:95]
  ds_read_b64_tr_b16 v[48:49], v7 offset:10240
  ds_read_b64_tr_b16 v[50:51], v7 offset:10752
  v_mfma_f32_32x32x16_bf16 v[128:143], v[28:31], v[20:23], v[128:143]
  ds_read_b64_tr_b16 v[52:53], v7 offset:18432
  ds_read_b64_tr_b16 v[54:55], v7 offset:18944
  v_mfma_f32_32x32x16_bf16 v[96:111], v[16:19], v[32:35], v[96:111]
  v_mfma_f32_32x32x16_bf16 v[144:159], v[20:23], v[32:35], v[144:159]
  s_waitcnt lgkmcnt(0)
  v_mfma_f32_32x32x16_bf16 v[64:79], v[44:47], v[36:39], v[64:79]
  ds_read_b128 v[16:19], v5 offset:0
  ds_read_b128 v[20:23], v5 offset:4096
  v_mfma_f32_32x32x16_bf16 v[112:127], v[44:47], v[40:43], v[112:127]
  ds_read_b64_tr_b16 v[24:25], v7 offset:4096
  ds_read_b64_tr_b16 v[26:27], v7 offset:4608
  v_mfma_f32_32x32x16_bf16 v[80:95], v[48:51], v[36:39], v[80:95]
  ds_read_b64_tr_b16 v[28:29], v7 offset:12288
  ds_read_b64_tr_b16 v[30:31], v7 offset:12800
  v_mfma_f32_32x32x16_bf16 v[128:143], v[48:51], v[40:43], v[128:143]
  ds_read_b64_tr_b16 v[32:33], v7 offset:20480
  ds_read_b64_tr_b16 v[34:35], v7 offset:20992
  v_mfma_f32_32x32x16_bf16 v[96:111], v[36:39], v[52:55], v[96:111]
  v_mfma_f32_32x32x16_bf16 v[144:159], v[40:43], v[52:55], v[144:159]
  s_waitcnt lgkmcnt(0)
  v_mfma_f32_32x32x16_bf16 v[64:79], v[24:27], v[16:19], v[64:79]
  ds_read_b128 v[36:39], v6 offset:0
  ds_read_b128 v[40:43], v6 offset:4096
  v_mfma_f32_32x32x16_bf16 v[112:127], v[24:27], v[20:23], v[112:127]
  ds_read_b64_tr_b16 v[44:45], v7 offset:6144
  ds_read_b64_tr_b16 v[46:47], v7 offset:6656
  v_mfma_f32_32x32x16_bf16 v[80:95], v[28:31], v[16:19], v[80:95]
  ds_read_b64_tr_b16 v[48:49], v7 offset:14336
  ds_read_b64_tr_b16 v[50:51], v7 offset:14848
  v_mfma_f32_32x32x16_bf16 v[128:143], v[28:31], v[20:23], v[128:143]
  ds_read_b64_tr_b16 v[52:53], v7 offset:22528
  ds_read_b64_tr_b16 v[54:55], v7 offset:23040
  v_mfma_f32_32x32x16_bf16 v[96:111], v[16:19], v[32:35], v[96:111]
  v_mfma_f32_32x32x16_bf16 v[144:159], v[20:23], v[32:35], v[144:159]
  s_waitcnt lgkmcnt(0)
  s_barrier
  v_add_u32 v3, 0xa000, v3
  v_add_u32 v4, 0xa000, v4
  v_add_u32 v5, 0xa000, v5
  v_add_u32 v6, 0xa000, v6
  v_add_u32 v7, 0xa000, v7
  v_mfma_f32_32x32x16_bf16 v[64:79], v[44:47], v[36:39], v[64:79]
  ds_read_b128 v[16:19], v3 offset:0
  ds_read_b128 v[20:23], v3 offset:4096
  v_mfma_f32_32x32x16_bf16 v[112:127], v[44:47], v[40:43], v[112:127]
  ds_read_b64_tr_b16 v[24:25], v7 offset:0
  ds_read_b64_tr_b16 v[26:27], v7 offset:512
  v_mfma_f32_32x32x16_bf16 v[80:95], v[48:51], v[36:39], v[80:95]
  ds_read_b64_tr_b16 v[28:29], v7 offset:8192
  ds_read_b64_tr_b16 v[30:31], v7 offset:8704
  v_mfma_f32_32x32x16_bf16 v[128:143], v[48:51], v[40:43], v[128:143]
  ds_read_b64_tr_b16 v[32:33], v7 offset:16384
  ds_read_b64_tr_b16 v[34:35], v7 offset:16896
  v_mfma_f32_32x32x16_bf16 v[96:111], v[36:39], v[52:55], v[96:111]
  v_mfma_f32_32x32x16_bf16 v[144:159], v[40:43], v[52:55], v[144:159]
  s_waitcnt lgkmcnt(0)
  v_mfma_f32_32x32x16_bf16 v[64:79], v[24:27], v[16:19], v[64:79]
  ds_read_b128 v[36:39], v4 offset:0
  ds_read_b128 v[40:43], v4 offset:4096
  v_mfma_f32_32x32x16_bf16 v[112:127], v[24:27], v[20:23], v[112:127]
  ds_read_b64_tr_b16 v[44:45], v7 offset:2048
  ds_read_b64_tr_b16 v[46:47], v7 offset:2560
  v_mfma_f32_32x32x16_bf16 v[80:95], v[28:31], v[16:19], v[80:95]
  ds_read_b64_tr_b16 v[48:49], v7 offset:10240
  ds_read_b64_tr_b16 v[50:51], v7 offset:10752
  v_mfma_f32_32x32x16_bf16 v[128:143], v[28:31], v[20:23], v[128:143]
  ds_read_b64_tr_b16 v[52:53], v7 offset:18432
  ds_read_b64_tr_b16 v[54:55], v7 offset:18944
  v_mfma_f32_32x32x16_bf16 v[96:111], v[16:19], v[32:35], v[96:111]
  v_mfma_f32_32x32x16_bf16 v[144:159], v[20:23], v[32:35], v[144:159]
  s_waitcnt lgkmcnt(0)
  v_mfma_f32_32x32x16_bf16 v[64:79], v[44:47], v[36:39], v[64:79]
  ds_read_b128 v[16:19], v5 offset:0
  ds_read_b128 v[20:23], v5 offset:4096
  v_mfma_f32_32x32x16_bf16 v[112:127], v[44:47], v[40:43], v[112:127]
  ds_read_b64_tr_b16 v[24:25], v7 offset:4096
  ds_read_b64_tr_b16 v[26:27], v7 offset:4608
  v_mfma_f32_32x32x16_bf16 v[80:95], v[48:51], v[36:39], v[80:95]
  ds_read_b64_tr_b16 v[28:29], v7 offset:12288
  ds_read_b64_tr_b16 v[30:31], v7 offset:12800
  v_mfma_f32_32x32x16_bf16 v[128:143], v[48:51], v[40:43], v[128:143]
  ds_read_b64_tr_b16 v[32:33], v7 offset:20480
  ds_read_b64_tr_b16 v[34:35], v7 offset:20992
  v_mfma_f32_32x32x16_bf16 v[96:111], v[36:39], v[52:55], v[96:111]
  v_mfma_f32_32x32x16_bf16 v[144:159], v[40:43], v[52:55], v[144:159]
  s_waitcnt lgkmcnt(0)
  v_mfma_f32_32x32x16_bf16 v[64:79], v[24:27], v[16:19], v[64:79]
  ds_read_b128 v[36:39], v6 offset:0
  ds_read_b128 v[40:43], v6 offset:4096
  v_mfma_f32_32x32x16_bf16 v[112:127], v[24:27], v[20:23], v[112:127]
  ds_read_b64_tr_b16 v[44:45], v7 offset:6144
  ds_read_b64_tr_b16 v[46:47], v7 offset:6656
  v_mfma_f32_32x32x16_bf16 v[80:95], v[28:31], v[16:19], v[80:95]
  ds_read_b64_tr_b16 v[48:49], v7 offset:14336
  ds_read_b64_tr_b16 v[50:51], v7 offset:14848
  v_mfma_f32_32x32x16_bf16 v[128:143], v[28:31], v[20:23], v[128:143]
  ds_read_b64_tr_b16 v[52:53], v7 offset:22528
  ds_read_b64_tr_b16 v[54:55], v7 offset:23040
  v_mfma_f32_32x32x16_bf16 v[96:111], v[16:19], v[32:35], v[96:111]
  v_mfma_f32_32x32x16_bf16 v[144:159], v[20:23], v[32:35], v[144:159]
  s_waitcnt lgkmcnt(0)
  s_barrier
  v_add_u32 v3, 0xa000, v3
  v_add_u32 v4, 0xa000, v4
  v_add_u32 v5, 0xa000, v5
  v_add_u32 v6, 0xa000, v6
  v_add_u32 v7, 0xa000, v7
  v_mfma_f32_32x32x16_bf16 v[64:79], v[44:47], v[36:39], v[64:79]
  ds_read_b128 v[16:19], v3 offset:0
  ds_read_b128 v[20:23], v3 offset:4096
  v_mfma_f32_32x32x16_bf16 v[112:127], v[44:47], v[40:43], v[112:127]
  ds_read_b64_tr_b16 v[24:25], v7 offset:0
  ds_read_b64_tr_b16 v[26:27], v7 offset:512
  v_mfma_f32_32x32x16_bf16 v[80:95], v[48:51], v[36:39], v[80:95]
  ds_read_b64_tr_b16 v[28:29], v7 offset:8192
  ds_read_b64_tr_b16 v[30:31], v7 offset:8704
  v_mfma_f32_32x32x16_bf16 v[128:143], v[48:51], v[40:43], v[128:143]
  ds_read_b64_tr_b16 v[32:33], v7 offset:16384
  ds_read_b64_tr_b16 v[34:35], v7 offset:16896
  v_mfma_f32_32x32x16_bf16 v[96:111], v[36:39], v[52:55], v[96:111]
  v_mfma_f32_32x32x16_bf16 v[144:159], v[40:43], v[52:55], v[144:159]
  s_waitcnt lgkmcnt(0)
  v_mfma_f32_32x32x16_bf16 v[64:79], v[24:27], v[16:19], v[64:79]
  ds_read_b128 v[36:39], v4 offset:0
  ds_read_b128 v[40:43], v4 offset:4096
  v_mfma_f32_32x32x16_bf16 v[112:127], v[24:27], v[20:23], v[112:127]
  ds_read_b64_tr_b16 v[44:45], v7 offset:2048
  ds_read_b64_tr_b16 v[46:47], v7 offset:2560
  v_mfma_f32_32x32x16_bf16 v[80:95], v[28:31], v[16:19], v[80:95]
  ds_read_b64_tr_b16 v[48:49], v7 offset:10240
  ds_read_b64_tr_b16 v[50:51], v7 offset:10752
  v_mfma_f32_32x32x16_bf16 v[128:143], v[28:31], v[20:23], v[128:143]
  ds_read_b64_tr_b16 v[52:53], v7 offset:18432
  ds_read_b64_tr_b16 v[54:55], v7 offset:18944
  v_mfma_f32_32x32x16_bf16 v[96:111], v[16:19], v[32:35], v[96:111]
  v_mfma_f32_32x32x16_bf16 v[144:159], v[20:23], v[32:35], v[144:159]
  v_lshlrev_b32 v240, 4, v0
  s_mul_i32 s28, s25, 3072
  s_add_u32 s28, s28, 81920
  v_add_u32 v240, s28, v240
  s_cmp_eq_u32 s25, 0
  s_cbranch_scc0 concat_heads__mha_block__spectral_fnet__prompt_kernel_cw0
  ds_write_b128 v240, v[160:163] offset:0
  ds_write_b128 v240, v[164:167] offset:1024
  ds_write_b128 v240, v[168:171] offset:2048
concat_heads__mha_block__spectral_fnet__prompt_kernel_cw0:
  s_cmp_eq_u32 s25, 1
  s_cbranch_scc0 concat_heads__mha_block__spectral_fnet__prompt_kernel_cw1
  ds_write_b128 v240, v[172:175] offset:0
  ds_write_b128 v240, v[192:195] offset:1024
  ds_write_b128 v240, v[196:199] offset:2048
concat_heads__mha_block__spectral_fnet__prompt_kernel_cw1:
  s_cmp_eq_u32 s25, 2
  s_cbranch_scc0 concat_heads__mha_block__spectral_fnet__prompt_kernel_cw2
  ds_write_b128 v240, v[200:203] offset:0
  ds_write_b128 v240, v[204:207] offset:1024
  ds_write_b128 v240, v[208:211] offset:2048
concat_heads__mha_block__spectral_fnet__prompt_kernel_cw2:
  s_cmp_eq_u32 s25, 3
  s_cbranch_scc0 concat_heads__mha_block__spectral_fnet__prompt_kernel_cw3
  ds_write_b128 v240, v[212:215] offset:0
  ds_write_b128 v240, v[216:219] offset:1024
  ds_write_b128 v240, v[220:223] offset:2048
concat_heads__mha_block__spectral_fnet__prompt_kernel_cw3:
  s_waitcnt lgkmcnt(0)
  v_mfma_f32_32x32x16_bf16 v[64:79], v[44:47], v[36:39], v[64:79]
  ds_read_b128 v[16:19], v5 offset:0
  ds_read_b128 v[20:23], v5 offset:4096
  v_mfma_f32_32x32x16_bf16 v[112:127], v[44:47], v[40:43], v[112:127]
  ds_read_b64_tr_b16 v[24:25], v7 offset:4096
  ds_read_b64_tr_b16 v[26:27], v7 offset:4608
  v_mfma_f32_32x32x16_bf16 v[80:95], v[48:51], v[36:39], v[80:95]
  ds_read_b64_tr_b16 v[28:29], v7 offset:12288
  ds_read_b64_tr_b16 v[30:31], v7 offset:12800
  v_mfma_f32_32x32x16_bf16 v[128:143], v[48:51], v[40:43], v[128:143]
  ds_read_b64_tr_b16 v[32:33], v7 offset:20480
  ds_read_b64_tr_b16 v[34:35], v7 offset:20992
  v_mfma_f32_32x32x16_bf16 v[96:111], v[36:39], v[52:55], v[96:111]
  v_mfma_f32_32x32x16_bf16 v[144:159], v[40:43], v[52:55], v[144:159]
  s_waitcnt lgkmcnt(0)
  v_mfma_f32_32x32x16_bf16 v[64:79], v[24:27], v[16:19], v[64:79]
  ds_read_b128 v[36:39], v6 offset:0
  ds_read_b128 v[40:43], v6 offset:4096
  v_mfma_f32_32x32x16_bf16 v[112:127], v[24:27], v[20:23], v[112:127]
  ds_read_b64_tr_b16 v[44:45], v7 offset:6144
  ds_read_b64_tr_b16 v[46:47], v7 offset:6656
  v_mfma_f32_32x32x16_bf16 v[80:95], v[28:31], v[16:19], v[80:95]
  ds_read_b64_tr_b16 v[48:49], v7 offset:14336
  ds_read_b64_tr_b16 v[50:51], v7 offset:14848
  v_mfma_f32_32x32x16_bf16 v[128:143], v[28:31], v[20:23], v[128:143]
  ds_read_b64_tr_b16 v[52:53], v7 offset:22528
  ds_read_b64_tr_b16 v[54:55], v7 offset:23040
  v_mfma_f32_32x32x16_bf16 v[96:111], v[16:19], v[32:35], v[96:111]
  v_mfma_f32_32x32x16_bf16 v[144:159], v[20:23], v[32:35], v[144:159]
  s_waitcnt lgkmcnt(0)
  v_mfma_f32_32x32x16_bf16 v[64:79], v[44:47], v[36:39], v[64:79]
  v_mfma_f32_32x32x16_bf16 v[112:127], v[44:47], v[40:43], v[112:127]
  v_mfma_f32_32x32x16_bf16 v[80:95], v[48:51], v[36:39], v[80:95]
  v_mfma_f32_32x32x16_bf16 v[128:143], v[48:51], v[40:43], v[128:143]
  v_mfma_f32_32x32x16_bf16 v[96:111], v[36:39], v[52:55], v[96:111]
  v_mfma_f32_32x32x16_bf16 v[144:159], v[40:43], v[52:55], v[144:159]
  s_mov_b32 s12, s8
  s_mov_b32 s13, s9
  s_mov_b32 s14, 0x1000000
  s_mov_b32 s15, 0x00020000
  s_lshl_b32 s28, s23, 1
  s_add_u32 s28, s28, s27
  s_lshl_b32 s29, s22, 2
  s_lshl_b32 s30, s26, 1
  s_add_u32 s29, s29, s30
  s_lshl_b32 s28, s28, 6
  s_add_u32 s28, s28, s29
  s_lshl_b32 s30, s28, 11
  s_lshl_b32 s31, s28, 12
  s_add_u32 s31, s31, 0x400000
  v_lshlrev_b32 v8, 4, v0
  v_add_u32 v9, 4096, v8
  s_nop 7
  v_mul_f32 v64, 0x3e8293ee, v64
  v_mul_f32 v65, 0x3e8293ee, v65
  v_mul_f32 v66, 0x3e8293ee, v66
  v_mul_f32 v67, 0x3e8293ee, v67
  v_mul_f32 v68, 0x3e8293ee, v68
  v_mul_f32 v69, 0x3e8293ee, v69
  v_mul_f32 v70, 0x3e8293ee, v70
  v_mul_f32 v71, 0x3e8293ee, v71
  v_mul_f32 v72, 0x3e8293ee, v72
  v_mul_f32 v73, 0x3e8293ee, v73
  v_mul_f32 v74, 0x3e8293ee, v74
  v_mul_f32 v75, 0x3e8293ee, v75
  v_mul_f32 v76, 0x3e8293ee, v76
  v_mul_f32 v77, 0x3e8293ee, v77
  v_mul_f32 v78, 0x3e8293ee, v78
  v_mul_f32 v79, 0x3e8293ee, v79
  v_cvt_pk_bf16_f32 v16, v64, v65
  v_cvt_pk_bf16_f32 v17, v66, v67
  v_cvt_pk_bf16_f32 v18, v68, v69
  v_cvt_pk_bf16_f32 v19, v70, v71
  v_cvt_pk_bf16_f32 v20, v72, v73
  v_cvt_pk_bf16_f32 v21, v74, v75
  v_cvt_pk_bf16_f32 v22, v76, v77
  v_cvt_pk_bf16_f32 v23, v78, v79
  buffer_store_dwordx4 v[16:19], v8, s[12:15], s30 offen offset:0 sc1
  buffer_store_dwordx4 v[20:23], v8, s[12:15], s30 offen offset:1024 sc1
  v_mul_f32 v112, 0x3e8293ee, v112
  v_mul_f32 v113, 0x3e8293ee, v113
  v_mul_f32 v114, 0x3e8293ee, v114
  v_mul_f32 v115, 0x3e8293ee, v115
  v_mul_f32 v116, 0x3e8293ee, v116
  v_mul_f32 v117, 0x3e8293ee, v117
  v_mul_f32 v118, 0x3e8293ee, v118
  v_mul_f32 v119, 0x3e8293ee, v119
  v_mul_f32 v120, 0x3e8293ee, v120
  v_mul_f32 v121, 0x3e8293ee, v121
  v_mul_f32 v122, 0x3e8293ee, v122
  v_mul_f32 v123, 0x3e8293ee, v123
  v_mul_f32 v124, 0x3e8293ee, v124
  v_mul_f32 v125, 0x3e8293ee, v125
  v_mul_f32 v126, 0x3e8293ee, v126
  v_mul_f32 v127, 0x3e8293ee, v127
  v_cvt_pk_bf16_f32 v24, v112, v113
  v_cvt_pk_bf16_f32 v25, v114, v115
  v_cvt_pk_bf16_f32 v26, v116, v117
  v_cvt_pk_bf16_f32 v27, v118, v119
  v_cvt_pk_bf16_f32 v28, v120, v121
  v_cvt_pk_bf16_f32 v29, v122, v123
  v_cvt_pk_bf16_f32 v30, v124, v125
  v_cvt_pk_bf16_f32 v31, v126, v127
  buffer_store_dwordx4 v[24:27], v8, s[12:15], s30 offen offset:2048 sc1
  buffer_store_dwordx4 v[28:31], v8, s[12:15], s30 offen offset:3072 sc1
  v_cvt_pk_bf16_f32 v32, v80, v81
  v_cvt_pk_bf16_f32 v33, v82, v83
  v_cvt_pk_bf16_f32 v34, v84, v85
  v_cvt_pk_bf16_f32 v35, v86, v87
  v_cvt_pk_bf16_f32 v36, v88, v89
  v_cvt_pk_bf16_f32 v37, v90, v91
  v_cvt_pk_bf16_f32 v38, v92, v93
  v_cvt_pk_bf16_f32 v39, v94, v95
  buffer_store_dwordx4 v[32:35], v8, s[12:15], s31 offen offset:0 sc1
  buffer_store_dwordx4 v[36:39], v8, s[12:15], s31 offen offset:1024 sc1
  v_cvt_pk_bf16_f32 v16, v128, v129
  v_cvt_pk_bf16_f32 v17, v130, v131
  v_cvt_pk_bf16_f32 v18, v132, v133
  v_cvt_pk_bf16_f32 v19, v134, v135
  v_cvt_pk_bf16_f32 v20, v136, v137
  v_cvt_pk_bf16_f32 v21, v138, v139
  v_cvt_pk_bf16_f32 v22, v140, v141
  v_cvt_pk_bf16_f32 v23, v142, v143
  buffer_store_dwordx4 v[16:19], v9, s[12:15], s31 offen offset:0 sc1
  buffer_store_dwordx4 v[20:23], v9, s[12:15], s31 offen offset:1024 sc1
  v_cvt_pk_bf16_f32 v24, v96, v97
  v_cvt_pk_bf16_f32 v25, v98, v99
  v_cvt_pk_bf16_f32 v26, v100, v101
  v_cvt_pk_bf16_f32 v27, v102, v103
  v_cvt_pk_bf16_f32 v28, v104, v105
  v_cvt_pk_bf16_f32 v29, v106, v107
  v_cvt_pk_bf16_f32 v30, v108, v109
  v_cvt_pk_bf16_f32 v31, v110, v111
  buffer_store_dwordx4 v[24:27], v8, s[12:15], s31 offen offset:2048 sc1
  buffer_store_dwordx4 v[28:31], v8, s[12:15], s31 offen offset:3072 sc1
  v_cvt_pk_bf16_f32 v32, v144, v145
  v_cvt_pk_bf16_f32 v33, v146, v147
  v_cvt_pk_bf16_f32 v34, v148, v149
  v_cvt_pk_bf16_f32 v35, v150, v151
  v_cvt_pk_bf16_f32 v36, v152, v153
  v_cvt_pk_bf16_f32 v37, v154, v155
  v_cvt_pk_bf16_f32 v38, v156, v157
  v_cvt_pk_bf16_f32 v39, v158, v159
  buffer_store_dwordx4 v[32:35], v9, s[12:15], s31 offen offset:2048 sc1
  buffer_store_dwordx4 v[36:39], v9, s[12:15], s31 offen offset:3072 sc1
  s_lshl_b32 s28, s23, 1
  s_add_u32 s28, s28, s27
  s_lshl_b32 s28, s28, 5
  s_lshl_b32 s29, s22, 1
  s_add_u32 s28, s28, s29
  s_add_u32 s28, s28, s26
  s_lshl_b32 s28, s28, 2
  s_add_u32 s90, s28, 0x1000
  v_mov_b32 v240, s89
  s_waitcnt vmcnt(0)
  s_mov_b64 exec, 1
  buffer_store_dword v240, off, s[92:95], s90 sc1
  s_mov_b64 exec, -1
  s_waitcnt lgkmcnt(0)
  s_barrier
  ds_read_b64_tr_b16 v[16:17], v243 offset:0
  ds_read_b64_tr_b16 v[18:19], v243 offset:16384
  ds_read_b64_tr_b16 v[20:21], v243 offset:32768
  ds_read_b64_tr_b16 v[22:23], v243 offset:49152
  ds_read_b64_tr_b16 v[24:25], v244 offset:0
  ds_read_b64_tr_b16 v[26:27], v244 offset:16384
  ds_read_b64_tr_b16 v[28:29], v244 offset:32768
  ds_read_b64_tr_b16 v[30:31], v244 offset:49152
  s_waitcnt lgkmcnt(0)
  s_barrier
  v_mfma_f32_32x32x16_bf16 v[32:47], v[16:19], v[160:163], 0
  v_mfma_f32_32x32x16_bf16 v[48:63], v[16:19], v[168:171], 0
  v_mfma_f32_32x32x16_bf16 v[32:47], v[20:23], v[164:167], v[32:47]
  v_mfma_f32_32x32x16_bf16 v[48:63], v[20:23], v[172:175], v[48:63]
  v_mfma_f32_32x32x16_bf16 v[32:47], v[24:27], v[176:179], v[32:47]
  v_mfma_f32_32x32x16_bf16 v[48:63], v[24:27], v[160:163], v[48:63]
  v_mfma_f32_32x32x16_bf16 v[32:47], v[28:31], v[180:183], v[32:47]
  v_mfma_f32_32x32x16_bf16 v[48:63], v[28:31], v[164:167], v[48:63]
  s_nop 15
  v_pk_mul_f32 v[16:17], v[48:49], v[208:209]
  v_pk_mul_f32 v[208:209], v[32:33], v[208:209]
  v_pk_fma_f32 v[32:33], v[32:33], v[192:193], v[16:17] neg_lo:[0,0,1] neg_hi:[0,0,1]
  v_pk_fma_f32 v[48:49], v[48:49], v[192:193], v[208:209]
  v_pk_mul_f32 v[18:19], v[50:51], v[210:211]
  v_pk_mul_f32 v[210:211], v[34:35], v[210:211]
  v_pk_fma_f32 v[34:35], v[34:35], v[194:195], v[18:19] neg_lo:[0,0,1] neg_hi:[0,0,1]
  v_pk_fma_f32 v[50:51], v[50:51], v[194:195], v[210:211]
  v_pk_mul_f32 v[16:17], v[52:53], v[212:213]
  v_pk_mul_f32 v[212:213], v[36:37], v[212:213]
  v_pk_fma_f32 v[36:37], v[36:37], v[196:197], v[16:17] neg_lo:[0,0,1] neg_hi:[0,0,1]
  v_pk_fma_f32 v[52:53], v[52:53], v[196:197], v[212:213]
  v_pk_mul_f32 v[18:19], v[54:55], v[214:215]
  v_pk_mul_f32 v[214:215], v[38:39], v[214:215]
  v_pk_fma_f32 v[38:39], v[38:39], v[198:199], v[18:19] neg_lo:[0,0,1] neg_hi:[0,0,1]
  v_pk_fma_f32 v[54:55], v[54:55], v[198:199], v[214:215]
  v_pk_mul_f32 v[16:17], v[56:57], v[216:217]
  v_pk_mul_f32 v[216:217], v[40:41], v[216:217]
  v_pk_fma_f32 v[40:41], v[40:41], v[200:201], v[16:17] neg_lo:[0,0,1] neg_hi:[0,0,1]
  v_pk_fma_f32 v[56:57], v[56:57], v[200:201], v[216:217]
  v_pk_mul_f32 v[18:19], v[58:59], v[218:219]
  v_pk_mul_f32 v[218:219], v[42:43], v[218:219]
  v_pk_fma_f32 v[42:43], v[42:43], v[202:203], v[18:19] neg_lo:[0,0,1] neg_hi:[0,0,1]
  v_pk_fma_f32 v[58:59], v[58:59], v[202:203], v[218:219]
  v_pk_mul_f32 v[16:17], v[60:61], v[220:221]
  v_pk_mul_f32 v[220:221], v[44:45], v[220:221]
  v_pk_fma_f32 v[44:45], v[44:45], v[204:205], v[16:17] neg_lo:[0,0,1] neg_hi:[0,0,1]
  v_pk_fma_f32 v[60:61], v[60:61], v[204:205], v[220:221]
  v_pk_mul_f32 v[18:19], v[62:63], v[222:223]
  v_pk_mul_f32 v[222:223], v[46:47], v[222:223]
  v_pk_fma_f32 v[46:47], v[46:47], v[206:207], v[18:19] neg_lo:[0,0,1] neg_hi:[0,0,1]
  v_pk_fma_f32 v[62:63], v[62:63], v[206:207], v[222:223]
  v_cvt_pk_bf16_f32 v64, v32, v33
  v_cvt_pk_bf16_f32 v72, v48, v49
  v_cvt_pk_bf16_f32 v65, v34, v35
  v_cvt_pk_bf16_f32 v73, v50, v51
  v_cvt_pk_bf16_f32 v66, v36, v37
  v_cvt_pk_bf16_f32 v74, v52, v53
  v_cvt_pk_bf16_f32 v67, v38, v39
  v_cvt_pk_bf16_f32 v75, v54, v55
  v_cvt_pk_bf16_f32 v68, v40, v41
  v_cvt_pk_bf16_f32 v76, v56, v57
  v_cvt_pk_bf16_f32 v69, v42, v43
  v_cvt_pk_bf16_f32 v77, v58, v59
  v_cvt_pk_bf16_f32 v70, v44, v45
  v_cvt_pk_bf16_f32 v78, v60, v61
  v_cvt_pk_bf16_f32 v71, v46, v47
  v_cvt_pk_bf16_f32 v79, v62, v63
  s_nop 1
  v_mfma_f32_32x32x16_bf16 v[32:47], v[64:67], v[160:163], 0
  v_mfma_f32_32x32x16_bf16 v[48:63], v[64:67], v[176:179], 0
  v_mfma_f32_32x32x16_bf16 v[32:47], v[68:71], v[164:167], v[32:47]
  v_mfma_f32_32x32x16_bf16 v[48:63], v[68:71], v[180:183], v[48:63]
  v_mfma_f32_32x32x16_bf16 v[32:47], v[72:75], v[176:179], v[32:47]
  v_mfma_f32_32x32x16_bf16 v[48:63], v[72:75], v[184:187], v[48:63]
  v_mfma_f32_32x32x16_bf16 v[32:47], v[76:79], v[180:183], v[32:47]
  v_mfma_f32_32x32x16_bf16 v[48:63], v[76:79], v[188:191], v[48:63]
  s_nop 15
  v_cvt_pk_bf16_f32 v224, v32, v33
  v_cvt_pk_bf16_f32 v225, v34, v35
  v_cvt_pk_bf16_f32 v226, v36, v37
  v_cvt_pk_bf16_f32 v227, v38, v39
  v_cvt_pk_bf16_f32 v228, v40, v41
  v_cvt_pk_bf16_f32 v229, v42, v43
  v_cvt_pk_bf16_f32 v230, v44, v45
  v_cvt_pk_bf16_f32 v231, v46, v47
  v_cvt_pk_bf16_f32 v232, v48, v49
  v_cvt_pk_bf16_f32 v233, v50, v51
  v_cvt_pk_bf16_f32 v234, v52, v53
  v_cvt_pk_bf16_f32 v235, v54, v55
  v_cvt_pk_bf16_f32 v236, v56, v57
  v_cvt_pk_bf16_f32 v237, v58, v59
  v_cvt_pk_bf16_f32 v238, v60, v61
  v_cvt_pk_bf16_f32 v239, v62, v63
  s_mov_b32 s22, s25
  s_and_b32 s44, s2, 7
  s_bfe_u32 s45, s2, 0x20003
  s_lshr_b32 s21, s2, 5
  s_lshl_b32 s20, s44, 2
  s_add_u32 s20, s20, s45
  v_lshlrev_b32 v5, 4, v0
  s_lshl_b32 s23, s21, 3
  s_add_u32 s23, s23, s22
  s_lshl_b32 s24, s20, 6
  s_add_u32 s24, s24, s23
  s_lshl_b32 s24, s24, 11
  s_lshl_b32 s25, s20, 18
  s_add_u32 s25, s25, 0x400000
  s_and_b32 s46, s22, 3
  s_lshr_b32 s52, s22, 2
  s_lshl_b32 s26, s46, 12
  v_add_u32 v4, s26, v5
  s_mov_b32 s12, s8
  s_mov_b32 s13, s9
  s_mov_b32 s14, 0x1000000
  s_mov_b32 s15, 0x00020000
  s_mov_b32 s16, s48
  s_mov_b32 s17, s49
  s_mov_b32 s18, 0x200000
  s_mov_b32 s19, 0x00020000
  s_add_u32 s56, s8, 0x1000000
  s_addc_u32 s57, s9, 0
  s_mov_b32 s58, 0x800000
  s_mov_b32 s59, 0x00020000
  v_lshrrev_b32 v6, 4, v0
  v_lshlrev_b32 v7, 2, v6
  v_and_b32 v1, 15, v0
  v_xor_b32 v1, v1, v7
  v_lshlrev_b32 v1, 4, v1
  v_lshlrev_b32 v6, 11, v6
  v_add_u32 v1, v1, v6
  s_lshr_b32 s28, s46, 1
  s_lshl_b32 s28, s28, 20
  s_and_b32 s29, s46, 1
  s_lshl_b32 s29, s29, 15
  s_add_u32 s28, s28, s29
  s_lshl_b32 s29, s21, 8
  s_add_u32 s28, s28, s29
  v_add_u32 v1, s28, v1
  s_add_u32 s47, s26, 65536
  v_bfe_u32 v6, v0, 2, 2
  v_lshrrev_b32 v7, 5, v0
  v_lshlrev_b32 v7, 2, v7
  v_add_u32 v7, v7, v6
  v_lshlrev_b32 v2, 8, v7
  v_xor_b32 v6, s46, v6
  v_lshlrev_b32 v6, 6, v6
  v_add_u32 v2, v2, v6
  v_bfe_u32 v6, v0, 4, 1
  v_lshlrev_b32 v6, 5, v6
  v_add_u32 v2, v2, v6
  v_and_b32 v6, 1, v0
  v_lshlrev_b32 v6, 4, v6
  v_add_u32 v2, v2, v6
  v_bfe_u32 v6, v0, 1, 1
  v_lshlrev_b32 v6, 3, v6
  v_add_u32 v2, v2, v6
  s_lshl_b32 s28, s52, 13
  s_add_u32 s28, s28, 65536
  v_add_u32 v2, s28, v2
  s_lshl_b32 s48, s45, 3
  s_add_u32 s48, s48, s44
  v_lshrrev_b32 v6, 4, v0
  v_and_b32 v7, 15, v0
  v_lshlrev_b32 v3, 1, v6
  v_xor_b32 v7, v7, v3
  v_lshrrev_b32 v3, 3, v7
  v_lshlrev_b32 v3, 10, v3
  v_and_b32 v7, 7, v7
  v_lshlrev_b32 v7, 4, v7
  v_add_u32 v7, v7, v3
  v_lshlrev_b32 v6, 11, v6
  v_add_u32 v6, v6, v7
  s_lshl_b32 s28, s48, 18
  s_lshl_b32 s29, s46, 16
  s_add_u32 s28, s28, s29
  s_lshl_b32 s29, s21, 7
  s_add_u32 s28, s28, s29
  v_add_u32 v3, s28, v6
  s_lshl_b32 s49, s46, 13
  s_add_u32 s49, s49, 131072
  v_and_b32 v6, 7, v0
  v_bfe_u32 v7, v0, 4, 1
  v_lshlrev_b32 v7, 2, v7
  v_cmp_eq_u32 vcc, v6, v7
  v_mov_b32 v6, 0x3f803f80
  s_nop 1
  v_cndmask_b32 v92, 0, v6, vcc
  v_cndmask_b32 v93, 0, v6, vcc
  v_cndmask_b32 v94, 0, v6, vcc
  v_cndmask_b32 v95, 0, v6, vcc
  s_mov_b32 s27, 0
concat_heads__mha_block__spectral_fnet__prompt_kernel_p2in:
  s_cmp_ge_u32 s22, 4
  s_cbranch_scc1 concat_heads__mha_block__spectral_fnet__prompt_kernel_pro_y
  s_barrier
  buffer_load_dwordx4 v[8:11], v5, s[12:15], s24 offen sc1
  buffer_load_dwordx4 v[12:15], v5, s[12:15], s24 offen offset:1024 sc1
  s_add_u32 s28, s25, 0
  s_add_u32 m0, s26, 0
  s_nop 0
  buffer_load_dwordx4 v4, s[12:15], s28 offen offset:0 sc1 lds
  buffer_load_dwordx4 v4, s[12:15], s28 offen offset:1024 sc1 lds
  buffer_load_dwordx4 v4, s[12:15], s28 offen offset:2048 sc1 lds
  buffer_load_dwordx4 v4, s[12:15], s28 offen offset:3072 sc1 lds
  s_add_u32 s28, s25, 16384
  s_add_u32 m0, s26, 16384
  s_nop 0
  buffer_load_dwordx4 v4, s[12:15], s28 offen offset:0 sc1 lds
  buffer_load_dwordx4 v4, s[12:15], s28 offen offset:1024 sc1 lds
  buffer_load_dwordx4 v4, s[12:15], s28 offen offset:2048 sc1 lds
  buffer_load_dwordx4 v4, s[12:15], s28 offen offset:3072 sc1 lds
  s_waitcnt vmcnt(4)
  s_branch concat_heads__mha_block__spectral_fnet__prompt_kernel_pro_j
concat_heads__mha_block__spectral_fnet__prompt_kernel_pro_y:
  s_cmp_lg_u32 s22, 4
  s_cbranch_scc1 concat_heads__mha_block__spectral_fnet__prompt_kernel_polled
  v_and_b32 v6, 31, v0
  v_lshlrev_b32 v6, 2, v6
  s_lshl_b32 s28, s20, 7
  s_add_u32 s28, s28, 0x1000
  s_mov_b32 s34, 0
concat_heads__mha_block__spectral_fnet__prompt_kernel_qpoll:
  buffer_load_dword v7, v6, s[92:95], s28 offen sc1
  s_waitcnt vmcnt(0)
  v_cmp_ne_u32 vcc, s89, v7
  s_add_u32 s34, s34, 1
  s_nop 2
  s_cmp_eq_u64 vcc, 0
  s_cbranch_scc1 concat_heads__mha_block__spectral_fnet__prompt_kernel_polled
  s_cmp_lt_u32 s34, 0x20000
  s_cbranch_scc1 concat_heads__mha_block__spectral_fnet__prompt_kernel_qpoll
concat_heads__mha_block__spectral_fnet__prompt_kernel_polled:
  s_barrier
  buffer_load_dwordx4 v[8:11], v5, s[12:15], s24 offen sc1
  buffer_load_dwordx4 v[12:15], v5, s[12:15], s24 offen offset:1024 sc1
  s_add_u32 m0, s47, 0
  s_mov_b32 s28, 0
  buffer_load_dwordx4 v1, s[16:19], s28 offen lds
  s_add_u32 m0, s47, 1024
  s_mov_b32 s28, 8192
  buffer_load_dwordx4 v1, s[16:19], s28 offen lds
  s_add_u32 m0, s47, 2048
  s_mov_b32 s28, 16384
  buffer_load_dwordx4 v1, s[16:19], s28 offen lds
  s_add_u32 m0, s47, 3072
  s_mov_b32 s28, 24576
  buffer_load_dwordx4 v1, s[16:19], s28 offen lds
  s_add_u32 s28, s25, 32768
  s_add_u32 m0, s26, 32768
  s_nop 0
  buffer_load_dwordx4 v4, s[12:15], s28 offen offset:0 sc1 lds
  buffer_load_dwordx4 v4, s[12:15], s28 offen offset:1024 sc1 lds
  buffer_load_dwordx4 v4, s[12:15], s28 offen offset:2048 sc1 lds
  buffer_load_dwordx4 v4, s[12:15], s28 offen offset:3072 sc1 lds
  s_add_u32 m0, s47, 16384
  s_mov_b32 s28, 65536
  buffer_load_dwordx4 v1, s[16:19], s28 offen lds
  s_add_u32 m0, s47, 17408
  s_mov_b32 s28, 73728
  buffer_load_dwordx4 v1, s[16:19], s28 offen lds
  s_add_u32 m0, s47, 18432
  s_mov_b32 s28, 81920
  buffer_load_dwordx4 v1, s[16:19], s28 offen lds
  s_add_u32 m0, s47, 19456
  s_mov_b32 s28, 90112
  buffer_load_dwordx4 v1, s[16:19], s28 offen lds
  s_waitcnt vmcnt(12)
  s_branch concat_heads__mha_block__spectral_fnet__prompt_kernel_pro_j
concat_heads__mha_block__spectral_fnet__prompt_kernel_start:
  s_cmp_ge_u32 s22, 4
  s_cbranch_scc1 concat_heads__mha_block__spectral_fnet__prompt_kernel_rp_y
  s_add_u32 s28, s25, 0
  s_add_u32 m0, s26, 0
  s_nop 0
  buffer_load_dwordx4 v4, s[12:15], s28 offen offset:0 sc1 lds
  buffer_load_dwordx4 v4, s[12:15], s28 offen offset:1024 sc1 lds
  buffer_load_dwordx4 v4, s[12:15], s28 offen offset:2048 sc1 lds
  buffer_load_dwordx4 v4, s[12:15], s28 offen offset:3072 sc1 lds
  s_add_u32 s28, s25, 16384
  s_add_u32 m0, s26, 16384
  s_nop 0
  buffer_load_dwordx4 v4, s[12:15], s28 offen offset:0 sc1 lds
  buffer_load_dwordx4 v4, s[12:15], s28 offen offset:1024 sc1 lds
  buffer_load_dwordx4 v4, s[12:15], s28 offen offset:2048 sc1 lds
  buffer_load_dwordx4 v4, s[12:15], s28 offen offset:3072 sc1 lds
  s_branch concat_heads__mha_block__spectral_fnet__prompt_kernel_rp_j
concat_heads__mha_block__spectral_fnet__prompt_kernel_rp_y:
  s_add_u32 m0, s47, 0
  s_mov_b32 s28, 0
  buffer_load_dwordx4 v1, s[16:19], s28 offen lds
  s_add_u32 m0, s47, 1024
  s_mov_b32 s28, 8192
  buffer_load_dwordx4 v1, s[16:19], s28 offen lds
  s_add_u32 m0, s47, 2048
  s_mov_b32 s28, 16384
  buffer_load_dwordx4 v1, s[16:19], s28 offen lds
  s_add_u32 m0, s47, 3072
  s_mov_b32 s28, 24576
  buffer_load_dwordx4 v1, s[16:19], s28 offen lds
  s_add_u32 m0, s47, 16384
  s_mov_b32 s28, 65536
  buffer_load_dwordx4 v1, s[16:19], s28 offen lds
  s_add_u32 m0, s47, 17408
  s_mov_b32 s28, 73728
  buffer_load_dwordx4 v1, s[16:19], s28 offen lds
  s_add_u32 m0, s47, 18432
  s_mov_b32 s28, 81920
  buffer_load_dwordx4 v1, s[16:19], s28 offen lds
  s_add_u32 m0, s47, 19456
  s_mov_b32 s28, 90112
  buffer_load_dwordx4 v1, s[16:19], s28 offen lds
  s_add_u32 s28, s25, 32768
  s_add_u32 m0, s26, 32768
  s_nop 0
  buffer_load_dwordx4 v4, s[12:15], s28 offen offset:0 sc1 lds
  buffer_load_dwordx4 v4, s[12:15], s28 offen offset:1024 sc1 lds
  buffer_load_dwordx4 v4, s[12:15], s28 offen offset:2048 sc1 lds
  buffer_load_dwordx4 v4, s[12:15], s28 offen offset:3072 sc1 lds
concat_heads__mha_block__spectral_fnet__prompt_kernel_rp_j:
  s_waitcnt vmcnt(0)
concat_heads__mha_block__spectral_fnet__prompt_kernel_pro_j:
  s_barrier
  ds_read_b128 v[96:99], v5
  ds_read_b128 v[100:103], v5 offset:1024
  ds_read_b128 v[104:107], v5 offset:4096
  ds_read_b128 v[108:111], v5 offset:5120
  ds_read_b128 v[112:115], v5 offset:2048
  ds_read_b128 v[116:119], v5 offset:3072
  s_waitcnt lgkmcnt(0)
  s_cmp_lg_u32 s27, 0
  s_cbranch_scc1 concat_heads__mha_block__spectral_fnet__prompt_kernel_havem
  v_mfma_f32_32x32x16_bf16 v[32:47], v[96:99], v[8:11], 0
  v_mfma_f32_32x32x16_bf16 v[32:47], v[100:103], v[12:15], v[32:47]
  v_mfma_f32_32x32x16_bf16 v[48:63], v[104:107], v[8:11], 0
  v_mfma_f32_32x32x16_bf16 v[48:63], v[108:111], v[12:15], v[48:63]
  s_nop 15
  v_max3_f32 v6, v32, v33, v34
  v_max3_f32 v6, v6, v35, v36
  v_max3_f32 v6, v6, v37, v38
  v_max3_f32 v6, v6, v39, v40
  v_max3_f32 v6, v6, v41, v42
  v_max3_f32 v6, v6, v43, v44
  v_max3_f32 v6, v6, v45, v46
  v_max3_f32 v6, v6, v47, v48
  v_max3_f32 v6, v6, v49, v50
  v_max3_f32 v6, v6, v51, v52
  v_max3_f32 v6, v6, v53, v54
  v_max3_f32 v6, v6, v55, v56
  v_max3_f32 v6, v6, v57, v58
  v_max3_f32 v6, v6, v59, v60
  v_max3_f32 v6, v6, v61, v62
  v_max_f32 v6, v6, v63
  v_mov_b32 v7, v6
  s_nop 1
  v_permlane32_swap_b32 v6, v7
  s_nop 1
  v_max_f32 v6, v6, v7
  v_add_f32 v6, 0x42a00000, v6
  v_sub_f32 v16, 0, v6
  v_sub_f32 v17, 0, v6
  v_sub_f32 v18, 0, v6
  v_sub_f32 v19, 0, v6
  v_sub_f32 v20, 0, v6
  v_sub_f32 v21, 0, v6
  v_sub_f32 v22, 0, v6
  v_sub_f32 v23, 0, v6
  v_sub_f32 v24, 0, v6
  v_sub_f32 v25, 0, v6
  v_sub_f32 v26, 0, v6
  v_sub_f32 v27, 0, v6
  v_sub_f32 v28, 0, v6
  v_sub_f32 v29, 0, v6
  v_sub_f32 v30, 0, v6
  v_sub_f32 v31, 0, v6
concat_heads__mha_block__spectral_fnet__prompt_kernel_havem:
  v_mov_b32 v64, 0
  v_mov_b32 v65, 0
  v_mov_b32 v66, 0
  v_mov_b32 v67, 0
  v_mov_b32 v68, 0
  v_mov_b32 v69, 0
  v_mov_b32 v70, 0
  v_mov_b32 v71, 0
  v_mov_b32 v72, 0
  v_mov_b32 v73, 0
  v_mov_b32 v74, 0
  v_mov_b32 v75, 0
  v_mov_b32 v76, 0
  v_mov_b32 v77, 0
  v_mov_b32 v78, 0
  v_mov_b32 v79, 0
  v_mov_b32 v88, 0
  v_mov_b32 v89, 0
  v_mov_b32 v90, 0
  v_mov_b32 v91, 0
  v_mov_b32 v84, 0
  v_mov_b32 v85, 0
  v_mov_b32 v86, 0
  v_mov_b32 v87, 0
  v_mov_b32 v124, 0
  v_mov_b32 v125, 0
  v_mov_b32 v126, 0
  v_mov_b32 v127, 0
  s_nop 1
  v_mfma_f32_32x32x16_bf16 v[32:47], v[96:99], v[8:11], v[16:31]
  v_mfma_f32_32x32x16_bf16 v[32:47], v[100:103], v[12:15], v[32:47]
  v_lshrrev_b32 v6, 3, v0
  v_lshlrev_b32 v6, 17, v6
  v_lshrrev_b32 v7, 4, v0
  v_xor_b32 v7, v7, v0
  v_and_b32 v7, 7, v7
  v_lshlrev_b32 v7, 4, v7
  v_add_u32 v6, v6, v7
  s_lshr_b32 s28, s46, 1
  s_lshl_b32 s28, s28, 22
  s_lshl_b32 s29, s48, 12
  s_add_u32 s28, s28, s29
  v_add_u32 v6, s28, v6
  s_and_b32 s28, s46, 1
  s_cmp_eq_u32 s28, 0
  s_cselect_b32 s84, s40, s42
  s_cselect_b32 s85, s41, s43
  s_mov_b32 s86, 0x800000
  s_mov_b32 s87, 0x00020000
  s_add_u32 s55, s26, 114688
  s_cmp_ge_u32 s22, 4
  s_cbranch_scc1 concat_heads__mha_block__spectral_fnet__prompt_kernel_loop_y
.p2align 6
concat_heads__mha_block__spectral_fnet__prompt_kernel_loop_o:
  s_waitcnt lgkmcnt(0)
  v_exp_f32 v32, v32
  v_mfma_f32_32x32x16_bf16 v[64:79], v[124:127], v[84:87], v[64:79]
  v_exp_f32 v33, v33
  v_exp_f32 v34, v34
  v_exp_f32 v35, v35
  v_mfma_f32_32x32x16_bf16 v[48:63], v[104:107], v[8:11], v[16:31]
  ds_read_b128 v[120:123], v5 offset:6144
  v_cvt_pk_bf16_f32 v80, v32, v33
  v_exp_f32 v36, v36
  v_exp_f32 v37, v37
  v_cvt_pk_bf16_f32 v81, v34, v35
  v_mfma_f32_16x16x32_bf16 v[88:91], v[92:95], v[84:87], v[88:91]
  ds_read_b128 v[124:127], v5 offset:7168
  v_exp_f32 v38, v38
  v_exp_f32 v39, v39
  v_mfma_f32_32x32x16_bf16 v[48:63], v[108:111], v[12:15], v[48:63]
  ds_read_b128 v[96:99], v5 offset:8192
  v_cvt_pk_bf16_f32 v82, v36, v37
  v_exp_f32 v40, v40
  v_cvt_pk_bf16_f32 v83, v38, v39
  v_exp_f32 v41, v41
  ds_read_b128 v[100:103], v5 offset:9216
  v_mfma_f32_32x32x16_bf16 v[64:79], v[112:115], v[80:83], v[64:79]
  v_exp_f32 v42, v42
  v_exp_f32 v43, v43
  v_cvt_pk_bf16_f32 v84, v40, v41
  v_exp_f32 v44, v44
  v_mfma_f32_16x16x32_bf16 v[88:91], v[92:95], v[80:83], v[88:91]
  v_exp_f32 v45, v45
  v_cvt_pk_bf16_f32 v85, v42, v43
  v_exp_f32 v46, v46
  v_exp_f32 v47, v47
  v_cvt_pk_bf16_f32 v86, v44, v45
  v_cvt_pk_bf16_f32 v87, v46, v47
  s_waitcnt lgkmcnt(0)
  v_exp_f32 v48, v48
  v_mfma_f32_32x32x16_bf16 v[64:79], v[116:119], v[84:87], v[64:79]
  v_exp_f32 v49, v49
  v_exp_f32 v50, v50
  v_exp_f32 v51, v51
  v_mfma_f32_32x32x16_bf16 v[32:47], v[96:99], v[8:11], v[16:31]
  ds_read_b128 v[112:115], v5 offset:10240
  v_cvt_pk_bf16_f32 v80, v48, v49
  v_exp_f32 v52, v52
  v_exp_f32 v53, v53
  v_cvt_pk_bf16_f32 v81, v50, v51
  v_mfma_f32_16x16x32_bf16 v[88:91], v[92:95], v[84:87], v[88:91]
  ds_read_b128 v[116:119], v5 offset:11264
  v_exp_f32 v54, v54
  v_exp_f32 v55, v55
  v_mfma_f32_32x32x16_bf16 v[32:47], v[100:103], v[12:15], v[32:47]
  ds_read_b128 v[104:107], v5 offset:12288
  v_cvt_pk_bf16_f32 v82, v52, v53
  v_exp_f32 v56, v56
  v_cvt_pk_bf16_f32 v83, v54, v55
  v_exp_f32 v57, v57
  ds_read_b128 v[108:111], v5 offset:13312
  v_mfma_f32_32x32x16_bf16 v[64:79], v[120:123], v[80:83], v[64:79]
  v_exp_f32 v58, v58
  v_exp_f32 v59, v59
  v_cvt_pk_bf16_f32 v84, v56, v57
  v_exp_f32 v60, v60
  v_mfma_f32_16x16x32_bf16 v[88:91], v[92:95], v[80:83], v[88:91]
  v_exp_f32 v61, v61
  v_cvt_pk_bf16_f32 v85, v58, v59
  v_exp_f32 v62, v62
  v_exp_f32 v63, v63
  v_cvt_pk_bf16_f32 v86, v60, v61
  v_cvt_pk_bf16_f32 v87, v62, v63
  s_waitcnt lgkmcnt(0)
  s_waitcnt vmcnt(0)
  s_barrier
  s_add_u32 s28, s25, 49152
  s_add_u32 m0, s26, 49152
  s_nop 0
  buffer_load_dwordx4 v4, s[12:15], s28 offen offset:0 sc1 lds
  buffer_load_dwordx4 v4, s[12:15], s28 offen offset:1024 sc1 lds
  buffer_load_dwordx4 v4, s[12:15], s28 offen offset:2048 sc1 lds
  buffer_load_dwordx4 v4, s[12:15], s28 offen offset:3072 sc1 lds
  s_add_u32 m0, s47, 32768
  s_mov_b32 s28, 131072
  buffer_load_dwordx4 v1, s[16:19], s28 offen lds
  s_add_u32 m0, s47, 33792
  s_mov_b32 s28, 139264
  buffer_load_dwordx4 v1, s[16:19], s28 offen lds
  s_add_u32 m0, s47, 34816
  s_mov_b32 s28, 147456
  buffer_load_dwordx4 v1, s[16:19], s28 offen lds
  s_add_u32 m0, s47, 35840
  s_mov_b32 s28, 155648
  buffer_load_dwordx4 v1, s[16:19], s28 offen lds
  v_exp_f32 v32, v32
  v_mfma_f32_32x32x16_bf16 v[64:79], v[124:127], v[84:87], v[64:79]
  v_exp_f32 v33, v33
  v_exp_f32 v34, v34
  v_exp_f32 v35, v35
  v_mfma_f32_32x32x16_bf16 v[48:63], v[104:107], v[8:11], v[16:31]
  ds_read_b128 v[120:123], v5 offset:14336
  v_cvt_pk_bf16_f32 v80, v32, v33
  v_exp_f32 v36, v36
  v_exp_f32 v37, v37
  v_cvt_pk_bf16_f32 v81, v34, v35
  v_mfma_f32_16x16x32_bf16 v[88:91], v[92:95], v[84:87], v[88:91]
  ds_read_b128 v[124:127], v5 offset:15360
  v_exp_f32 v38, v38
  v_exp_f32 v39, v39
  v_mfma_f32_32x32x16_bf16 v[48:63], v[108:111], v[12:15], v[48:63]
  ds_read_b128 v[96:99], v5 offset:16384
  v_cvt_pk_bf16_f32 v82, v36, v37
  v_exp_f32 v40, v40
  v_cvt_pk_bf16_f32 v83, v38, v39
  v_exp_f32 v41, v41
  ds_read_b128 v[100:103], v5 offset:17408
  v_mfma_f32_32x32x16_bf16 v[64:79], v[112:115], v[80:83], v[64:79]
  v_exp_f32 v42, v42
  v_exp_f32 v43, v43
  v_cvt_pk_bf16_f32 v84, v40, v41
  v_exp_f32 v44, v44
  v_mfma_f32_16x16x32_bf16 v[88:91], v[92:95], v[80:83], v[88:91]
  v_exp_f32 v45, v45
  v_cvt_pk_bf16_f32 v85, v42, v43
  v_exp_f32 v46, v46
  v_exp_f32 v47, v47
  v_cvt_pk_bf16_f32 v86, v44, v45
  v_cvt_pk_bf16_f32 v87, v46, v47
  s_waitcnt lgkmcnt(0)
  v_exp_f32 v48, v48
  v_mfma_f32_32x32x16_bf16 v[64:79], v[116:119], v[84:87], v[64:79]
  v_exp_f32 v49, v49
  v_exp_f32 v50, v50
  v_exp_f32 v51, v51
  v_mfma_f32_32x32x16_bf16 v[32:47], v[96:99], v[8:11], v[16:31]
  ds_read_b128 v[112:115], v5 offset:18432
  v_cvt_pk_bf16_f32 v80, v48, v49
  v_exp_f32 v52, v52
  v_exp_f32 v53, v53
  v_cvt_pk_bf16_f32 v81, v50, v51
  v_mfma_f32_16x16x32_bf16 v[88:91], v[92:95], v[84:87], v[88:91]
  ds_read_b128 v[116:119], v5 offset:19456
  ds_read_b64_tr_b16 v[128:129], v2 offset:0
  ds_read_b64_tr_b16 v[130:131], v2 offset:2048
  v_exp_f32 v54, v54
  v_exp_f32 v55, v55
  v_mfma_f32_32x32x16_bf16 v[32:47], v[100:103], v[12:15], v[32:47]
  ds_read_b128 v[104:107], v5 offset:20480
  v_cvt_pk_bf16_f32 v82, v52, v53
  v_exp_f32 v56, v56
  v_cvt_pk_bf16_f32 v83, v54, v55
  v_exp_f32 v57, v57
  ds_read_b128 v[108:111], v5 offset:21504
  ds_read_b64_tr_b16 v[132:133], v2 offset:4096
  ds_read_b64_tr_b16 v[134:135], v2 offset:6144
  v_mfma_f32_32x32x16_bf16 v[64:79], v[120:123], v[80:83], v[64:79]
  v_exp_f32 v58, v58
  v_exp_f32 v59, v59
  v_cvt_pk_bf16_f32 v84, v56, v57
  v_exp_f32 v60, v60
  v_mfma_f32_16x16x32_bf16 v[88:91], v[92:95], v[80:83], v[88:91]
  v_exp_f32 v61, v61
  v_cvt_pk_bf16_f32 v85, v58, v59
  v_exp_f32 v62, v62
  v_exp_f32 v63, v63
  v_cvt_pk_bf16_f32 v86, v60, v61
  v_cvt_pk_bf16_f32 v87, v62, v63
  s_waitcnt lgkmcnt(0)
  v_exp_f32 v32, v32
  v_mfma_f32_32x32x16_bf16 v[64:79], v[124:127], v[84:87], v[64:79]
  v_exp_f32 v33, v33
  v_exp_f32 v34, v34
  v_exp_f32 v35, v35
  v_mfma_f32_32x32x16_bf16 v[48:63], v[104:107], v[8:11], v[16:31]
  ds_read_b128 v[120:123], v5 offset:22528
  v_cvt_pk_bf16_f32 v80, v32, v33
  v_exp_f32 v36, v36
  v_exp_f32 v37, v37
  v_cvt_pk_bf16_f32 v81, v34, v35
  v_mfma_f32_16x16x32_bf16 v[88:91], v[92:95], v[84:87], v[88:91]
  ds_read_b128 v[124:127], v5 offset:23552
  v_exp_f32 v38, v38
  v_exp_f32 v39, v39
  v_mfma_f32_32x32x16_bf16 v[48:63], v[108:111], v[12:15], v[48:63]
  ds_read_b128 v[96:99], v5 offset:24576
  v_cvt_pk_bf16_f32 v82, v36, v37
  v_exp_f32 v40, v40
  v_cvt_pk_bf16_f32 v83, v38, v39
  v_exp_f32 v41, v41
  ds_read_b128 v[100:103], v5 offset:25600
  v_mfma_f32_32x32x16_bf16 v[64:79], v[112:115], v[80:83], v[64:79]
  v_exp_f32 v42, v42
  v_exp_f32 v43, v43
  v_cvt_pk_bf16_f32 v84, v40, v41
  v_exp_f32 v44, v44
  v_mfma_f32_16x16x32_bf16 v[88:91], v[92:95], v[80:83], v[88:91]
  v_exp_f32 v45, v45
  v_cvt_pk_bf16_f32 v85, v42, v43
  v_exp_f32 v46, v46
  v_exp_f32 v47, v47
  v_cvt_pk_bf16_f32 v86, v44, v45
  v_cvt_pk_bf16_f32 v87, v46, v47
  s_waitcnt lgkmcnt(0)
  v_exp_f32 v48, v48
  v_mfma_f32_32x32x16_bf16 v[64:79], v[116:119], v[84:87], v[64:79]
  v_exp_f32 v49, v49
  v_exp_f32 v50, v50
  v_exp_f32 v51, v51
  v_mfma_f32_32x32x16_bf16 v[32:47], v[96:99], v[8:11], v[16:31]
  ds_read_b128 v[112:115], v5 offset:26624
  v_cvt_pk_bf16_f32 v80, v48, v49
  v_exp_f32 v52, v52
  v_exp_f32 v53, v53
  v_cvt_pk_bf16_f32 v81, v50, v51
  v_mfma_f32_16x16x32_bf16 v[88:91], v[92:95], v[84:87], v[88:91]
  ds_read_b128 v[116:119], v5 offset:27648
  v_exp_f32 v54, v54
  v_exp_f32 v55, v55
  v_mfma_f32_32x32x16_bf16 v[32:47], v[100:103], v[12:15], v[32:47]
  ds_read_b128 v[104:107], v5 offset:28672
  v_cvt_pk_bf16_f32 v82, v52, v53
  v_exp_f32 v56, v56
  v_cvt_pk_bf16_f32 v83, v54, v55
  v_exp_f32 v57, v57
  ds_read_b128 v[108:111], v5 offset:29696
  v_mfma_f32_32x32x16_bf16 v[64:79], v[120:123], v[80:83], v[64:79]
  v_exp_f32 v58, v58
  v_exp_f32 v59, v59
  v_cvt_pk_bf16_f32 v84, v56, v57
  v_exp_f32 v60, v60
  v_mfma_f32_16x16x32_bf16 v[88:91], v[92:95], v[80:83], v[88:91]
  v_exp_f32 v61, v61
  v_cvt_pk_bf16_f32 v85, v58, v59
  v_exp_f32 v62, v62
  v_exp_f32 v63, v63
  v_cvt_pk_bf16_f32 v86, v60, v61
  v_cvt_pk_bf16_f32 v87, v62, v63
  s_waitcnt lgkmcnt(0)
  s_barrier
  s_add_u32 s28, s25, 65536
  s_add_u32 m0, s26, 0
  s_nop 0
  buffer_load_dwordx4 v4, s[12:15], s28 offen offset:0 sc1 lds
  buffer_load_dwordx4 v4, s[12:15], s28 offen offset:1024 sc1 lds
  buffer_load_dwordx4 v4, s[12:15], s28 offen offset:2048 sc1 lds
  buffer_load_dwordx4 v4, s[12:15], s28 offen offset:3072 sc1 lds
  s_add_u32 m0, s47, 0
  s_mov_b32 s28, 196608
  buffer_load_dwordx4 v1, s[16:19], s28 offen lds
  s_add_u32 m0, s47, 1024
  s_mov_b32 s28, 204800
  buffer_load_dwordx4 v1, s[16:19], s28 offen lds
  s_add_u32 m0, s47, 2048
  s_mov_b32 s28, 212992
  buffer_load_dwordx4 v1, s[16:19], s28 offen lds
  s_add_u32 m0, s47, 3072
  s_mov_b32 s28, 221184
  buffer_load_dwordx4 v1, s[16:19], s28 offen lds
  s_cmp_lg_u32 s27, 0
  s_cbranch_scc1 concat_heads__mha_block__spectral_fnet__prompt_kernel_nosf0
  v_mov_b32 v248, -1
  v_mov_b32 v249, -1
  v_mov_b32 v250, -1
  v_mov_b32 v251, -1
  s_lshl_b32 s28, s23, 6
  s_lshl_b32 s29, s20, 1
  s_add_u32 s28, s28, s29
  s_lshl_b32 s28, s28, 10
  s_add_u32 s28, s28, 0xc00000
  buffer_store_dwordx4 v[248:251], v5, s[12:15], s28 offen sc1
  buffer_store_dwordx4 v[248:251], v5, s[12:15], s28 offen offset:1024 sc1
concat_heads__mha_block__spectral_fnet__prompt_kernel_nosf0b:
  v_exp_f32 v32, v32
  v_mfma_f32_32x32x16_bf16 v[64:79], v[124:127], v[84:87], v[64:79]
  v_exp_f32 v33, v33
  v_exp_f32 v34, v34
  v_exp_f32 v35, v35
  v_mfma_f32_32x32x16_bf16 v[48:63], v[104:107], v[8:11], v[16:31]
  ds_read_b128 v[120:123], v5 offset:30720
  v_cvt_pk_bf16_f32 v80, v32, v33
  v_exp_f32 v36, v36
  v_exp_f32 v37, v37
  v_cvt_pk_bf16_f32 v81, v34, v35
  v_mfma_f32_16x16x32_bf16 v[88:91], v[92:95], v[84:87], v[88:91]
  ds_read_b128 v[124:127], v5 offset:31744
  v_exp_f32 v38, v38
  v_exp_f32 v39, v39
  v_mfma_f32_32x32x16_bf16 v[48:63], v[108:111], v[12:15], v[48:63]
  ds_read_b128 v[96:99], v5 offset:32768
  v_cvt_pk_bf16_f32 v82, v36, v37
  v_exp_f32 v40, v40
  v_cvt_pk_bf16_f32 v83, v38, v39
  v_exp_f32 v41, v41
  ds_read_b128 v[100:103], v5 offset:33792
  v_mfma_f32_32x32x16_bf16 v[64:79], v[112:115], v[80:83], v[64:79]
  v_exp_f32 v42, v42
  v_exp_f32 v43, v43
  v_cvt_pk_bf16_f32 v84, v40, v41
  v_exp_f32 v44, v44
  v_mfma_f32_16x16x32_bf16 v[88:91], v[92:95], v[80:83], v[88:91]
  v_exp_f32 v45, v45
  v_cvt_pk_bf16_f32 v85, v42, v43
  v_exp_f32 v46, v46
  v_exp_f32 v47, v47
  v_cvt_pk_bf16_f32 v86, v44, v45
  v_cvt_pk_bf16_f32 v87, v46, v47
  s_waitcnt lgkmcnt(0)
  v_exp_f32 v48, v48
  v_mfma_f32_32x32x16_bf16 v[64:79], v[116:119], v[84:87], v[64:79]
  v_exp_f32 v49, v49
  v_exp_f32 v50, v50
  v_exp_f32 v51, v51
  v_mfma_f32_32x32x16_bf16 v[32:47], v[96:99], v[8:11], v[16:31]
  ds_read_b128 v[112:115], v5 offset:34816
  v_cvt_pk_bf16_f32 v80, v48, v49
  v_exp_f32 v52, v52
  v_exp_f32 v53, v53
  v_cvt_pk_bf16_f32 v81, v50, v51
  v_mfma_f32_16x16x32_bf16 v[88:91], v[92:95], v[84:87], v[88:91]
  ds_read_b128 v[116:119], v5 offset:35840
  ds_read_b64_tr_b16 v[136:137], v2 offset:16384
  ds_read_b64_tr_b16 v[138:139], v2 offset:18432
  v_exp_f32 v54, v54
  v_exp_f32 v55, v55
  v_mfma_f32_32x32x16_bf16 v[32:47], v[100:103], v[12:15], v[32:47]
  ds_read_b128 v[104:107], v5 offset:36864
  v_cvt_pk_bf16_f32 v82, v52, v53
  v_exp_f32 v56, v56
  v_cvt_pk_bf16_f32 v83, v54, v55
  v_exp_f32 v57, v57
  ds_read_b128 v[108:111], v5 offset:37888
  ds_read_b64_tr_b16 v[140:141], v2 offset:20480
  ds_read_b64_tr_b16 v[142:143], v2 offset:22528
  v_mfma_f32_32x32x16_bf16 v[64:79], v[120:123], v[80:83], v[64:79]
  v_exp_f32 v58, v58
  v_exp_f32 v59, v59
  v_cvt_pk_bf16_f32 v84, v56, v57
  v_exp_f32 v60, v60
  v_mfma_f32_16x16x32_bf16 v[88:91], v[92:95], v[80:83], v[88:91]
  v_exp_f32 v61, v61
  v_cvt_pk_bf16_f32 v85, v58, v59
  v_exp_f32 v62, v62
  v_exp_f32 v63, v63
  v_cvt_pk_bf16_f32 v86, v60, v61
  v_cvt_pk_bf16_f32 v87, v62, v63
  s_waitcnt lgkmcnt(0)
  v_exp_f32 v32, v32
  v_mfma_f32_32x32x16_bf16 v[64:79], v[124:127], v[84:87], v[64:79]
  v_exp_f32 v33, v33
  v_exp_f32 v34, v34
  v_exp_f32 v35, v35
  v_mfma_f32_32x32x16_bf16 v[48:63], v[104:107], v[8:11], v[16:31]
  ds_read_b128 v[120:123], v5 offset:38912
  v_cvt_pk_bf16_f32 v80, v32, v33
  v_exp_f32 v36, v36
  v_exp_f32 v37, v37
  v_cvt_pk_bf16_f32 v81, v34, v35
  v_mfma_f32_16x16x32_bf16 v[88:91], v[92:95], v[84:87], v[88:91]
  ds_read_b128 v[124:127], v5 offset:39936
  v_exp_f32 v38, v38
  v_exp_f32 v39, v39
  v_mfma_f32_32x32x16_bf16 v[48:63], v[108:111], v[12:15], v[48:63]
  ds_read_b128 v[96:99], v5 offset:40960
  v_cvt_pk_bf16_f32 v82, v36, v37
  v_exp_f32 v40, v40
  v_cvt_pk_bf16_f32 v83, v38, v39
  v_exp_f32 v41, v41
  ds_read_b128 v[100:103], v5 offset:41984
  v_mfma_f32_32x32x16_bf16 v[64:79], v[112:115], v[80:83], v[64:79]
  v_exp_f32 v42, v42
  v_exp_f32 v43, v43
  v_cvt_pk_bf16_f32 v84, v40, v41
  v_exp_f32 v44, v44
  v_mfma_f32_16x16x32_bf16 v[88:91], v[92:95], v[80:83], v[88:91]
  v_exp_f32 v45, v45
  v_cvt_pk_bf16_f32 v85, v42, v43
  v_exp_f32 v46, v46
  v_exp_f32 v47, v47
  v_cvt_pk_bf16_f32 v86, v44, v45
  v_cvt_pk_bf16_f32 v87, v46, v47
  s_waitcnt lgkmcnt(0)
  v_exp_f32 v48, v48
  v_mfma_f32_32x32x16_bf16 v[64:79], v[116:119], v[84:87], v[64:79]
  v_exp_f32 v49, v49
  v_exp_f32 v50, v50
  v_exp_f32 v51, v51
  v_mfma_f32_32x32x16_bf16 v[32:47], v[96:99], v[8:11], v[16:31]
  ds_read_b128 v[112:115], v5 offset:43008
  v_cvt_pk_bf16_f32 v80, v48, v49
  v_exp_f32 v52, v52
  v_exp_f32 v53, v53
  v_cvt_pk_bf16_f32 v81, v50, v51
  v_mfma_f32_16x16x32_bf16 v[88:91], v[92:95], v[84:87], v[88:91]
  ds_read_b128 v[116:119], v5 offset:44032
  v_exp_f32 v54, v54
  v_exp_f32 v55, v55
  v_mfma_f32_32x32x16_bf16 v[32:47], v[100:103], v[12:15], v[32:47]
  ds_read_b128 v[104:107], v5 offset:45056
  v_cvt_pk_bf16_f32 v82, v52, v53
  v_exp_f32 v56, v56
  v_cvt_pk_bf16_f32 v83, v54, v55
  v_exp_f32 v57, v57
  ds_read_b128 v[108:111], v5 offset:46080
  v_mfma_f32_32x32x16_bf16 v[64:79], v[120:123], v[80:83], v[64:79]
  v_exp_f32 v58, v58
  v_exp_f32 v59, v59
  v_cvt_pk_bf16_f32 v84, v56, v57
  v_exp_f32 v60, v60
  v_mfma_f32_16x16x32_bf16 v[88:91], v[92:95], v[80:83], v[88:91]
  v_exp_f32 v61, v61
  v_cvt_pk_bf16_f32 v85, v58, v59
  v_exp_f32 v62, v62
  v_exp_f32 v63, v63
  v_cvt_pk_bf16_f32 v86, v60, v61
  v_cvt_pk_bf16_f32 v87, v62, v63
  s_waitcnt lgkmcnt(0)
  s_waitcnt vmcnt(10)
  s_barrier
  s_add_u32 s28, s25, 81920
  s_add_u32 m0, s26, 16384
  s_nop 0
  buffer_load_dwordx4 v4, s[12:15], s28 offen offset:0 sc1 lds
  buffer_load_dwordx4 v4, s[12:15], s28 offen offset:1024 sc1 lds
  buffer_load_dwordx4 v4, s[12:15], s28 offen offset:2048 sc1 lds
  buffer_load_dwordx4 v4, s[12:15], s28 offen offset:3072 sc1 lds
  s_add_u32 m0, s47, 16384
  s_mov_b32 s28, 262144
  buffer_load_dwordx4 v1, s[16:19], s28 offen lds
  s_add_u32 m0, s47, 17408
  s_mov_b32 s28, 270336
  buffer_load_dwordx4 v1, s[16:19], s28 offen lds
  s_add_u32 m0, s47, 18432
  s_mov_b32 s28, 278528
  buffer_load_dwordx4 v1, s[16:19], s28 offen lds
  s_add_u32 m0, s47, 19456
  s_mov_b32 s28, 286720
  buffer_load_dwordx4 v1, s[16:19], s28 offen lds
  s_cmp_lg_u32 s27, 0
  s_cbranch_scc1 concat_heads__mha_block__spectral_fnet__prompt_kernel_nozs0
  buffer_store_dwordx4 v[224:227], v245, s[76:79], 0 offen sc1
  buffer_store_dwordx4 v[228:231], v245, s[76:79], 0 offen offset:1024 sc1
  v_add_u32 v240, 131072, v245
  buffer_store_dwordx4 v[232:235], v240, s[76:79], 0 offen sc1
  buffer_store_dwordx4 v[236:239], v240, s[76:79], 0 offen offset:1024 sc1
concat_heads__mha_block__spectral_fnet__prompt_kernel_nozs0b:
  v_exp_f32 v32, v32
  v_mfma_f32_32x32x16_bf16 v[64:79], v[124:127], v[84:87], v[64:79]
  v_exp_f32 v33, v33
  v_exp_f32 v34, v34
  v_exp_f32 v35, v35
  v_mfma_f32_32x32x16_bf16 v[48:63], v[104:107], v[8:11], v[16:31]
  ds_read_b128 v[120:123], v5 offset:47104
  v_cvt_pk_bf16_f32 v80, v32, v33
  v_exp_f32 v36, v36
  v_exp_f32 v37, v37
  v_cvt_pk_bf16_f32 v81, v34, v35
  v_mfma_f32_16x16x32_bf16 v[88:91], v[92:95], v[84:87], v[88:91]
  ds_read_b128 v[124:127], v5 offset:48128
  v_exp_f32 v38, v38
  v_exp_f32 v39, v39
  v_mfma_f32_32x32x16_bf16 v[48:63], v[108:111], v[12:15], v[48:63]
  ds_read_b128 v[96:99], v5 offset:49152
  v_cvt_pk_bf16_f32 v82, v36, v37
  v_exp_f32 v40, v40
  v_cvt_pk_bf16_f32 v83, v38, v39
  v_exp_f32 v41, v41
  ds_read_b128 v[100:103], v5 offset:50176
  v_mfma_f32_32x32x16_bf16 v[64:79], v[112:115], v[80:83], v[64:79]
  v_exp_f32 v42, v42
  v_exp_f32 v43, v43
  v_cvt_pk_bf16_f32 v84, v40, v41
  v_exp_f32 v44, v44
  v_mfma_f32_16x16x32_bf16 v[88:91], v[92:95], v[80:83], v[88:91]
  v_exp_f32 v45, v45
  v_cvt_pk_bf16_f32 v85, v42, v43
  v_exp_f32 v46, v46
  v_exp_f32 v47, v47
  v_cvt_pk_bf16_f32 v86, v44, v45
  v_cvt_pk_bf16_f32 v87, v46, v47
  s_waitcnt lgkmcnt(0)
  v_exp_f32 v48, v48
  v_mfma_f32_32x32x16_bf16 v[64:79], v[116:119], v[84:87], v[64:79]
  v_exp_f32 v49, v49
  v_exp_f32 v50, v50
  v_exp_f32 v51, v51
  v_mfma_f32_32x32x16_bf16 v[32:47], v[96:99], v[8:11], v[16:31]
  ds_read_b128 v[112:115], v5 offset:51200
  v_cvt_pk_bf16_f32 v80, v48, v49
  v_exp_f32 v52, v52
  v_exp_f32 v53, v53
  v_cvt_pk_bf16_f32 v81, v50, v51
  v_mfma_f32_16x16x32_bf16 v[88:91], v[92:95], v[84:87], v[88:91]
  ds_read_b128 v[116:119], v5 offset:52224
  ds_read_b64_tr_b16 v[144:145], v2 offset:32768
  ds_read_b64_tr_b16 v[146:147], v2 offset:34816
  v_exp_f32 v54, v54
  v_exp_f32 v55, v55
  v_mfma_f32_32x32x16_bf16 v[32:47], v[100:103], v[12:15], v[32:47]
  ds_read_b128 v[104:107], v5 offset:53248
  v_cvt_pk_bf16_f32 v82, v52, v53
  v_exp_f32 v56, v56
  v_cvt_pk_bf16_f32 v83, v54, v55
  v_exp_f32 v57, v57
  ds_read_b128 v[108:111], v5 offset:54272
  ds_read_b64_tr_b16 v[148:149], v2 offset:36864
  ds_read_b64_tr_b16 v[150:151], v2 offset:38912
  v_mfma_f32_32x32x16_bf16 v[64:79], v[120:123], v[80:83], v[64:79]
  v_exp_f32 v58, v58
  v_exp_f32 v59, v59
  v_cvt_pk_bf16_f32 v84, v56, v57
  v_exp_f32 v60, v60
  v_mfma_f32_16x16x32_bf16 v[88:91], v[92:95], v[80:83], v[88:91]
  v_exp_f32 v61, v61
  v_cvt_pk_bf16_f32 v85, v58, v59
  v_exp_f32 v62, v62
  v_exp_f32 v63, v63
  v_cvt_pk_bf16_f32 v86, v60, v61
  v_cvt_pk_bf16_f32 v87, v62, v63
  s_waitcnt lgkmcnt(0)
  v_exp_f32 v32, v32
  v_mfma_f32_32x32x16_bf16 v[64:79], v[124:127], v[84:87], v[64:79]
  v_exp_f32 v33, v33
  v_exp_f32 v34, v34
  v_exp_f32 v35, v35
  v_mfma_f32_32x32x16_bf16 v[48:63], v[104:107], v[8:11], v[16:31]
  ds_read_b128 v[120:123], v5 offset:55296
  v_cvt_pk_bf16_f32 v80, v32, v33
  v_exp_f32 v36, v36
  v_exp_f32 v37, v37
  v_cvt_pk_bf16_f32 v81, v34, v35
  v_mfma_f32_16x16x32_bf16 v[88:91], v[92:95], v[84:87], v[88:91]
  ds_read_b128 v[124:127], v5 offset:56320
  v_exp_f32 v38, v38
  v_exp_f32 v39, v39
  v_mfma_f32_32x32x16_bf16 v[48:63], v[108:111], v[12:15], v[48:63]
  ds_read_b128 v[96:99], v5 offset:57344
  v_cvt_pk_bf16_f32 v82, v36, v37
  v_exp_f32 v40, v40
  v_cvt_pk_bf16_f32 v83, v38, v39
  v_exp_f32 v41, v41
  ds_read_b128 v[100:103], v5 offset:58368
  v_mfma_f32_32x32x16_bf16 v[64:79], v[112:115], v[80:83], v[64:79]
  v_exp_f32 v42, v42
  v_exp_f32 v43, v43
  v_cvt_pk_bf16_f32 v84, v40, v41
  v_exp_f32 v44, v44
  v_mfma_f32_16x16x32_bf16 v[88:91], v[92:95], v[80:83], v[88:91]
  v_exp_f32 v45, v45
  v_cvt_pk_bf16_f32 v85, v42, v43
  v_exp_f32 v46, v46
  v_exp_f32 v47, v47
  v_cvt_pk_bf16_f32 v86, v44, v45
  v_cvt_pk_bf16_f32 v87, v46, v47
  s_waitcnt lgkmcnt(0)
  v_exp_f32 v48, v48
  v_mfma_f32_32x32x16_bf16 v[64:79], v[116:119], v[84:87], v[64:79]
  v_exp_f32 v49, v49
  v_exp_f32 v50, v50
  v_exp_f32 v51, v51
  v_mfma_f32_32x32x16_bf16 v[32:47], v[96:99], v[8:11], v[16:31]
  ds_read_b128 v[112:115], v5 offset:59392
  v_cvt_pk_bf16_f32 v80, v48, v49
  v_exp_f32 v52, v52
  v_exp_f32 v53, v53
  v_cvt_pk_bf16_f32 v81, v50, v51
  v_mfma_f32_16x16x32_bf16 v[88:91], v[92:95], v[84:87], v[88:91]
  ds_read_b128 v[116:119], v5 offset:60416
  v_exp_f32 v54, v54
  v_exp_f32 v55, v55
  v_mfma_f32_32x32x16_bf16 v[32:47], v[100:103], v[12:15], v[32:47]
  ds_read_b128 v[104:107], v5 offset:61440
  v_cvt_pk_bf16_f32 v82, v52, v53
  v_exp_f32 v56, v56
  v_cvt_pk_bf16_f32 v83, v54, v55
  v_exp_f32 v57, v57
  ds_read_b128 v[108:111], v5 offset:62464
  v_mfma_f32_32x32x16_bf16 v[64:79], v[120:123], v[80:83], v[64:79]
  v_exp_f32 v58, v58
  v_exp_f32 v59, v59
  v_cvt_pk_bf16_f32 v84, v56, v57
  v_exp_f32 v60, v60
  v_mfma_f32_16x16x32_bf16 v[88:91], v[92:95], v[80:83], v[88:91]
  v_exp_f32 v61, v61
  v_cvt_pk_bf16_f32 v85, v58, v59
  v_exp_f32 v62, v62
  v_exp_f32 v63, v63
  v_cvt_pk_bf16_f32 v86, v60, v61
  v_cvt_pk_bf16_f32 v87, v62, v63
  s_waitcnt lgkmcnt(0)
  s_waitcnt vmcnt(14)
  s_barrier
  s_add_u32 s28, s25, 98304
  s_add_u32 m0, s26, 32768
  s_nop 0
  buffer_load_dwordx4 v4, s[12:15], s28 offen offset:0 sc1 lds
  buffer_load_dwordx4 v4, s[12:15], s28 offen offset:1024 sc1 lds
  buffer_load_dwordx4 v4, s[12:15], s28 offen offset:2048 sc1 lds
  buffer_load_dwordx4 v4, s[12:15], s28 offen offset:3072 sc1 lds
  s_add_u32 m0, s47, 32768
  s_mov_b32 s28, 327680
  buffer_load_dwordx4 v1, s[16:19], s28 offen lds
  s_add_u32 m0, s47, 33792
  s_mov_b32 s28, 335872
  buffer_load_dwordx4 v1, s[16:19], s28 offen lds
  s_add_u32 m0, s47, 34816
  s_mov_b32 s28, 344064
  buffer_load_dwordx4 v1, s[16:19], s28 offen lds
  s_add_u32 m0, s47, 35840
  s_mov_b32 s28, 352256
  buffer_load_dwordx4 v1, s[16:19], s28 offen lds
  v_exp_f32 v32, v32
  v_mfma_f32_32x32x16_bf16 v[64:79], v[124:127], v[84:87], v[64:79]
  v_exp_f32 v33, v33
  v_exp_f32 v34, v34
  v_exp_f32 v35, v35
  v_mfma_f32_32x32x16_bf16 v[48:63], v[104:107], v[8:11], v[16:31]
  ds_read_b128 v[120:123], v5 offset:63488
  v_cvt_pk_bf16_f32 v80, v32, v33
  v_exp_f32 v36, v36
  v_exp_f32 v37, v37
  v_cvt_pk_bf16_f32 v81, v34, v35
  v_mfma_f32_16x16x32_bf16 v[88:91], v[92:95], v[84:87], v[88:91]
  ds_read_b128 v[124:127], v5 offset:64512
  v_exp_f32 v38, v38
  v_exp_f32 v39, v39
  v_mfma_f32_32x32x16_bf16 v[48:63], v[108:111], v[12:15], v[48:63]
  ds_read_b128 v[96:99], v5 offset:0
  v_cvt_pk_bf16_f32 v82, v36, v37
  v_exp_f32 v40, v40
  v_cvt_pk_bf16_f32 v83, v38, v39
  v_exp_f32 v41, v41
  ds_read_b128 v[100:103], v5 offset:1024
  v_mfma_f32_32x32x16_bf16 v[64:79], v[112:115], v[80:83], v[64:79]
  v_exp_f32 v42, v42
  v_exp_f32 v43, v43
  v_cvt_pk_bf16_f32 v84, v40, v41
  v_exp_f32 v44, v44
  v_mfma_f32_16x16x32_bf16 v[88:91], v[92:95], v[80:83], v[88:91]
  v_exp_f32 v45, v45
  v_cvt_pk_bf16_f32 v85, v42, v43
  v_exp_f32 v46, v46
  v_exp_f32 v47, v47
  v_cvt_pk_bf16_f32 v86, v44, v45
  v_cvt_pk_bf16_f32 v87, v46, v47
  s_waitcnt lgkmcnt(0)
  v_exp_f32 v48, v48
  v_mfma_f32_32x32x16_bf16 v[64:79], v[116:119], v[84:87], v[64:79]
  v_exp_f32 v49, v49
  v_exp_f32 v50, v50
  v_exp_f32 v51, v51
  v_mfma_f32_32x32x16_bf16 v[32:47], v[96:99], v[8:11], v[16:31]
  ds_read_b128 v[112:115], v5 offset:2048
  v_cvt_pk_bf16_f32 v80, v48, v49
  v_exp_f32 v52, v52
  v_exp_f32 v53, v53
  v_cvt_pk_bf16_f32 v81, v50, v51
  v_mfma_f32_16x16x32_bf16 v[88:91], v[92:95], v[84:87], v[88:91]
  ds_read_b128 v[116:119], v5 offset:3072
  ds_read_b64_tr_b16 v[152:153], v2 offset:0
  ds_read_b64_tr_b16 v[154:155], v2 offset:2048
  v_exp_f32 v54, v54
  v_exp_f32 v55, v55
  v_mfma_f32_32x32x16_bf16 v[32:47], v[100:103], v[12:15], v[32:47]
  ds_read_b128 v[104:107], v5 offset:4096
  v_cvt_pk_bf16_f32 v82, v52, v53
  v_exp_f32 v56, v56
  v_cvt_pk_bf16_f32 v83, v54, v55
  v_exp_f32 v57, v57
  ds_read_b128 v[108:111], v5 offset:5120
  ds_read_b64_tr_b16 v[156:157], v2 offset:4096
  ds_read_b64_tr_b16 v[158:159], v2 offset:6144
  v_mfma_f32_32x32x16_bf16 v[64:79], v[120:123], v[80:83], v[64:79]
  v_exp_f32 v58, v58
  v_exp_f32 v59, v59
  v_cvt_pk_bf16_f32 v84, v56, v57
  v_exp_f32 v60, v60
  v_mfma_f32_16x16x32_bf16 v[88:91], v[92:95], v[80:83], v[88:91]
  v_exp_f32 v61, v61
  v_cvt_pk_bf16_f32 v85, v58, v59
  v_exp_f32 v62, v62
  v_exp_f32 v63, v63
  v_cvt_pk_bf16_f32 v86, v60, v61
  v_cvt_pk_bf16_f32 v87, v62, v63
  s_waitcnt lgkmcnt(0)
  v_exp_f32 v32, v32
  v_mfma_f32_32x32x16_bf16 v[64:79], v[124:127], v[84:87], v[64:79]
  v_exp_f32 v33, v33
  v_exp_f32 v34, v34
  v_exp_f32 v35, v35
  v_mfma_f32_32x32x16_bf16 v[48:63], v[104:107], v[8:11], v[16:31]
  ds_read_b128 v[120:123], v5 offset:6144
  v_cvt_pk_bf16_f32 v80, v32, v33
  v_exp_f32 v36, v36
  v_exp_f32 v37, v37
  v_cvt_pk_bf16_f32 v81, v34, v35
  v_mfma_f32_16x16x32_bf16 v[88:91], v[92:95], v[84:87], v[88:91]
  ds_read_b128 v[124:127], v5 offset:7168
  v_exp_f32 v38, v38
  v_exp_f32 v39, v39
  v_mfma_f32_32x32x16_bf16 v[48:63], v[108:111], v[12:15], v[48:63]
  ds_read_b128 v[96:99], v5 offset:8192
  v_cvt_pk_bf16_f32 v82, v36, v37
  v_exp_f32 v40, v40
  v_cvt_pk_bf16_f32 v83, v38, v39
  v_exp_f32 v41, v41
  ds_read_b128 v[100:103], v5 offset:9216
  v_mfma_f32_32x32x16_bf16 v[64:79], v[112:115], v[80:83], v[64:79]
  v_exp_f32 v42, v42
  v_exp_f32 v43, v43
  v_cvt_pk_bf16_f32 v84, v40, v41
  v_exp_f32 v44, v44
  v_mfma_f32_16x16x32_bf16 v[88:91], v[92:95], v[80:83], v[88:91]
  v_exp_f32 v45, v45
  v_cvt_pk_bf16_f32 v85, v42, v43
  v_exp_f32 v46, v46
  v_exp_f32 v47, v47
  v_cvt_pk_bf16_f32 v86, v44, v45
  v_cvt_pk_bf16_f32 v87, v46, v47
  s_waitcnt lgkmcnt(0)
  v_exp_f32 v48, v48
  v_mfma_f32_32x32x16_bf16 v[64:79], v[116:119], v[84:87], v[64:79]
  v_exp_f32 v49, v49
  v_exp_f32 v50, v50
  v_exp_f32 v51, v51
  v_mfma_f32_32x32x16_bf16 v[32:47], v[96:99], v[8:11], v[16:31]
  ds_read_b128 v[112:115], v5 offset:10240
  v_cvt_pk_bf16_f32 v80, v48, v49
  v_exp_f32 v52, v52
  v_exp_f32 v53, v53
  v_cvt_pk_bf16_f32 v81, v50, v51
  v_mfma_f32_16x16x32_bf16 v[88:91], v[92:95], v[84:87], v[88:91]
  ds_read_b128 v[116:119], v5 offset:11264
  v_exp_f32 v54, v54
  v_exp_f32 v55, v55
  v_mfma_f32_32x32x16_bf16 v[32:47], v[100:103], v[12:15], v[32:47]
  ds_read_b128 v[104:107], v5 offset:12288
  v_cvt_pk_bf16_f32 v82, v52, v53
  v_exp_f32 v56, v56
  v_cvt_pk_bf16_f32 v83, v54, v55
  v_exp_f32 v57, v57
  ds_read_b128 v[108:111], v5 offset:13312
  v_mfma_f32_32x32x16_bf16 v[64:79], v[120:123], v[80:83], v[64:79]
  v_exp_f32 v58, v58
  v_exp_f32 v59, v59
  v_cvt_pk_bf16_f32 v84, v56, v57
  v_exp_f32 v60, v60
  v_mfma_f32_16x16x32_bf16 v[88:91], v[92:95], v[80:83], v[88:91]
  v_exp_f32 v61, v61
  v_cvt_pk_bf16_f32 v85, v58, v59
  v_exp_f32 v62, v62
  v_exp_f32 v63, v63
  v_cvt_pk_bf16_f32 v86, v60, v61
  v_cvt_pk_bf16_f32 v87, v62, v63
  s_waitcnt lgkmcnt(0)
  s_waitcnt vmcnt(12)
  s_barrier
  s_add_u32 s28, s25, 114688
  s_add_u32 m0, s26, 49152
  s_nop 0
  buffer_load_dwordx4 v4, s[12:15], s28 offen offset:0 sc1 lds
  buffer_load_dwordx4 v4, s[12:15], s28 offen offset:1024 sc1 lds
  buffer_load_dwordx4 v4, s[12:15], s28 offen offset:2048 sc1 lds
  buffer_load_dwordx4 v4, s[12:15], s28 offen offset:3072 sc1 lds
  s_add_u32 m0, s47, 0
  s_mov_b32 s28, 393216
  buffer_load_dwordx4 v1, s[16:19], s28 offen lds
  s_add_u32 m0, s47, 1024
  s_mov_b32 s28, 401408
  buffer_load_dwordx4 v1, s[16:19], s28 offen lds
  s_add_u32 m0, s47, 2048
  s_mov_b32 s28, 409600
  buffer_load_dwordx4 v1, s[16:19], s28 offen lds
  s_add_u32 m0, s47, 3072
  s_mov_b32 s28, 417792
  buffer_load_dwordx4 v1, s[16:19], s28 offen lds
  v_exp_f32 v32, v32
  v_mfma_f32_32x32x16_bf16 v[64:79], v[124:127], v[84:87], v[64:79]
  v_exp_f32 v33, v33
  v_exp_f32 v34, v34
  v_exp_f32 v35, v35
  v_mfma_f32_32x32x16_bf16 v[48:63], v[104:107], v[8:11], v[16:31]
  ds_read_b128 v[120:123], v5 offset:14336
  v_cvt_pk_bf16_f32 v80, v32, v33
  v_exp_f32 v36, v36
  v_exp_f32 v37, v37
  v_cvt_pk_bf16_f32 v81, v34, v35
  v_mfma_f32_16x16x32_bf16 v[88:91], v[92:95], v[84:87], v[88:91]
  ds_read_b128 v[124:127], v5 offset:15360
  v_exp_f32 v38, v38
  v_exp_f32 v39, v39
  v_mfma_f32_32x32x16_bf16 v[48:63], v[108:111], v[12:15], v[48:63]
  ds_read_b128 v[96:99], v5 offset:16384
  v_cvt_pk_bf16_f32 v82, v36, v37
  v_exp_f32 v40, v40
  v_cvt_pk_bf16_f32 v83, v38, v39
  v_exp_f32 v41, v41
  ds_read_b128 v[100:103], v5 offset:17408
  v_mfma_f32_32x32x16_bf16 v[64:79], v[112:115], v[80:83], v[64:79]
  v_exp_f32 v42, v42
  v_exp_f32 v43, v43
  v_cvt_pk_bf16_f32 v84, v40, v41
  v_exp_f32 v44, v44
  v_mfma_f32_16x16x32_bf16 v[88:91], v[92:95], v[80:83], v[88:91]
  v_exp_f32 v45, v45
  v_cvt_pk_bf16_f32 v85, v42, v43
  v_exp_f32 v46, v46
  v_exp_f32 v47, v47
  v_cvt_pk_bf16_f32 v86, v44, v45
  v_cvt_pk_bf16_f32 v87, v46, v47
  s_waitcnt lgkmcnt(0)
  v_exp_f32 v48, v48
  v_mfma_f32_32x32x16_bf16 v[64:79], v[116:119], v[84:87], v[64:79]
  v_exp_f32 v49, v49
  v_exp_f32 v50, v50
  v_exp_f32 v51, v51
  v_mfma_f32_32x32x16_bf16 v[32:47], v[96:99], v[8:11], v[16:31]
  ds_read_b128 v[112:115], v5 offset:18432
  v_cvt_pk_bf16_f32 v80, v48, v49
  v_exp_f32 v52, v52
  v_exp_f32 v53, v53
  v_cvt_pk_bf16_f32 v81, v50, v51
  v_mfma_f32_16x16x32_bf16 v[88:91], v[92:95], v[84:87], v[88:91]
  ds_read_b128 v[116:119], v5 offset:19456
  ds_read_b64_tr_b16 v[160:161], v2 offset:16384
  ds_read_b64_tr_b16 v[162:163], v2 offset:18432
  v_exp_f32 v54, v54
  v_exp_f32 v55, v55
  v_mfma_f32_32x32x16_bf16 v[32:47], v[100:103], v[12:15], v[32:47]
  ds_read_b128 v[104:107], v5 offset:20480
  v_cvt_pk_bf16_f32 v82, v52, v53
  v_exp_f32 v56, v56
  v_cvt_pk_bf16_f32 v83, v54, v55
  v_exp_f32 v57, v57
  ds_read_b128 v[108:111], v5 offset:21504
  ds_read_b64_tr_b16 v[164:165], v2 offset:20480
  ds_read_b64_tr_b16 v[166:167], v2 offset:22528
  v_mfma_f32_32x32x16_bf16 v[64:79], v[120:123], v[80:83], v[64:79]
  v_exp_f32 v58, v58
  v_exp_f32 v59, v59
  v_cvt_pk_bf16_f32 v84, v56, v57
  v_exp_f32 v60, v60
  v_mfma_f32_16x16x32_bf16 v[88:91], v[92:95], v[80:83], v[88:91]
  v_exp_f32 v61, v61
  v_cvt_pk_bf16_f32 v85, v58, v59
  v_exp_f32 v62, v62
  v_exp_f32 v63, v63
  v_cvt_pk_bf16_f32 v86, v60, v61
  v_cvt_pk_bf16_f32 v87, v62, v63
  s_waitcnt lgkmcnt(0)
  v_exp_f32 v32, v32
  v_mfma_f32_32x32x16_bf16 v[64:79], v[124:127], v[84:87], v[64:79]
  v_exp_f32 v33, v33
  v_exp_f32 v34, v34
  v_exp_f32 v35, v35
  v_mfma_f32_32x32x16_bf16 v[48:63], v[104:107], v[8:11], v[16:31]
  ds_read_b128 v[120:123], v5 offset:22528
  v_cvt_pk_bf16_f32 v80, v32, v33
  v_exp_f32 v36, v36
  v_exp_f32 v37, v37
  v_cvt_pk_bf16_f32 v81, v34, v35
  v_mfma_f32_16x16x32_bf16 v[88:91], v[92:95], v[84:87], v[88:91]
  ds_read_b128 v[124:127], v5 offset:23552
  v_exp_f32 v38, v38
  v_exp_f32 v39, v39
  v_mfma_f32_32x32x16_bf16 v[48:63], v[108:111], v[12:15], v[48:63]
  ds_read_b128 v[96:99], v5 offset:24576
  v_cvt_pk_bf16_f32 v82, v36, v37
  v_exp_f32 v40, v40
  v_cvt_pk_bf16_f32 v83, v38, v39
  v_exp_f32 v41, v41
  ds_read_b128 v[100:103], v5 offset:25600
  v_mfma_f32_32x32x16_bf16 v[64:79], v[112:115], v[80:83], v[64:79]
  v_exp_f32 v42, v42
  v_exp_f32 v43, v43
  v_cvt_pk_bf16_f32 v84, v40, v41
  v_exp_f32 v44, v44
  v_mfma_f32_16x16x32_bf16 v[88:91], v[92:95], v[80:83], v[88:91]
  v_exp_f32 v45, v45
  v_cvt_pk_bf16_f32 v85, v42, v43
  v_exp_f32 v46, v46
  v_exp_f32 v47, v47
  v_cvt_pk_bf16_f32 v86, v44, v45
  v_cvt_pk_bf16_f32 v87, v46, v47
  s_waitcnt lgkmcnt(0)
  v_exp_f32 v48, v48
  v_mfma_f32_32x32x16_bf16 v[64:79], v[116:119], v[84:87], v[64:79]
  v_exp_f32 v49, v49
  v_exp_f32 v50, v50
  v_exp_f32 v51, v51
  v_mfma_f32_32x32x16_bf16 v[32:47], v[96:99], v[8:11], v[16:31]
  ds_read_b128 v[112:115], v5 offset:26624
  v_cvt_pk_bf16_f32 v80, v48, v49
  v_exp_f32 v52, v52
  v_exp_f32 v53, v53
  v_cvt_pk_bf16_f32 v81, v50, v51
  v_mfma_f32_16x16x32_bf16 v[88:91], v[92:95], v[84:87], v[88:91]
  ds_read_b128 v[116:119], v5 offset:27648
  v_exp_f32 v54, v54
  v_exp_f32 v55, v55
  v_mfma_f32_32x32x16_bf16 v[32:47], v[100:103], v[12:15], v[32:47]
  ds_read_b128 v[104:107], v5 offset:28672
  v_cvt_pk_bf16_f32 v82, v52, v53
  v_exp_f32 v56, v56
  v_cvt_pk_bf16_f32 v83, v54, v55
  v_exp_f32 v57, v57
  ds_read_b128 v[108:111], v5 offset:29696
  v_mfma_f32_32x32x16_bf16 v[64:79], v[120:123], v[80:83], v[64:79]
  v_exp_f32 v58, v58
  v_exp_f32 v59, v59
  v_cvt_pk_bf16_f32 v84, v56, v57
  v_exp_f32 v60, v60
  v_mfma_f32_16x16x32_bf16 v[88:91], v[92:95], v[80:83], v[88:91]
  v_exp_f32 v61, v61
  v_cvt_pk_bf16_f32 v85, v58, v59
  v_exp_f32 v62, v62
  v_exp_f32 v63, v63
  v_cvt_pk_bf16_f32 v86, v60, v61
  v_cvt_pk_bf16_f32 v87, v62, v63
  s_waitcnt lgkmcnt(0)
  s_waitcnt vmcnt(8)
  s_barrier
  s_add_u32 s28, s25, 131072
  s_add_u32 m0, s26, 0
  s_nop 0
  buffer_load_dwordx4 v4, s[12:15], s28 offen offset:0 sc1 lds
  buffer_load_dwordx4 v4, s[12:15], s28 offen offset:1024 sc1 lds
  buffer_load_dwordx4 v4, s[12:15], s28 offen offset:2048 sc1 lds
  buffer_load_dwordx4 v4, s[12:15], s28 offen offset:3072 sc1 lds
  s_add_u32 m0, s47, 16384
  s_mov_b32 s28, 458752
  buffer_load_dwordx4 v1, s[16:19], s28 offen lds
  s_add_u32 m0, s47, 17408
  s_mov_b32 s28, 466944
  buffer_load_dwordx4 v1, s[16:19], s28 offen lds
  s_add_u32 m0, s47, 18432
  s_mov_b32 s28, 475136
  buffer_load_dwordx4 v1, s[16:19], s28 offen lds
  s_add_u32 m0, s47, 19456
  s_mov_b32 s28, 483328
  buffer_load_dwordx4 v1, s[16:19], s28 offen lds
  v_exp_f32 v32, v32
  v_mfma_f32_32x32x16_bf16 v[64:79], v[124:127], v[84:87], v[64:79]
  v_exp_f32 v33, v33
  v_exp_f32 v34, v34
  v_exp_f32 v35, v35
  v_mfma_f32_32x32x16_bf16 v[48:63], v[104:107], v[8:11], v[16:31]
  ds_read_b128 v[120:123], v5 offset:30720
  v_cvt_pk_bf16_f32 v80, v32, v33
  v_exp_f32 v36, v36
  v_exp_f32 v37, v37
  v_cvt_pk_bf16_f32 v81, v34, v35
  v_mfma_f32_16x16x32_bf16 v[88:91], v[92:95], v[84:87], v[88:91]
  ds_read_b128 v[124:127], v5 offset:31744
  v_exp_f32 v38, v38
  v_exp_f32 v39, v39
  v_mfma_f32_32x32x16_bf16 v[48:63], v[108:111], v[12:15], v[48:63]
  ds_read_b128 v[96:99], v5 offset:32768
  v_cvt_pk_bf16_f32 v82, v36, v37
  v_exp_f32 v40, v40
  v_cvt_pk_bf16_f32 v83, v38, v39
  v_exp_f32 v41, v41
  ds_read_b128 v[100:103], v5 offset:33792
  v_mfma_f32_32x32x16_bf16 v[64:79], v[112:115], v[80:83], v[64:79]
  v_exp_f32 v42, v42
  v_exp_f32 v43, v43
  v_cvt_pk_bf16_f32 v84, v40, v41
  v_exp_f32 v44, v44
  v_mfma_f32_16x16x32_bf16 v[88:91], v[92:95], v[80:83], v[88:91]
  v_exp_f32 v45, v45
  v_cvt_pk_bf16_f32 v85, v42, v43
  v_exp_f32 v46, v46
  v_exp_f32 v47, v47
  v_cvt_pk_bf16_f32 v86, v44, v45
  v_cvt_pk_bf16_f32 v87, v46, v47
  s_waitcnt lgkmcnt(0)
  v_exp_f32 v48, v48
  v_mfma_f32_32x32x16_bf16 v[64:79], v[116:119], v[84:87], v[64:79]
  v_exp_f32 v49, v49
  v_exp_f32 v50, v50
  v_exp_f32 v51, v51
  v_mfma_f32_32x32x16_bf16 v[32:47], v[96:99], v[8:11], v[16:31]
  ds_read_b128 v[112:115], v5 offset:34816
  v_cvt_pk_bf16_f32 v80, v48, v49
  v_exp_f32 v52, v52
  v_exp_f32 v53, v53
  v_cvt_pk_bf16_f32 v81, v50, v51
  v_mfma_f32_16x16x32_bf16 v[88:91], v[92:95], v[84:87], v[88:91]
  ds_read_b128 v[116:119], v5 offset:35840
  ds_read_b64_tr_b16 v[168:169], v2 offset:32768
  ds_read_b64_tr_b16 v[170:171], v2 offset:34816
  v_exp_f32 v54, v54
  v_exp_f32 v55, v55
  v_mfma_f32_32x32x16_bf16 v[32:47], v[100:103], v[12:15], v[32:47]
  ds_read_b128 v[104:107], v5 offset:36864
  v_cvt_pk_bf16_f32 v82, v52, v53
  v_exp_f32 v56, v56
  v_cvt_pk_bf16_f32 v83, v54, v55
  v_exp_f32 v57, v57
  ds_read_b128 v[108:111], v5 offset:37888
  ds_read_b64_tr_b16 v[172:173], v2 offset:36864
  ds_read_b64_tr_b16 v[174:175], v2 offset:38912
  v_mfma_f32_32x32x16_bf16 v[64:79], v[120:123], v[80:83], v[64:79]
  v_exp_f32 v58, v58
  v_exp_f32 v59, v59
  v_cvt_pk_bf16_f32 v84, v56, v57
  v_exp_f32 v60, v60
  v_mfma_f32_16x16x32_bf16 v[88:91], v[92:95], v[80:83], v[88:91]
  v_exp_f32 v61, v61
  v_cvt_pk_bf16_f32 v85, v58, v59
  v_exp_f32 v62, v62
  v_exp_f32 v63, v63
  v_cvt_pk_bf16_f32 v86, v60, v61
  v_cvt_pk_bf16_f32 v87, v62, v63
  s_waitcnt lgkmcnt(0)
  v_exp_f32 v32, v32
  v_mfma_f32_32x32x16_bf16 v[64:79], v[124:127], v[84:87], v[64:79]
  v_exp_f32 v33, v33
  v_exp_f32 v34, v34
  v_exp_f32 v35, v35
  v_mfma_f32_32x32x16_bf16 v[48:63], v[104:107], v[8:11], v[16:31]
  ds_read_b128 v[120:123], v5 offset:38912
  v_cvt_pk_bf16_f32 v80, v32, v33
  v_exp_f32 v36, v36
  v_exp_f32 v37, v37
  v_cvt_pk_bf16_f32 v81, v34, v35
  v_mfma_f32_16x16x32_bf16 v[88:91], v[92:95], v[84:87], v[88:91]
  ds_read_b128 v[124:127], v5 offset:39936
  v_exp_f32 v38, v38
  v_exp_f32 v39, v39
  v_mfma_f32_32x32x16_bf16 v[48:63], v[108:111], v[12:15], v[48:63]
  ds_read_b128 v[96:99], v5 offset:40960
  v_cvt_pk_bf16_f32 v82, v36, v37
  v_exp_f32 v40, v40
  v_cvt_pk_bf16_f32 v83, v38, v39
  v_exp_f32 v41, v41
  ds_read_b128 v[100:103], v5 offset:41984
  v_mfma_f32_32x32x16_bf16 v[64:79], v[112:115], v[80:83], v[64:79]
  v_exp_f32 v42, v42
  v_exp_f32 v43, v43
  v_cvt_pk_bf16_f32 v84, v40, v41
  v_exp_f32 v44, v44
  v_mfma_f32_16x16x32_bf16 v[88:91], v[92:95], v[80:83], v[88:91]
  v_exp_f32 v45, v45
  v_cvt_pk_bf16_f32 v85, v42, v43
  v_exp_f32 v46, v46
  v_exp_f32 v47, v47
  v_cvt_pk_bf16_f32 v86, v44, v45
  v_cvt_pk_bf16_f32 v87, v46, v47
  s_waitcnt lgkmcnt(0)
  v_exp_f32 v48, v48
  v_mfma_f32_32x32x16_bf16 v[64:79], v[116:119], v[84:87], v[64:79]
  v_exp_f32 v49, v49
  v_exp_f32 v50, v50
  v_exp_f32 v51, v51
  v_mfma_f32_32x32x16_bf16 v[32:47], v[96:99], v[8:11], v[16:31]
  ds_read_b128 v[112:115], v5 offset:43008
  v_cvt_pk_bf16_f32 v80, v48, v49
  v_exp_f32 v52, v52
  v_exp_f32 v53, v53
  v_cvt_pk_bf16_f32 v81, v50, v51
  v_mfma_f32_16x16x32_bf16 v[88:91], v[92:95], v[84:87], v[88:91]
  ds_read_b128 v[116:119], v5 offset:44032
  v_exp_f32 v54, v54
  v_exp_f32 v55, v55
  v_mfma_f32_32x32x16_bf16 v[32:47], v[100:103], v[12:15], v[32:47]
  ds_read_b128 v[104:107], v5 offset:45056
  v_cvt_pk_bf16_f32 v82, v52, v53
  v_exp_f32 v56, v56
  v_cvt_pk_bf16_f32 v83, v54, v55
  v_exp_f32 v57, v57
  ds_read_b128 v[108:111], v5 offset:46080
  v_mfma_f32_32x32x16_bf16 v[64:79], v[120:123], v[80:83], v[64:79]
  v_exp_f32 v58, v58
  v_exp_f32 v59, v59
  v_cvt_pk_bf16_f32 v84, v56, v57
  v_exp_f32 v60, v60
  v_mfma_f32_16x16x32_bf16 v[88:91], v[92:95], v[80:83], v[88:91]
  v_exp_f32 v61, v61
  v_cvt_pk_bf16_f32 v85, v58, v59
  v_exp_f32 v62, v62
  v_exp_f32 v63, v63
  v_cvt_pk_bf16_f32 v86, v60, v61
  v_cvt_pk_bf16_f32 v87, v62, v63
  s_waitcnt lgkmcnt(0)
  s_waitcnt vmcnt(8)
  s_barrier
  s_add_u32 s28, s25, 147456
  s_add_u32 m0, s26, 16384
  s_nop 0
  buffer_load_dwordx4 v4, s[12:15], s28 offen offset:0 sc1 lds
  buffer_load_dwordx4 v4, s[12:15], s28 offen offset:1024 sc1 lds
  buffer_load_dwordx4 v4, s[12:15], s28 offen offset:2048 sc1 lds
  buffer_load_dwordx4 v4, s[12:15], s28 offen offset:3072 sc1 lds
  s_add_u32 m0, s47, 32768
  s_mov_b32 s28, 524288
  buffer_load_dwordx4 v1, s[16:19], s28 offen lds
  s_add_u32 m0, s47, 33792
  s_mov_b32 s28, 532480
  buffer_load_dwordx4 v1, s[16:19], s28 offen lds
  s_add_u32 m0, s47, 34816
  s_mov_b32 s28, 540672
  buffer_load_dwordx4 v1, s[16:19], s28 offen lds
  s_add_u32 m0, s47, 35840
  s_mov_b32 s28, 548864
  buffer_load_dwordx4 v1, s[16:19], s28 offen lds
  v_exp_f32 v32, v32
  v_mfma_f32_32x32x16_bf16 v[64:79], v[124:127], v[84:87], v[64:79]
  v_exp_f32 v33, v33
  v_exp_f32 v34, v34
  v_exp_f32 v35, v35
  v_mfma_f32_32x32x16_bf16 v[48:63], v[104:107], v[8:11], v[16:31]
  ds_read_b128 v[120:123], v5 offset:47104
  v_cvt_pk_bf16_f32 v80, v32, v33
  v_exp_f32 v36, v36
  v_exp_f32 v37, v37
  v_cvt_pk_bf16_f32 v81, v34, v35
  v_mfma_f32_16x16x32_bf16 v[88:91], v[92:95], v[84:87], v[88:91]
  ds_read_b128 v[124:127], v5 offset:48128
  v_exp_f32 v38, v38
  v_exp_f32 v39, v39
  v_mfma_f32_32x32x16_bf16 v[48:63], v[108:111], v[12:15], v[48:63]
  ds_read_b128 v[96:99], v5 offset:49152
  v_cvt_pk_bf16_f32 v82, v36, v37
  v_exp_f32 v40, v40
  v_cvt_pk_bf16_f32 v83, v38, v39
  v_exp_f32 v41, v41
  ds_read_b128 v[100:103], v5 offset:50176
  v_mfma_f32_32x32x16_bf16 v[64:79], v[112:115], v[80:83], v[64:79]
  v_exp_f32 v42, v42
  v_exp_f32 v43, v43
  v_cvt_pk_bf16_f32 v84, v40, v41
  v_exp_f32 v44, v44
  v_mfma_f32_16x16x32_bf16 v[88:91], v[92:95], v[80:83], v[88:91]
  v_exp_f32 v45, v45
  v_cvt_pk_bf16_f32 v85, v42, v43
  v_exp_f32 v46, v46
  v_exp_f32 v47, v47
  v_cvt_pk_bf16_f32 v86, v44, v45
  v_cvt_pk_bf16_f32 v87, v46, v47
  s_waitcnt lgkmcnt(0)
  v_exp_f32 v48, v48
  v_mfma_f32_32x32x16_bf16 v[64:79], v[116:119], v[84:87], v[64:79]
  v_exp_f32 v49, v49
  v_exp_f32 v50, v50
  v_exp_f32 v51, v51
  v_mfma_f32_32x32x16_bf16 v[32:47], v[96:99], v[8:11], v[16:31]
  ds_read_b128 v[112:115], v5 offset:51200
  v_cvt_pk_bf16_f32 v80, v48, v49
  v_exp_f32 v52, v52
  v_exp_f32 v53, v53
  v_cvt_pk_bf16_f32 v81, v50, v51
  v_mfma_f32_16x16x32_bf16 v[88:91], v[92:95], v[84:87], v[88:91]
  ds_read_b128 v[116:119], v5 offset:52224
  ds_read_b64_tr_b16 v[176:177], v2 offset:0
  ds_read_b64_tr_b16 v[178:179], v2 offset:2048
  v_exp_f32 v54, v54
  v_exp_f32 v55, v55
  v_mfma_f32_32x32x16_bf16 v[32:47], v[100:103], v[12:15], v[32:47]
  ds_read_b128 v[104:107], v5 offset:53248
  v_cvt_pk_bf16_f32 v82, v52, v53
  v_exp_f32 v56, v56
  v_cvt_pk_bf16_f32 v83, v54, v55
  v_exp_f32 v57, v57
  ds_read_b128 v[108:111], v5 offset:54272
  ds_read_b64_tr_b16 v[180:181], v2 offset:4096
  ds_read_b64_tr_b16 v[182:183], v2 offset:6144
  v_mfma_f32_32x32x16_bf16 v[64:79], v[120:123], v[80:83], v[64:79]
  v_exp_f32 v58, v58
  v_exp_f32 v59, v59
  v_cvt_pk_bf16_f32 v84, v56, v57
  v_exp_f32 v60, v60
  v_mfma_f32_16x16x32_bf16 v[88:91], v[92:95], v[80:83], v[88:91]
  v_exp_f32 v61, v61
  v_cvt_pk_bf16_f32 v85, v58, v59
  v_exp_f32 v62, v62
  v_exp_f32 v63, v63
  v_cvt_pk_bf16_f32 v86, v60, v61
  v_cvt_pk_bf16_f32 v87, v62, v63
  s_waitcnt lgkmcnt(0)
  v_exp_f32 v32, v32
  v_mfma_f32_32x32x16_bf16 v[64:79], v[124:127], v[84:87], v[64:79]
  v_exp_f32 v33, v33
  v_exp_f32 v34, v34
  v_exp_f32 v35, v35
  v_mfma_f32_32x32x16_bf16 v[48:63], v[104:107], v[8:11], v[16:31]
  ds_read_b128 v[120:123], v5 offset:55296
  v_cvt_pk_bf16_f32 v80, v32, v33
  v_exp_f32 v36, v36
  v_exp_f32 v37, v37
  v_cvt_pk_bf16_f32 v81, v34, v35
  v_mfma_f32_16x16x32_bf16 v[88:91], v[92:95], v[84:87], v[88:91]
  ds_read_b128 v[124:127], v5 offset:56320
  v_exp_f32 v38, v38
  v_exp_f32 v39, v39
  v_mfma_f32_32x32x16_bf16 v[48:63], v[108:111], v[12:15], v[48:63]
  ds_read_b128 v[96:99], v5 offset:57344
  v_cvt_pk_bf16_f32 v82, v36, v37
  v_exp_f32 v40, v40
  v_cvt_pk_bf16_f32 v83, v38, v39
  v_exp_f32 v41, v41
  ds_read_b128 v[100:103], v5 offset:58368
  v_mfma_f32_32x32x16_bf16 v[64:79], v[112:115], v[80:83], v[64:79]
  v_exp_f32 v42, v42
  v_exp_f32 v43, v43
  v_cvt_pk_bf16_f32 v84, v40, v41
  v_exp_f32 v44, v44
  v_mfma_f32_16x16x32_bf16 v[88:91], v[92:95], v[80:83], v[88:91]
  v_exp_f32 v45, v45
  v_cvt_pk_bf16_f32 v85, v42, v43
  v_exp_f32 v46, v46
  v_exp_f32 v47, v47
  v_cvt_pk_bf16_f32 v86, v44, v45
  v_cvt_pk_bf16_f32 v87, v46, v47
  s_waitcnt lgkmcnt(0)
  v_exp_f32 v48, v48
  v_mfma_f32_32x32x16_bf16 v[64:79], v[116:119], v[84:87], v[64:79]
  v_exp_f32 v49, v49
  v_exp_f32 v50, v50
  v_exp_f32 v51, v51
  v_mfma_f32_32x32x16_bf16 v[32:47], v[96:99], v[8:11], v[16:31]
  ds_read_b128 v[112:115], v5 offset:59392
  v_cvt_pk_bf16_f32 v80, v48, v49
  v_exp_f32 v52, v52
  v_exp_f32 v53, v53
  v_cvt_pk_bf16_f32 v81, v50, v51
  v_mfma_f32_16x16x32_bf16 v[88:91], v[92:95], v[84:87], v[88:91]
  ds_read_b128 v[116:119], v5 offset:60416
  v_exp_f32 v54, v54
  v_exp_f32 v55, v55
  v_mfma_f32_32x32x16_bf16 v[32:47], v[100:103], v[12:15], v[32:47]
  ds_read_b128 v[104:107], v5 offset:61440
  v_cvt_pk_bf16_f32 v82, v52, v53
  v_exp_f32 v56, v56
  v_cvt_pk_bf16_f32 v83, v54, v55
  v_exp_f32 v57, v57
  ds_read_b128 v[108:111], v5 offset:62464
  v_mfma_f32_32x32x16_bf16 v[64:79], v[120:123], v[80:83], v[64:79]
  v_exp_f32 v58, v58
  v_exp_f32 v59, v59
  v_cvt_pk_bf16_f32 v84, v56, v57
  v_exp_f32 v60, v60
  v_mfma_f32_16x16x32_bf16 v[88:91], v[92:95], v[80:83], v[88:91]
  v_exp_f32 v61, v61
  v_cvt_pk_bf16_f32 v85, v58, v59
  v_exp_f32 v62, v62
  v_exp_f32 v63, v63
  v_cvt_pk_bf16_f32 v86, v60, v61
  v_cvt_pk_bf16_f32 v87, v62, v63
  s_waitcnt lgkmcnt(0)
  s_waitcnt vmcnt(8)
  s_barrier
  s_add_u32 s28, s25, 163840
  s_add_u32 m0, s26, 32768
  s_nop 0
  buffer_load_dwordx4 v4, s[12:15], s28 offen offset:0 sc1 lds
  buffer_load_dwordx4 v4, s[12:15], s28 offen offset:1024 sc1 lds
  buffer_load_dwordx4 v4, s[12:15], s28 offen offset:2048 sc1 lds
  buffer_load_dwordx4 v4, s[12:15], s28 offen offset:3072 sc1 lds
  s_add_u32 m0, s47, 0
  s_mov_b32 s28, 589824
  buffer_load_dwordx4 v1, s[16:19], s28 offen lds
  s_add_u32 m0, s47, 1024
  s_mov_b32 s28, 598016
  buffer_load_dwordx4 v1, s[16:19], s28 offen lds
  s_add_u32 m0, s47, 2048
  s_mov_b32 s28, 606208
  buffer_load_dwordx4 v1, s[16:19], s28 offen lds
  s_add_u32 m0, s47, 3072
  s_mov_b32 s28, 614400
  buffer_load_dwordx4 v1, s[16:19], s28 offen lds
  v_exp_f32 v32, v32
  v_mfma_f32_32x32x16_bf16 v[64:79], v[124:127], v[84:87], v[64:79]
  v_exp_f32 v33, v33
  v_exp_f32 v34, v34
  v_exp_f32 v35, v35
  v_mfma_f32_32x32x16_bf16 v[48:63], v[104:107], v[8:11], v[16:31]
  ds_read_b128 v[120:123], v5 offset:63488
  v_cvt_pk_bf16_f32 v80, v32, v33
  v_exp_f32 v36, v36
  v_exp_f32 v37, v37
  v_cvt_pk_bf16_f32 v81, v34, v35
  v_mfma_f32_16x16x32_bf16 v[88:91], v[92:95], v[84:87], v[88:91]
  ds_read_b128 v[124:127], v5 offset:64512
  v_exp_f32 v38, v38
  v_exp_f32 v39, v39
  v_mfma_f32_32x32x16_bf16 v[48:63], v[108:111], v[12:15], v[48:63]
  ds_read_b128 v[96:99], v5 offset:0
  v_cvt_pk_bf16_f32 v82, v36, v37
  v_exp_f32 v40, v40
  v_cvt_pk_bf16_f32 v83, v38, v39
  v_exp_f32 v41, v41
  ds_read_b128 v[100:103], v5 offset:1024
  v_mfma_f32_32x32x16_bf16 v[64:79], v[112:115], v[80:83], v[64:79]
  v_exp_f32 v42, v42
  v_exp_f32 v43, v43
  v_cvt_pk_bf16_f32 v84, v40, v41
  v_exp_f32 v44, v44
  v_mfma_f32_16x16x32_bf16 v[88:91], v[92:95], v[80:83], v[88:91]
  v_exp_f32 v45, v45
  v_cvt_pk_bf16_f32 v85, v42, v43
  v_exp_f32 v46, v46
  v_exp_f32 v47, v47
  v_cvt_pk_bf16_f32 v86, v44, v45
  v_cvt_pk_bf16_f32 v87, v46, v47
  s_waitcnt lgkmcnt(0)
  v_exp_f32 v48, v48
  v_mfma_f32_32x32x16_bf16 v[64:79], v[116:119], v[84:87], v[64:79]
  v_exp_f32 v49, v49
  v_exp_f32 v50, v50
  v_exp_f32 v51, v51
  v_mfma_f32_32x32x16_bf16 v[32:47], v[96:99], v[8:11], v[16:31]
  ds_read_b128 v[112:115], v5 offset:2048
  v_cvt_pk_bf16_f32 v80, v48, v49
  v_exp_f32 v52, v52
  v_exp_f32 v53, v53
  v_cvt_pk_bf16_f32 v81, v50, v51
  v_mfma_f32_16x16x32_bf16 v[88:91], v[92:95], v[84:87], v[88:91]
  ds_read_b128 v[116:119], v5 offset:3072
  ds_read_b64_tr_b16 v[184:185], v2 offset:16384
  ds_read_b64_tr_b16 v[186:187], v2 offset:18432
  v_exp_f32 v54, v54
  v_exp_f32 v55, v55
  v_mfma_f32_32x32x16_bf16 v[32:47], v[100:103], v[12:15], v[32:47]
  ds_read_b128 v[104:107], v5 offset:4096
  v_cvt_pk_bf16_f32 v82, v52, v53
  v_exp_f32 v56, v56
  v_cvt_pk_bf16_f32 v83, v54, v55
  v_exp_f32 v57, v57
  ds_read_b128 v[108:111], v5 offset:5120
  ds_read_b64_tr_b16 v[188:189], v2 offset:20480
  ds_read_b64_tr_b16 v[190:191], v2 offset:22528
  v_mfma_f32_32x32x16_bf16 v[64:79], v[120:123], v[80:83], v[64:79]
  v_exp_f32 v58, v58
  v_exp_f32 v59, v59
  v_cvt_pk_bf16_f32 v84, v56, v57
  v_exp_f32 v60, v60
  v_mfma_f32_16x16x32_bf16 v[88:91], v[92:95], v[80:83], v[88:91]
  v_exp_f32 v61, v61
  v_cvt_pk_bf16_f32 v85, v58, v59
  v_exp_f32 v62, v62
  v_exp_f32 v63, v63
  v_cvt_pk_bf16_f32 v86, v60, v61
  v_cvt_pk_bf16_f32 v87, v62, v63
  s_waitcnt lgkmcnt(0)
  v_exp_f32 v32, v32
  v_mfma_f32_32x32x16_bf16 v[64:79], v[124:127], v[84:87], v[64:79]
  v_exp_f32 v33, v33
  v_exp_f32 v34, v34
  v_exp_f32 v35, v35
  v_mfma_f32_32x32x16_bf16 v[48:63], v[104:107], v[8:11], v[16:31]
  ds_read_b128 v[120:123], v5 offset:6144
  v_cvt_pk_bf16_f32 v80, v32, v33
  v_exp_f32 v36, v36
  v_exp_f32 v37, v37
  v_cvt_pk_bf16_f32 v81, v34, v35
  v_mfma_f32_16x16x32_bf16 v[88:91], v[92:95], v[84:87], v[88:91]
  ds_read_b128 v[124:127], v5 offset:7168
  v_exp_f32 v38, v38
  v_exp_f32 v39, v39
  v_mfma_f32_32x32x16_bf16 v[48:63], v[108:111], v[12:15], v[48:63]
  ds_read_b128 v[96:99], v5 offset:8192
  v_cvt_pk_bf16_f32 v82, v36, v37
  v_exp_f32 v40, v40
  v_cvt_pk_bf16_f32 v83, v38, v39
  v_exp_f32 v41, v41
  ds_read_b128 v[100:103], v5 offset:9216
  v_mfma_f32_32x32x16_bf16 v[64:79], v[112:115], v[80:83], v[64:79]
  v_exp_f32 v42, v42
  v_exp_f32 v43, v43
  v_cvt_pk_bf16_f32 v84, v40, v41
  v_exp_f32 v44, v44
  v_mfma_f32_16x16x32_bf16 v[88:91], v[92:95], v[80:83], v[88:91]
  v_exp_f32 v45, v45
  v_cvt_pk_bf16_f32 v85, v42, v43
  v_exp_f32 v46, v46
  v_exp_f32 v47, v47
  v_cvt_pk_bf16_f32 v86, v44, v45
  v_cvt_pk_bf16_f32 v87, v46, v47
  s_waitcnt lgkmcnt(0)
  v_exp_f32 v48, v48
  v_mfma_f32_32x32x16_bf16 v[64:79], v[116:119], v[84:87], v[64:79]
  v_exp_f32 v49, v49
  v_exp_f32 v50, v50
  v_exp_f32 v51, v51
  v_mfma_f32_32x32x16_bf16 v[32:47], v[96:99], v[8:11], v[16:31]
  ds_read_b128 v[112:115], v5 offset:10240
  v_cvt_pk_bf16_f32 v80, v48, v49
  v_exp_f32 v52, v52
  v_exp_f32 v53, v53
  v_cvt_pk_bf16_f32 v81, v50, v51
  v_mfma_f32_16x16x32_bf16 v[88:91], v[92:95], v[84:87], v[88:91]
  ds_read_b128 v[116:119], v5 offset:11264
  v_exp_f32 v54, v54
  v_exp_f32 v55, v55
  v_mfma_f32_32x32x16_bf16 v[32:47], v[100:103], v[12:15], v[32:47]
  ds_read_b128 v[104:107], v5 offset:12288
  v_cvt_pk_bf16_f32 v82, v52, v53
  v_exp_f32 v56, v56
  v_cvt_pk_bf16_f32 v83, v54, v55
  v_exp_f32 v57, v57
  ds_read_b128 v[108:111], v5 offset:13312
  v_mfma_f32_32x32x16_bf16 v[64:79], v[120:123], v[80:83], v[64:79]
  v_exp_f32 v58, v58
  v_exp_f32 v59, v59
  v_cvt_pk_bf16_f32 v84, v56, v57
  v_exp_f32 v60, v60
  v_mfma_f32_16x16x32_bf16 v[88:91], v[92:95], v[80:83], v[88:91]
  v_exp_f32 v61, v61
  v_cvt_pk_bf16_f32 v85, v58, v59
  v_exp_f32 v62, v62
  v_exp_f32 v63, v63
  v_cvt_pk_bf16_f32 v86, v60, v61
  v_cvt_pk_bf16_f32 v87, v62, v63
  s_waitcnt lgkmcnt(0)
  s_waitcnt vmcnt(8)
  s_barrier
  s_add_u32 s28, s25, 180224
  s_add_u32 m0, s26, 49152
  s_nop 0
  buffer_load_dwordx4 v4, s[12:15], s28 offen offset:0 sc1 lds
  buffer_load_dwordx4 v4, s[12:15], s28 offen offset:1024 sc1 lds
  buffer_load_dwordx4 v4, s[12:15], s28 offen offset:2048 sc1 lds
  buffer_load_dwordx4 v4, s[12:15], s28 offen offset:3072 sc1 lds
  s_add_u32 m0, s47, 16384
  s_mov_b32 s28, 655360
  buffer_load_dwordx4 v1, s[16:19], s28 offen lds
  s_add_u32 m0, s47, 17408
  s_mov_b32 s28, 663552
  buffer_load_dwordx4 v1, s[16:19], s28 offen lds
  s_add_u32 m0, s47, 18432
  s_mov_b32 s28, 671744
  buffer_load_dwordx4 v1, s[16:19], s28 offen lds
  s_add_u32 m0, s47, 19456
  s_mov_b32 s28, 679936
  buffer_load_dwordx4 v1, s[16:19], s28 offen lds
  v_exp_f32 v32, v32
  v_mfma_f32_32x32x16_bf16 v[64:79], v[124:127], v[84:87], v[64:79]
  v_exp_f32 v33, v33
  v_exp_f32 v34, v34
  v_exp_f32 v35, v35
  v_mfma_f32_32x32x16_bf16 v[48:63], v[104:107], v[8:11], v[16:31]
  ds_read_b128 v[120:123], v5 offset:14336
  v_cvt_pk_bf16_f32 v80, v32, v33
  v_exp_f32 v36, v36
  v_exp_f32 v37, v37
  v_cvt_pk_bf16_f32 v81, v34, v35
  v_mfma_f32_16x16x32_bf16 v[88:91], v[92:95], v[84:87], v[88:91]
  ds_read_b128 v[124:127], v5 offset:15360
  v_exp_f32 v38, v38
  v_exp_f32 v39, v39
  v_mfma_f32_32x32x16_bf16 v[48:63], v[108:111], v[12:15], v[48:63]
  ds_read_b128 v[96:99], v5 offset:16384
  v_cvt_pk_bf16_f32 v82, v36, v37
  v_exp_f32 v40, v40
  v_cvt_pk_bf16_f32 v83, v38, v39
  v_exp_f32 v41, v41
  ds_read_b128 v[100:103], v5 offset:17408
  v_mfma_f32_32x32x16_bf16 v[64:79], v[112:115], v[80:83], v[64:79]
  v_exp_f32 v42, v42
  v_exp_f32 v43, v43
  v_cvt_pk_bf16_f32 v84, v40, v41
  v_exp_f32 v44, v44
  v_mfma_f32_16x16x32_bf16 v[88:91], v[92:95], v[80:83], v[88:91]
  v_exp_f32 v45, v45
  v_cvt_pk_bf16_f32 v85, v42, v43
  v_exp_f32 v46, v46
  v_exp_f32 v47, v47
  v_cvt_pk_bf16_f32 v86, v44, v45
  v_cvt_pk_bf16_f32 v87, v46, v47
  s_waitcnt lgkmcnt(0)
  v_exp_f32 v48, v48
  v_mfma_f32_32x32x16_bf16 v[64:79], v[116:119], v[84:87], v[64:79]
  v_exp_f32 v49, v49
  v_exp_f32 v50, v50
  v_exp_f32 v51, v51
  v_mfma_f32_32x32x16_bf16 v[32:47], v[96:99], v[8:11], v[16:31]
  ds_read_b128 v[112:115], v5 offset:18432
  v_cvt_pk_bf16_f32 v80, v48, v49
  v_exp_f32 v52, v52
  v_exp_f32 v53, v53
  v_cvt_pk_bf16_f32 v81, v50, v51
  v_mfma_f32_16x16x32_bf16 v[88:91], v[92:95], v[84:87], v[88:91]
  ds_read_b128 v[116:119], v5 offset:19456
  ds_read_b64_tr_b16 v[192:193], v2 offset:32768
  ds_read_b64_tr_b16 v[194:195], v2 offset:34816
  v_exp_f32 v54, v54
  v_exp_f32 v55, v55
  v_mfma_f32_32x32x16_bf16 v[32:47], v[100:103], v[12:15], v[32:47]
  ds_read_b128 v[104:107], v5 offset:20480
  v_cvt_pk_bf16_f32 v82, v52, v53
  v_exp_f32 v56, v56
  v_cvt_pk_bf16_f32 v83, v54, v55
  v_exp_f32 v57, v57
  ds_read_b128 v[108:111], v5 offset:21504
  ds_read_b64_tr_b16 v[196:197], v2 offset:36864
  ds_read_b64_tr_b16 v[198:199], v2 offset:38912
  v_mfma_f32_32x32x16_bf16 v[64:79], v[120:123], v[80:83], v[64:79]
  v_exp_f32 v58, v58
  v_exp_f32 v59, v59
  v_cvt_pk_bf16_f32 v84, v56, v57
  v_exp_f32 v60, v60
  v_mfma_f32_16x16x32_bf16 v[88:91], v[92:95], v[80:83], v[88:91]
  v_exp_f32 v61, v61
  v_cvt_pk_bf16_f32 v85, v58, v59
  v_exp_f32 v62, v62
  v_exp_f32 v63, v63
  v_cvt_pk_bf16_f32 v86, v60, v61
  v_cvt_pk_bf16_f32 v87, v62, v63
  s_waitcnt lgkmcnt(0)
  v_exp_f32 v32, v32
  v_mfma_f32_32x32x16_bf16 v[64:79], v[124:127], v[84:87], v[64:79]
  v_exp_f32 v33, v33
  v_exp_f32 v34, v34
  v_exp_f32 v35, v35
  v_mfma_f32_32x32x16_bf16 v[48:63], v[104:107], v[8:11], v[16:31]
  ds_read_b128 v[120:123], v5 offset:22528
  v_cvt_pk_bf16_f32 v80, v32, v33
  v_exp_f32 v36, v36
  v_exp_f32 v37, v37
  v_cvt_pk_bf16_f32 v81, v34, v35
  v_mfma_f32_16x16x32_bf16 v[88:91], v[92:95], v[84:87], v[88:91]
  ds_read_b128 v[124:127], v5 offset:23552
  v_exp_f32 v38, v38
  v_exp_f32 v39, v39
  v_mfma_f32_32x32x16_bf16 v[48:63], v[108:111], v[12:15], v[48:63]
  ds_read_b128 v[96:99], v5 offset:24576
  v_cvt_pk_bf16_f32 v82, v36, v37
  v_exp_f32 v40, v40
  v_cvt_pk_bf16_f32 v83, v38, v39
  v_exp_f32 v41, v41
  ds_read_b128 v[100:103], v5 offset:25600
  v_mfma_f32_32x32x16_bf16 v[64:79], v[112:115], v[80:83], v[64:79]
  v_exp_f32 v42, v42
  v_exp_f32 v43, v43
  v_cvt_pk_bf16_f32 v84, v40, v41
  v_exp_f32 v44, v44
  v_mfma_f32_16x16x32_bf16 v[88:91], v[92:95], v[80:83], v[88:91]
  v_exp_f32 v45, v45
  v_cvt_pk_bf16_f32 v85, v42, v43
  v_exp_f32 v46, v46
  v_exp_f32 v47, v47
  v_cvt_pk_bf16_f32 v86, v44, v45
  v_cvt_pk_bf16_f32 v87, v46, v47
  s_waitcnt lgkmcnt(0)
  v_exp_f32 v48, v48
  v_mfma_f32_32x32x16_bf16 v[64:79], v[116:119], v[84:87], v[64:79]
  v_exp_f32 v49, v49
  v_exp_f32 v50, v50
  v_exp_f32 v51, v51
  v_mfma_f32_32x32x16_bf16 v[32:47], v[96:99], v[8:11], v[16:31]
  ds_read_b128 v[112:115], v5 offset:26624
  v_cvt_pk_bf16_f32 v80, v48, v49
  v_exp_f32 v52, v52
  v_exp_f32 v53, v53
  v_cvt_pk_bf16_f32 v81, v50, v51
  v_mfma_f32_16x16x32_bf16 v[88:91], v[92:95], v[84:87], v[88:91]
  ds_read_b128 v[116:119], v5 offset:27648
  v_exp_f32 v54, v54
  v_exp_f32 v55, v55
  v_mfma_f32_32x32x16_bf16 v[32:47], v[100:103], v[12:15], v[32:47]
  ds_read_b128 v[104:107], v5 offset:28672
  v_cvt_pk_bf16_f32 v82, v52, v53
  v_exp_f32 v56, v56
  v_cvt_pk_bf16_f32 v83, v54, v55
  v_exp_f32 v57, v57
  ds_read_b128 v[108:111], v5 offset:29696
  v_mfma_f32_32x32x16_bf16 v[64:79], v[120:123], v[80:83], v[64:79]
  v_exp_f32 v58, v58
  v_exp_f32 v59, v59
  v_cvt_pk_bf16_f32 v84, v56, v57
  v_exp_f32 v60, v60
  v_mfma_f32_16x16x32_bf16 v[88:91], v[92:95], v[80:83], v[88:91]
  v_exp_f32 v61, v61
  v_cvt_pk_bf16_f32 v85, v58, v59
  v_exp_f32 v62, v62
  v_exp_f32 v63, v63
  v_cvt_pk_bf16_f32 v86, v60, v61
  v_cvt_pk_bf16_f32 v87, v62, v63
  s_waitcnt lgkmcnt(0)
  s_waitcnt vmcnt(8)
  s_barrier
  s_add_u32 s28, s25, 196608
  s_add_u32 m0, s26, 0
  s_nop 0
  buffer_load_dwordx4 v4, s[12:15], s28 offen offset:0 sc1 lds
  buffer_load_dwordx4 v4, s[12:15], s28 offen offset:1024 sc1 lds
  buffer_load_dwordx4 v4, s[12:15], s28 offen offset:2048 sc1 lds
  buffer_load_dwordx4 v4, s[12:15], s28 offen offset:3072 sc1 lds
  s_add_u32 m0, s47, 32768
  s_mov_b32 s28, 720896
  buffer_load_dwordx4 v1, s[16:19], s28 offen lds
  s_add_u32 m0, s47, 33792
  s_mov_b32 s28, 729088
  buffer_load_dwordx4 v1, s[16:19], s28 offen lds
  s_add_u32 m0, s47, 34816
  s_mov_b32 s28, 737280
  buffer_load_dwordx4 v1, s[16:19], s28 offen lds
  s_add_u32 m0, s47, 35840
  s_mov_b32 s28, 745472
  buffer_load_dwordx4 v1, s[16:19], s28 offen lds
  v_exp_f32 v32, v32
  v_mfma_f32_32x32x16_bf16 v[64:79], v[124:127], v[84:87], v[64:79]
  v_exp_f32 v33, v33
  v_exp_f32 v34, v34
  v_exp_f32 v35, v35
  v_mfma_f32_32x32x16_bf16 v[48:63], v[104:107], v[8:11], v[16:31]
  ds_read_b128 v[120:123], v5 offset:30720
  v_cvt_pk_bf16_f32 v80, v32, v33
  v_exp_f32 v36, v36
  v_exp_f32 v37, v37
  v_cvt_pk_bf16_f32 v81, v34, v35
  v_mfma_f32_16x16x32_bf16 v[88:91], v[92:95], v[84:87], v[88:91]
  ds_read_b128 v[124:127], v5 offset:31744
  v_exp_f32 v38, v38
  v_exp_f32 v39, v39
  v_mfma_f32_32x32x16_bf16 v[48:63], v[108:111], v[12:15], v[48:63]
  ds_read_b128 v[96:99], v5 offset:32768
  v_cvt_pk_bf16_f32 v82, v36, v37
  v_exp_f32 v40, v40
  v_cvt_pk_bf16_f32 v83, v38, v39
  v_exp_f32 v41, v41
  ds_read_b128 v[100:103], v5 offset:33792
  v_mfma_f32_32x32x16_bf16 v[64:79], v[112:115], v[80:83], v[64:79]
  v_exp_f32 v42, v42
  v_exp_f32 v43, v43
  v_cvt_pk_bf16_f32 v84, v40, v41
  v_exp_f32 v44, v44
  v_mfma_f32_16x16x32_bf16 v[88:91], v[92:95], v[80:83], v[88:91]
  v_exp_f32 v45, v45
  v_cvt_pk_bf16_f32 v85, v42, v43
  v_exp_f32 v46, v46
  v_exp_f32 v47, v47
  v_cvt_pk_bf16_f32 v86, v44, v45
  v_cvt_pk_bf16_f32 v87, v46, v47
  s_waitcnt lgkmcnt(0)
  v_exp_f32 v48, v48
  v_mfma_f32_32x32x16_bf16 v[64:79], v[116:119], v[84:87], v[64:79]
  v_exp_f32 v49, v49
  v_exp_f32 v50, v50
  v_exp_f32 v51, v51
  v_mfma_f32_32x32x16_bf16 v[32:47], v[96:99], v[8:11], v[16:31]
  ds_read_b128 v[112:115], v5 offset:34816
  v_cvt_pk_bf16_f32 v80, v48, v49
  v_exp_f32 v52, v52
  v_exp_f32 v53, v53
  v_cvt_pk_bf16_f32 v81, v50, v51
  v_mfma_f32_16x16x32_bf16 v[88:91], v[92:95], v[84:87], v[88:91]
  ds_read_b128 v[116:119], v5 offset:35840
  ds_read_b64_tr_b16 v[200:201], v2 offset:0
  ds_read_b64_tr_b16 v[202:203], v2 offset:2048
  v_exp_f32 v54, v54
  v_exp_f32 v55, v55
  v_mfma_f32_32x32x16_bf16 v[32:47], v[100:103], v[12:15], v[32:47]
  ds_read_b128 v[104:107], v5 offset:36864
  v_cvt_pk_bf16_f32 v82, v52, v53
  v_exp_f32 v56, v56
  v_cvt_pk_bf16_f32 v83, v54, v55
  v_exp_f32 v57, v57
  ds_read_b128 v[108:111], v5 offset:37888
  ds_read_b64_tr_b16 v[204:205], v2 offset:4096
  ds_read_b64_tr_b16 v[206:207], v2 offset:6144
  v_mfma_f32_32x32x16_bf16 v[64:79], v[120:123], v[80:83], v[64:79]
  v_exp_f32 v58, v58
  v_exp_f32 v59, v59
  v_cvt_pk_bf16_f32 v84, v56, v57
  v_exp_f32 v60, v60
  v_mfma_f32_16x16x32_bf16 v[88:91], v[92:95], v[80:83], v[88:91]
  v_exp_f32 v61, v61
  v_cvt_pk_bf16_f32 v85, v58, v59
  v_exp_f32 v62, v62
  v_exp_f32 v63, v63
  v_cvt_pk_bf16_f32 v86, v60, v61
  v_cvt_pk_bf16_f32 v87, v62, v63
  s_waitcnt lgkmcnt(0)
  v_exp_f32 v32, v32
  v_mfma_f32_32x32x16_bf16 v[64:79], v[124:127], v[84:87], v[64:79]
  v_exp_f32 v33, v33
  v_exp_f32 v34, v34
  v_exp_f32 v35, v35
  v_mfma_f32_32x32x16_bf16 v[48:63], v[104:107], v[8:11], v[16:31]
  ds_read_b128 v[120:123], v5 offset:38912
  v_cvt_pk_bf16_f32 v80, v32, v33
  v_exp_f32 v36, v36
  v_exp_f32 v37, v37
  v_cvt_pk_bf16_f32 v81, v34, v35
  v_mfma_f32_16x16x32_bf16 v[88:91], v[92:95], v[84:87], v[88:91]
  ds_read_b128 v[124:127], v5 offset:39936
  v_exp_f32 v38, v38
  v_exp_f32 v39, v39
  v_mfma_f32_32x32x16_bf16 v[48:63], v[108:111], v[12:15], v[48:63]
  ds_read_b128 v[96:99], v5 offset:40960
  v_cvt_pk_bf16_f32 v82, v36, v37
  v_exp_f32 v40, v40
  v_cvt_pk_bf16_f32 v83, v38, v39
  v_exp_f32 v41, v41
  ds_read_b128 v[100:103], v5 offset:41984
  v_mfma_f32_32x32x16_bf16 v[64:79], v[112:115], v[80:83], v[64:79]
  v_exp_f32 v42, v42
  v_exp_f32 v43, v43
  v_cvt_pk_bf16_f32 v84, v40, v41
  v_exp_f32 v44, v44
  v_mfma_f32_16x16x32_bf16 v[88:91], v[92:95], v[80:83], v[88:91]
  v_exp_f32 v45, v45
  v_cvt_pk_bf16_f32 v85, v42, v43
  v_exp_f32 v46, v46
  v_exp_f32 v47, v47
  v_cvt_pk_bf16_f32 v86, v44, v45
  v_cvt_pk_bf16_f32 v87, v46, v47
  s_waitcnt lgkmcnt(0)
  v_exp_f32 v48, v48
  v_mfma_f32_32x32x16_bf16 v[64:79], v[116:119], v[84:87], v[64:79]
  v_exp_f32 v49, v49
  v_exp_f32 v50, v50
  v_exp_f32 v51, v51
  v_mfma_f32_32x32x16_bf16 v[32:47], v[96:99], v[8:11], v[16:31]
  ds_read_b128 v[112:115], v5 offset:43008
  v_cvt_pk_bf16_f32 v80, v48, v49
  v_exp_f32 v52, v52
  v_exp_f32 v53, v53
  v_cvt_pk_bf16_f32 v81, v50, v51
  v_mfma_f32_16x16x32_bf16 v[88:91], v[92:95], v[84:87], v[88:91]
  ds_read_b128 v[116:119], v5 offset:44032
  v_exp_f32 v54, v54
  v_exp_f32 v55, v55
  v_mfma_f32_32x32x16_bf16 v[32:47], v[100:103], v[12:15], v[32:47]
  ds_read_b128 v[104:107], v5 offset:45056
  v_cvt_pk_bf16_f32 v82, v52, v53
  v_exp_f32 v56, v56
  v_cvt_pk_bf16_f32 v83, v54, v55
  v_exp_f32 v57, v57
  ds_read_b128 v[108:111], v5 offset:46080
  v_mfma_f32_32x32x16_bf16 v[64:79], v[120:123], v[80:83], v[64:79]
  v_exp_f32 v58, v58
  v_exp_f32 v59, v59
  v_cvt_pk_bf16_f32 v84, v56, v57
  v_exp_f32 v60, v60
  v_mfma_f32_16x16x32_bf16 v[88:91], v[92:95], v[80:83], v[88:91]
  v_exp_f32 v61, v61
  v_cvt_pk_bf16_f32 v85, v58, v59
  v_exp_f32 v62, v62
  v_exp_f32 v63, v63
  v_cvt_pk_bf16_f32 v86, v60, v61
  v_cvt_pk_bf16_f32 v87, v62, v63
  s_waitcnt lgkmcnt(0)
  s_waitcnt vmcnt(8)
  s_barrier
  s_add_u32 s28, s25, 212992
  s_add_u32 m0, s26, 16384
  s_nop 0
  buffer_load_dwordx4 v4, s[12:15], s28 offen offset:0 sc1 lds
  buffer_load_dwordx4 v4, s[12:15], s28 offen offset:1024 sc1 lds
  buffer_load_dwordx4 v4, s[12:15], s28 offen offset:2048 sc1 lds
  buffer_load_dwordx4 v4, s[12:15], s28 offen offset:3072 sc1 lds
  s_add_u32 m0, s47, 0
  s_mov_b32 s28, 786432
  buffer_load_dwordx4 v1, s[16:19], s28 offen lds
  s_add_u32 m0, s47, 1024
  s_mov_b32 s28, 794624
  buffer_load_dwordx4 v1, s[16:19], s28 offen lds
  s_add_u32 m0, s47, 2048
  s_mov_b32 s28, 802816
  buffer_load_dwordx4 v1, s[16:19], s28 offen lds
  s_add_u32 m0, s47, 3072
  s_mov_b32 s28, 811008
  buffer_load_dwordx4 v1, s[16:19], s28 offen lds
  v_exp_f32 v32, v32
  v_mfma_f32_32x32x16_bf16 v[64:79], v[124:127], v[84:87], v[64:79]
  v_exp_f32 v33, v33
  v_exp_f32 v34, v34
  v_exp_f32 v35, v35
  v_mfma_f32_32x32x16_bf16 v[48:63], v[104:107], v[8:11], v[16:31]
  ds_read_b128 v[120:123], v5 offset:47104
  v_cvt_pk_bf16_f32 v80, v32, v33
  v_exp_f32 v36, v36
  v_exp_f32 v37, v37
  v_cvt_pk_bf16_f32 v81, v34, v35
  v_mfma_f32_16x16x32_bf16 v[88:91], v[92:95], v[84:87], v[88:91]
  ds_read_b128 v[124:127], v5 offset:48128
  v_exp_f32 v38, v38
  v_exp_f32 v39, v39
  v_mfma_f32_32x32x16_bf16 v[48:63], v[108:111], v[12:15], v[48:63]
  ds_read_b128 v[96:99], v5 offset:49152
  v_cvt_pk_bf16_f32 v82, v36, v37
  v_exp_f32 v40, v40
  v_cvt_pk_bf16_f32 v83, v38, v39
  v_exp_f32 v41, v41
  ds_read_b128 v[100:103], v5 offset:50176
  v_mfma_f32_32x32x16_bf16 v[64:79], v[112:115], v[80:83], v[64:79]
  v_exp_f32 v42, v42
  v_exp_f32 v43, v43
  v_cvt_pk_bf16_f32 v84, v40, v41
  v_exp_f32 v44, v44
  v_mfma_f32_16x16x32_bf16 v[88:91], v[92:95], v[80:83], v[88:91]
  v_exp_f32 v45, v45
  v_cvt_pk_bf16_f32 v85, v42, v43
  v_exp_f32 v46, v46
  v_exp_f32 v47, v47
  v_cvt_pk_bf16_f32 v86, v44, v45
  v_cvt_pk_bf16_f32 v87, v46, v47
  s_waitcnt lgkmcnt(0)
  v_exp_f32 v48, v48
  v_mfma_f32_32x32x16_bf16 v[64:79], v[116:119], v[84:87], v[64:79]
  v_exp_f32 v49, v49
  v_exp_f32 v50, v50
  v_exp_f32 v51, v51
  v_mfma_f32_32x32x16_bf16 v[32:47], v[96:99], v[8:11], v[16:31]
  ds_read_b128 v[112:115], v5 offset:51200
  v_cvt_pk_bf16_f32 v80, v48, v49
  v_exp_f32 v52, v52
  v_exp_f32 v53, v53
  v_cvt_pk_bf16_f32 v81, v50, v51
  v_mfma_f32_16x16x32_bf16 v[88:91], v[92:95], v[84:87], v[88:91]
  ds_read_b128 v[116:119], v5 offset:52224
  ds_read_b64_tr_b16 v[208:209], v2 offset:16384
  ds_read_b64_tr_b16 v[210:211], v2 offset:18432
  v_exp_f32 v54, v54
  v_exp_f32 v55, v55
  v_mfma_f32_32x32x16_bf16 v[32:47], v[100:103], v[12:15], v[32:47]
  ds_read_b128 v[104:107], v5 offset:53248
  v_cvt_pk_bf16_f32 v82, v52, v53
  v_exp_f32 v56, v56
  v_cvt_pk_bf16_f32 v83, v54, v55
  v_exp_f32 v57, v57
  ds_read_b128 v[108:111], v5 offset:54272
  ds_read_b64_tr_b16 v[212:213], v2 offset:20480
  ds_read_b64_tr_b16 v[214:215], v2 offset:22528
  v_mfma_f32_32x32x16_bf16 v[64:79], v[120:123], v[80:83], v[64:79]
  v_exp_f32 v58, v58
  v_exp_f32 v59, v59
  v_cvt_pk_bf16_f32 v84, v56, v57
  v_exp_f32 v60, v60
  v_mfma_f32_16x16x32_bf16 v[88:91], v[92:95], v[80:83], v[88:91]
  v_exp_f32 v61, v61
  v_cvt_pk_bf16_f32 v85, v58, v59
  v_exp_f32 v62, v62
  v_exp_f32 v63, v63
  v_cvt_pk_bf16_f32 v86, v60, v61
  v_cvt_pk_bf16_f32 v87, v62, v63
  s_waitcnt lgkmcnt(0)
  v_exp_f32 v32, v32
  v_mfma_f32_32x32x16_bf16 v[64:79], v[124:127], v[84:87], v[64:79]
  v_exp_f32 v33, v33
  v_exp_f32 v34, v34
  v_exp_f32 v35, v35
  v_mfma_f32_32x32x16_bf16 v[48:63], v[104:107], v[8:11], v[16:31]
  ds_read_b128 v[120:123], v5 offset:55296
  v_cvt_pk_bf16_f32 v80, v32, v33
  v_exp_f32 v36, v36
  v_exp_f32 v37, v37
  v_cvt_pk_bf16_f32 v81, v34, v35
  v_mfma_f32_16x16x32_bf16 v[88:91], v[92:95], v[84:87], v[88:91]
  ds_read_b128 v[124:127], v5 offset:56320
  v_exp_f32 v38, v38
  v_exp_f32 v39, v39
  v_mfma_f32_32x32x16_bf16 v[48:63], v[108:111], v[12:15], v[48:63]
  ds_read_b128 v[96:99], v5 offset:57344
  v_cvt_pk_bf16_f32 v82, v36, v37
  v_exp_f32 v40, v40
  v_cvt_pk_bf16_f32 v83, v38, v39
  v_exp_f32 v41, v41
  ds_read_b128 v[100:103], v5 offset:58368
  v_mfma_f32_32x32x16_bf16 v[64:79], v[112:115], v[80:83], v[64:79]
  v_exp_f32 v42, v42
  v_exp_f32 v43, v43
  v_cvt_pk_bf16_f32 v84, v40, v41
  v_exp_f32 v44, v44
  v_mfma_f32_16x16x32_bf16 v[88:91], v[92:95], v[80:83], v[88:91]
  v_exp_f32 v45, v45
  v_cvt_pk_bf16_f32 v85, v42, v43
  v_exp_f32 v46, v46
  v_exp_f32 v47, v47
  v_cvt_pk_bf16_f32 v86, v44, v45
  v_cvt_pk_bf16_f32 v87, v46, v47
  s_waitcnt lgkmcnt(0)
  v_exp_f32 v48, v48
  v_mfma_f32_32x32x16_bf16 v[64:79], v[116:119], v[84:87], v[64:79]
  v_exp_f32 v49, v49
  v_exp_f32 v50, v50
  v_exp_f32 v51, v51
  v_mfma_f32_32x32x16_bf16 v[32:47], v[96:99], v[8:11], v[16:31]
  ds_read_b128 v[112:115], v5 offset:59392
  v_cvt_pk_bf16_f32 v80, v48, v49
  v_exp_f32 v52, v52
  v_exp_f32 v53, v53
  v_cvt_pk_bf16_f32 v81, v50, v51
  v_mfma_f32_16x16x32_bf16 v[88:91], v[92:95], v[84:87], v[88:91]
  ds_read_b128 v[116:119], v5 offset:60416
  v_exp_f32 v54, v54
  v_exp_f32 v55, v55
  v_mfma_f32_32x32x16_bf16 v[32:47], v[100:103], v[12:15], v[32:47]
  ds_read_b128 v[104:107], v5 offset:61440
  v_cvt_pk_bf16_f32 v82, v52, v53
  v_exp_f32 v56, v56
  v_cvt_pk_bf16_f32 v83, v54, v55
  v_exp_f32 v57, v57
  ds_read_b128 v[108:111], v5 offset:62464
  v_mfma_f32_32x32x16_bf16 v[64:79], v[120:123], v[80:83], v[64:79]
  v_exp_f32 v58, v58
  v_exp_f32 v59, v59
  v_cvt_pk_bf16_f32 v84, v56, v57
  v_exp_f32 v60, v60
  v_mfma_f32_16x16x32_bf16 v[88:91], v[92:95], v[80:83], v[88:91]
  v_exp_f32 v61, v61
  v_cvt_pk_bf16_f32 v85, v58, v59
  v_exp_f32 v62, v62
  v_exp_f32 v63, v63
  v_cvt_pk_bf16_f32 v86, v60, v61
  v_cvt_pk_bf16_f32 v87, v62, v63
  s_waitcnt lgkmcnt(0)
  s_waitcnt vmcnt(8)
  s_barrier
  s_add_u32 s28, s25, 229376
  s_add_u32 m0, s26, 32768
  s_nop 0
  buffer_load_dwordx4 v4, s[12:15], s28 offen offset:0 sc1 lds
  buffer_load_dwordx4 v4, s[12:15], s28 offen offset:1024 sc1 lds
  buffer_load_dwordx4 v4, s[12:15], s28 offen offset:2048 sc1 lds
  buffer_load_dwordx4 v4, s[12:15], s28 offen offset:3072 sc1 lds
  s_add_u32 m0, s47, 16384
  s_mov_b32 s28, 851968
  buffer_load_dwordx4 v1, s[16:19], s28 offen lds
  s_add_u32 m0, s47, 17408
  s_mov_b32 s28, 860160
  buffer_load_dwordx4 v1, s[16:19], s28 offen lds
  s_add_u32 m0, s47, 18432
  s_mov_b32 s28, 868352
  buffer_load_dwordx4 v1, s[16:19], s28 offen lds
  s_add_u32 m0, s47, 19456
  s_mov_b32 s28, 876544
  buffer_load_dwordx4 v1, s[16:19], s28 offen lds
  v_exp_f32 v32, v32
  v_mfma_f32_32x32x16_bf16 v[64:79], v[124:127], v[84:87], v[64:79]
  v_exp_f32 v33, v33
  v_exp_f32 v34, v34
  v_exp_f32 v35, v35
  v_mfma_f32_32x32x16_bf16 v[48:63], v[104:107], v[8:11], v[16:31]
  ds_read_b128 v[120:123], v5 offset:63488
  v_cvt_pk_bf16_f32 v80, v32, v33
  v_exp_f32 v36, v36
  v_exp_f32 v37, v37
  v_cvt_pk_bf16_f32 v81, v34, v35
  v_mfma_f32_16x16x32_bf16 v[88:91], v[92:95], v[84:87], v[88:91]
  ds_read_b128 v[124:127], v5 offset:64512
  v_exp_f32 v38, v38
  v_exp_f32 v39, v39
  v_mfma_f32_32x32x16_bf16 v[48:63], v[108:111], v[12:15], v[48:63]
  ds_read_b128 v[96:99], v5 offset:0
  v_cvt_pk_bf16_f32 v82, v36, v37
  v_exp_f32 v40, v40
  v_cvt_pk_bf16_f32 v83, v38, v39
  v_exp_f32 v41, v41
  ds_read_b128 v[100:103], v5 offset:1024
  v_mfma_f32_32x32x16_bf16 v[64:79], v[112:115], v[80:83], v[64:79]
  v_exp_f32 v42, v42
  v_exp_f32 v43, v43
  v_cvt_pk_bf16_f32 v84, v40, v41
  v_exp_f32 v44, v44
  v_mfma_f32_16x16x32_bf16 v[88:91], v[92:95], v[80:83], v[88:91]
  v_exp_f32 v45, v45
  v_cvt_pk_bf16_f32 v85, v42, v43
  v_exp_f32 v46, v46
  v_exp_f32 v47, v47
  v_cvt_pk_bf16_f32 v86, v44, v45
  v_cvt_pk_bf16_f32 v87, v46, v47
  s_waitcnt lgkmcnt(0)
  v_exp_f32 v48, v48
  v_mfma_f32_32x32x16_bf16 v[64:79], v[116:119], v[84:87], v[64:79]
  v_exp_f32 v49, v49
  v_exp_f32 v50, v50
  v_exp_f32 v51, v51
  v_mfma_f32_32x32x16_bf16 v[32:47], v[96:99], v[8:11], v[16:31]
  ds_read_b128 v[112:115], v5 offset:2048
  v_cvt_pk_bf16_f32 v80, v48, v49
  v_exp_f32 v52, v52
  v_exp_f32 v53, v53
  v_cvt_pk_bf16_f32 v81, v50, v51
  v_mfma_f32_16x16x32_bf16 v[88:91], v[92:95], v[84:87], v[88:91]
  ds_read_b128 v[116:119], v5 offset:3072
  ds_read_b64_tr_b16 v[216:217], v2 offset:32768
  ds_read_b64_tr_b16 v[218:219], v2 offset:34816
  v_exp_f32 v54, v54
  v_exp_f32 v55, v55
  v_mfma_f32_32x32x16_bf16 v[32:47], v[100:103], v[12:15], v[32:47]
  ds_read_b128 v[104:107], v5 offset:4096
  v_cvt_pk_bf16_f32 v82, v52, v53
  v_exp_f32 v56, v56
  v_cvt_pk_bf16_f32 v83, v54, v55
  v_exp_f32 v57, v57
  ds_read_b128 v[108:111], v5 offset:5120
  ds_read_b64_tr_b16 v[220:221], v2 offset:36864
  ds_read_b64_tr_b16 v[222:223], v2 offset:38912
  v_mfma_f32_32x32x16_bf16 v[64:79], v[120:123], v[80:83], v[64:79]
  v_exp_f32 v58, v58
  v_exp_f32 v59, v59
  v_cvt_pk_bf16_f32 v84, v56, v57
  v_exp_f32 v60, v60
  v_mfma_f32_16x16x32_bf16 v[88:91], v[92:95], v[80:83], v[88:91]
  v_exp_f32 v61, v61
  v_cvt_pk_bf16_f32 v85, v58, v59
  v_exp_f32 v62, v62
  v_exp_f32 v63, v63
  v_cvt_pk_bf16_f32 v86, v60, v61
  v_cvt_pk_bf16_f32 v87, v62, v63
  s_waitcnt lgkmcnt(0)
  v_exp_f32 v32, v32
  v_mfma_f32_32x32x16_bf16 v[64:79], v[124:127], v[84:87], v[64:79]
  v_exp_f32 v33, v33
  v_exp_f32 v34, v34
  v_exp_f32 v35, v35
  v_mfma_f32_32x32x16_bf16 v[48:63], v[104:107], v[8:11], v[16:31]
  ds_read_b128 v[120:123], v5 offset:6144
  v_cvt_pk_bf16_f32 v80, v32, v33
  v_exp_f32 v36, v36
  v_exp_f32 v37, v37
  v_cvt_pk_bf16_f32 v81, v34, v35
  v_mfma_f32_16x16x32_bf16 v[88:91], v[92:95], v[84:87], v[88:91]
  ds_read_b128 v[124:127], v5 offset:7168
  v_exp_f32 v38, v38
  v_exp_f32 v39, v39
  v_mfma_f32_32x32x16_bf16 v[48:63], v[108:111], v[12:15], v[48:63]
  ds_read_b128 v[96:99], v5 offset:8192
  v_cvt_pk_bf16_f32 v82, v36, v37
  v_exp_f32 v40, v40
  v_cvt_pk_bf16_f32 v83, v38, v39
  v_exp_f32 v41, v41
  ds_read_b128 v[100:103], v5 offset:9216
  v_mfma_f32_32x32x16_bf16 v[64:79], v[112:115], v[80:83], v[64:79]
  v_exp_f32 v42, v42
  v_exp_f32 v43, v43
  v_cvt_pk_bf16_f32 v84, v40, v41
  v_exp_f32 v44, v44
  v_mfma_f32_16x16x32_bf16 v[88:91], v[92:95], v[80:83], v[88:91]
  v_exp_f32 v45, v45
  v_cvt_pk_bf16_f32 v85, v42, v43
  v_exp_f32 v46, v46
  v_exp_f32 v47, v47
  v_cvt_pk_bf16_f32 v86, v44, v45
  v_cvt_pk_bf16_f32 v87, v46, v47
  s_waitcnt lgkmcnt(0)
  v_exp_f32 v48, v48
  v_mfma_f32_32x32x16_bf16 v[64:79], v[116:119], v[84:87], v[64:79]
  v_exp_f32 v49, v49
  v_exp_f32 v50, v50
  v_exp_f32 v51, v51
  v_mfma_f32_32x32x16_bf16 v[32:47], v[96:99], v[8:11], v[16:31]
  ds_read_b128 v[112:115], v5 offset:10240
  v_cvt_pk_bf16_f32 v80, v48, v49
  v_exp_f32 v52, v52
  v_exp_f32 v53, v53
  v_cvt_pk_bf16_f32 v81, v50, v51
  v_mfma_f32_16x16x32_bf16 v[88:91], v[92:95], v[84:87], v[88:91]
  ds_read_b128 v[116:119], v5 offset:11264
  v_exp_f32 v54, v54
  v_exp_f32 v55, v55
  v_mfma_f32_32x32x16_bf16 v[32:47], v[100:103], v[12:15], v[32:47]
  ds_read_b128 v[104:107], v5 offset:12288
  v_cvt_pk_bf16_f32 v82, v52, v53
  v_exp_f32 v56, v56
  v_cvt_pk_bf16_f32 v83, v54, v55
  v_exp_f32 v57, v57
  ds_read_b128 v[108:111], v5 offset:13312
  v_mfma_f32_32x32x16_bf16 v[64:79], v[120:123], v[80:83], v[64:79]
  v_exp_f32 v58, v58
  v_exp_f32 v59, v59
  v_cvt_pk_bf16_f32 v84, v56, v57
  v_exp_f32 v60, v60
  v_mfma_f32_16x16x32_bf16 v[88:91], v[92:95], v[80:83], v[88:91]
  v_exp_f32 v61, v61
  v_cvt_pk_bf16_f32 v85, v58, v59
  v_exp_f32 v62, v62
  v_exp_f32 v63, v63
  v_cvt_pk_bf16_f32 v86, v60, v61
  v_cvt_pk_bf16_f32 v87, v62, v63
  s_waitcnt lgkmcnt(0)
  s_waitcnt vmcnt(8)
  s_barrier
  s_add_u32 s28, s25, 245760
  s_add_u32 m0, s26, 49152
  s_nop 0
  buffer_load_dwordx4 v4, s[12:15], s28 offen offset:0 sc1 lds
  buffer_load_dwordx4 v4, s[12:15], s28 offen offset:1024 sc1 lds
  buffer_load_dwordx4 v4, s[12:15], s28 offen offset:2048 sc1 lds
  buffer_load_dwordx4 v4, s[12:15], s28 offen offset:3072 sc1 lds
  s_add_u32 m0, s47, 32768
  s_mov_b32 s28, 917504
  buffer_load_dwordx4 v1, s[16:19], s28 offen lds
  s_add_u32 m0, s47, 33792
  s_mov_b32 s28, 925696
  buffer_load_dwordx4 v1, s[16:19], s28 offen lds
  s_add_u32 m0, s47, 34816
  s_mov_b32 s28, 933888
  buffer_load_dwordx4 v1, s[16:19], s28 offen lds
  s_add_u32 m0, s47, 35840
  s_mov_b32 s28, 942080
  buffer_load_dwordx4 v1, s[16:19], s28 offen lds
  v_exp_f32 v32, v32
  v_mfma_f32_32x32x16_bf16 v[64:79], v[124:127], v[84:87], v[64:79]
  v_exp_f32 v33, v33
  v_exp_f32 v34, v34
  v_exp_f32 v35, v35
  v_mfma_f32_32x32x16_bf16 v[48:63], v[104:107], v[8:11], v[16:31]
  ds_read_b128 v[120:123], v5 offset:14336
  v_cvt_pk_bf16_f32 v80, v32, v33
  v_exp_f32 v36, v36
  v_exp_f32 v37, v37
  v_cvt_pk_bf16_f32 v81, v34, v35
  v_mfma_f32_16x16x32_bf16 v[88:91], v[92:95], v[84:87], v[88:91]
  ds_read_b128 v[124:127], v5 offset:15360
  v_exp_f32 v38, v38
  v_exp_f32 v39, v39
  v_mfma_f32_32x32x16_bf16 v[48:63], v[108:111], v[12:15], v[48:63]
  ds_read_b128 v[96:99], v5 offset:16384
  v_cvt_pk_bf16_f32 v82, v36, v37
  v_exp_f32 v40, v40
  v_cvt_pk_bf16_f32 v83, v38, v39
  v_exp_f32 v41, v41
  ds_read_b128 v[100:103], v5 offset:17408
  v_mfma_f32_32x32x16_bf16 v[64:79], v[112:115], v[80:83], v[64:79]
  v_exp_f32 v42, v42
  v_exp_f32 v43, v43
  v_cvt_pk_bf16_f32 v84, v40, v41
  v_exp_f32 v44, v44
  v_mfma_f32_16x16x32_bf16 v[88:91], v[92:95], v[80:83], v[88:91]
  v_exp_f32 v45, v45
  v_cvt_pk_bf16_f32 v85, v42, v43
  v_exp_f32 v46, v46
  v_exp_f32 v47, v47
  v_cvt_pk_bf16_f32 v86, v44, v45
  v_cvt_pk_bf16_f32 v87, v46, v47
  s_waitcnt lgkmcnt(0)
  v_exp_f32 v48, v48
  v_mfma_f32_32x32x16_bf16 v[64:79], v[116:119], v[84:87], v[64:79]
  v_exp_f32 v49, v49
  v_exp_f32 v50, v50
  v_exp_f32 v51, v51
  v_mfma_f32_32x32x16_bf16 v[32:47], v[96:99], v[8:11], v[16:31]
  ds_read_b128 v[112:115], v5 offset:18432
  v_cvt_pk_bf16_f32 v80, v48, v49
  v_exp_f32 v52, v52
  v_exp_f32 v53, v53
  v_cvt_pk_bf16_f32 v81, v50, v51
  v_mfma_f32_16x16x32_bf16 v[88:91], v[92:95], v[84:87], v[88:91]
  ds_read_b128 v[116:119], v5 offset:19456
  ds_read_b64_tr_b16 v[224:225], v2 offset:0
  ds_read_b64_tr_b16 v[226:227], v2 offset:2048
  v_exp_f32 v54, v54
  v_exp_f32 v55, v55
  v_mfma_f32_32x32x16_bf16 v[32:47], v[100:103], v[12:15], v[32:47]
  ds_read_b128 v[104:107], v5 offset:20480
  v_cvt_pk_bf16_f32 v82, v52, v53
  v_exp_f32 v56, v56
  v_cvt_pk_bf16_f32 v83, v54, v55
  v_exp_f32 v57, v57
  ds_read_b128 v[108:111], v5 offset:21504
  ds_read_b64_tr_b16 v[228:229], v2 offset:4096
  ds_read_b64_tr_b16 v[230:231], v2 offset:6144
  v_mfma_f32_32x32x16_bf16 v[64:79], v[120:123], v[80:83], v[64:79]
  v_exp_f32 v58, v58
  v_exp_f32 v59, v59
  v_cvt_pk_bf16_f32 v84, v56, v57
  v_exp_f32 v60, v60
  v_mfma_f32_16x16x32_bf16 v[88:91], v[92:95], v[80:83], v[88:91]
  v_exp_f32 v61, v61
  v_cvt_pk_bf16_f32 v85, v58, v59
  v_exp_f32 v62, v62
  v_exp_f32 v63, v63
  v_cvt_pk_bf16_f32 v86, v60, v61
  v_cvt_pk_bf16_f32 v87, v62, v63
  s_waitcnt lgkmcnt(0)
  v_exp_f32 v32, v32
  v_mfma_f32_32x32x16_bf16 v[64:79], v[124:127], v[84:87], v[64:79]
  v_exp_f32 v33, v33
  v_exp_f32 v34, v34
  v_exp_f32 v35, v35
  v_mfma_f32_32x32x16_bf16 v[48:63], v[104:107], v[8:11], v[16:31]
  ds_read_b128 v[120:123], v5 offset:22528
  v_cvt_pk_bf16_f32 v80, v32, v33
  v_exp_f32 v36, v36
  v_exp_f32 v37, v37
  v_cvt_pk_bf16_f32 v81, v34, v35
  v_mfma_f32_16x16x32_bf16 v[88:91], v[92:95], v[84:87], v[88:91]
  ds_read_b128 v[124:127], v5 offset:23552
  v_exp_f32 v38, v38
  v_exp_f32 v39, v39
  v_mfma_f32_32x32x16_bf16 v[48:63], v[108:111], v[12:15], v[48:63]
  ds_read_b128 v[96:99], v5 offset:24576
  v_cvt_pk_bf16_f32 v82, v36, v37
  v_exp_f32 v40, v40
  v_cvt_pk_bf16_f32 v83, v38, v39
  v_exp_f32 v41, v41
  ds_read_b128 v[100:103], v5 offset:25600
  v_mfma_f32_32x32x16_bf16 v[64:79], v[112:115], v[80:83], v[64:79]
  v_exp_f32 v42, v42
  v_exp_f32 v43, v43
  v_cvt_pk_bf16_f32 v84, v40, v41
  v_exp_f32 v44, v44
  v_mfma_f32_16x16x32_bf16 v[88:91], v[92:95], v[80:83], v[88:91]
  v_exp_f32 v45, v45
  v_cvt_pk_bf16_f32 v85, v42, v43
  v_exp_f32 v46, v46
  v_exp_f32 v47, v47
  v_cvt_pk_bf16_f32 v86, v44, v45
  v_cvt_pk_bf16_f32 v87, v46, v47
  s_waitcnt lgkmcnt(0)
  v_exp_f32 v48, v48
  v_mfma_f32_32x32x16_bf16 v[64:79], v[116:119], v[84:87], v[64:79]
  v_exp_f32 v49, v49
  v_exp_f32 v50, v50
  v_exp_f32 v51, v51
  v_mfma_f32_32x32x16_bf16 v[32:47], v[96:99], v[8:11], v[16:31]
  ds_read_b128 v[112:115], v5 offset:26624
  v_cvt_pk_bf16_f32 v80, v48, v49
  v_exp_f32 v52, v52
  v_exp_f32 v53, v53
  v_cvt_pk_bf16_f32 v81, v50, v51
  v_mfma_f32_16x16x32_bf16 v[88:91], v[92:95], v[84:87], v[88:91]
  ds_read_b128 v[116:119], v5 offset:27648
  v_exp_f32 v54, v54
  v_exp_f32 v55, v55
  v_mfma_f32_32x32x16_bf16 v[32:47], v[100:103], v[12:15], v[32:47]
  ds_read_b128 v[104:107], v5 offset:28672
  v_cvt_pk_bf16_f32 v82, v52, v53
  v_exp_f32 v56, v56
  v_cvt_pk_bf16_f32 v83, v54, v55
  v_exp_f32 v57, v57
  ds_read_b128 v[108:111], v5 offset:29696
  v_mfma_f32_32x32x16_bf16 v[64:79], v[120:123], v[80:83], v[64:79]
  v_exp_f32 v58, v58
  v_exp_f32 v59, v59
  v_cvt_pk_bf16_f32 v84, v56, v57
  v_exp_f32 v60, v60
  v_mfma_f32_16x16x32_bf16 v[88:91], v[92:95], v[80:83], v[88:91]
  v_exp_f32 v61, v61
  v_cvt_pk_bf16_f32 v85, v58, v59
  v_exp_f32 v62, v62
  v_exp_f32 v63, v63
  v_cvt_pk_bf16_f32 v86, v60, v61
  v_cvt_pk_bf16_f32 v87, v62, v63
  s_waitcnt lgkmcnt(0)
  s_waitcnt vmcnt(8)
  s_barrier
  s_add_u32 m0, s47, 0
  s_mov_b32 s28, 983040
  buffer_load_dwordx4 v1, s[16:19], s28 offen lds
  s_add_u32 m0, s47, 1024
  s_mov_b32 s28, 991232
  buffer_load_dwordx4 v1, s[16:19], s28 offen lds
  s_add_u32 m0, s47, 2048
  s_mov_b32 s28, 999424
  buffer_load_dwordx4 v1, s[16:19], s28 offen lds
  s_add_u32 m0, s47, 3072
  s_mov_b32 s28, 1007616
  buffer_load_dwordx4 v1, s[16:19], s28 offen lds
  v_exp_f32 v32, v32
  v_mfma_f32_32x32x16_bf16 v[64:79], v[124:127], v[84:87], v[64:79]
  v_exp_f32 v33, v33
  v_exp_f32 v34, v34
  v_exp_f32 v35, v35
  v_mfma_f32_32x32x16_bf16 v[48:63], v[104:107], v[8:11], v[16:31]
  ds_read_b128 v[120:123], v5 offset:30720
  v_cvt_pk_bf16_f32 v80, v32, v33
  v_exp_f32 v36, v36
  v_exp_f32 v37, v37
  v_cvt_pk_bf16_f32 v81, v34, v35
  v_mfma_f32_16x16x32_bf16 v[88:91], v[92:95], v[84:87], v[88:91]
  ds_read_b128 v[124:127], v5 offset:31744
  v_exp_f32 v38, v38
  v_exp_f32 v39, v39
  v_mfma_f32_32x32x16_bf16 v[48:63], v[108:111], v[12:15], v[48:63]
  ds_read_b128 v[96:99], v5 offset:32768
  v_cvt_pk_bf16_f32 v82, v36, v37
  v_exp_f32 v40, v40
  v_cvt_pk_bf16_f32 v83, v38, v39
  v_exp_f32 v41, v41
  ds_read_b128 v[100:103], v5 offset:33792
  v_mfma_f32_32x32x16_bf16 v[64:79], v[112:115], v[80:83], v[64:79]
  v_exp_f32 v42, v42
  v_exp_f32 v43, v43
  v_cvt_pk_bf16_f32 v84, v40, v41
  v_exp_f32 v44, v44
  v_mfma_f32_16x16x32_bf16 v[88:91], v[92:95], v[80:83], v[88:91]
  v_exp_f32 v45, v45
  v_cvt_pk_bf16_f32 v85, v42, v43
  v_exp_f32 v46, v46
  v_exp_f32 v47, v47
  v_cvt_pk_bf16_f32 v86, v44, v45
  v_cvt_pk_bf16_f32 v87, v46, v47
  s_waitcnt lgkmcnt(0)
  v_exp_f32 v48, v48
  v_mfma_f32_32x32x16_bf16 v[64:79], v[116:119], v[84:87], v[64:79]
  v_exp_f32 v49, v49
  v_exp_f32 v50, v50
  v_exp_f32 v51, v51
  v_mfma_f32_32x32x16_bf16 v[32:47], v[96:99], v[8:11], v[16:31]
  ds_read_b128 v[112:115], v5 offset:34816
  v_cvt_pk_bf16_f32 v80, v48, v49
  v_exp_f32 v52, v52
  v_exp_f32 v53, v53
  v_cvt_pk_bf16_f32 v81, v50, v51
  v_mfma_f32_16x16x32_bf16 v[88:91], v[92:95], v[84:87], v[88:91]
  ds_read_b128 v[116:119], v5 offset:35840
  ds_read_b64_tr_b16 v[232:233], v2 offset:16384
  ds_read_b64_tr_b16 v[234:235], v2 offset:18432
  v_exp_f32 v54, v54
  v_exp_f32 v55, v55
  v_mfma_f32_32x32x16_bf16 v[32:47], v[100:103], v[12:15], v[32:47]
  ds_read_b128 v[104:107], v5 offset:36864
  v_cvt_pk_bf16_f32 v82, v52, v53
  v_exp_f32 v56, v56
  v_cvt_pk_bf16_f32 v83, v54, v55
  v_exp_f32 v57, v57
  ds_read_b128 v[108:111], v5 offset:37888
  ds_read_b64_tr_b16 v[236:237], v2 offset:20480
  ds_read_b64_tr_b16 v[238:239], v2 offset:22528
  v_mfma_f32_32x32x16_bf16 v[64:79], v[120:123], v[80:83], v[64:79]
  v_exp_f32 v58, v58
  v_exp_f32 v59, v59
  v_cvt_pk_bf16_f32 v84, v56, v57
  v_exp_f32 v60, v60
  v_mfma_f32_16x16x32_bf16 v[88:91], v[92:95], v[80:83], v[88:91]
  v_exp_f32 v61, v61
  v_cvt_pk_bf16_f32 v85, v58, v59
  v_exp_f32 v62, v62
  v_exp_f32 v63, v63
  v_cvt_pk_bf16_f32 v86, v60, v61
  v_cvt_pk_bf16_f32 v87, v62, v63
  s_waitcnt lgkmcnt(0)
  v_exp_f32 v32, v32
  v_mfma_f32_32x32x16_bf16 v[64:79], v[124:127], v[84:87], v[64:79]
  v_exp_f32 v33, v33
  v_exp_f32 v34, v34
  v_exp_f32 v35, v35
  v_mfma_f32_32x32x16_bf16 v[48:63], v[104:107], v[8:11], v[16:31]
  ds_read_b128 v[120:123], v5 offset:38912
  v_cvt_pk_bf16_f32 v80, v32, v33
  v_exp_f32 v36, v36
  v_exp_f32 v37, v37
  v_cvt_pk_bf16_f32 v81, v34, v35
  v_mfma_f32_16x16x32_bf16 v[88:91], v[92:95], v[84:87], v[88:91]
  ds_read_b128 v[124:127], v5 offset:39936
  v_exp_f32 v38, v38
  v_exp_f32 v39, v39
  v_mfma_f32_32x32x16_bf16 v[48:63], v[108:111], v[12:15], v[48:63]
  ds_read_b128 v[96:99], v5 offset:40960
  v_cvt_pk_bf16_f32 v82, v36, v37
  v_exp_f32 v40, v40
  v_cvt_pk_bf16_f32 v83, v38, v39
  v_exp_f32 v41, v41
  ds_read_b128 v[100:103], v5 offset:41984
  v_mfma_f32_32x32x16_bf16 v[64:79], v[112:115], v[80:83], v[64:79]
  v_exp_f32 v42, v42
  v_exp_f32 v43, v43
  v_cvt_pk_bf16_f32 v84, v40, v41
  v_exp_f32 v44, v44
  v_mfma_f32_16x16x32_bf16 v[88:91], v[92:95], v[80:83], v[88:91]
  v_exp_f32 v45, v45
  v_cvt_pk_bf16_f32 v85, v42, v43
  v_exp_f32 v46, v46
  v_exp_f32 v47, v47
  v_cvt_pk_bf16_f32 v86, v44, v45
  v_cvt_pk_bf16_f32 v87, v46, v47
  s_waitcnt lgkmcnt(0)
  v_exp_f32 v48, v48
  v_mfma_f32_32x32x16_bf16 v[64:79], v[116:119], v[84:87], v[64:79]
  v_exp_f32 v49, v49
  v_exp_f32 v50, v50
  v_exp_f32 v51, v51
  v_mfma_f32_32x32x16_bf16 v[32:47], v[96:99], v[8:11], v[16:31]
  ds_read_b128 v[112:115], v5 offset:43008
  v_cvt_pk_bf16_f32 v80, v48, v49
  v_exp_f32 v52, v52
  v_exp_f32 v53, v53
  v_cvt_pk_bf16_f32 v81, v50, v51
  v_mfma_f32_16x16x32_bf16 v[88:91], v[92:95], v[84:87], v[88:91]
  ds_read_b128 v[116:119], v5 offset:44032
  v_exp_f32 v54, v54
  v_exp_f32 v55, v55
  v_mfma_f32_32x32x16_bf16 v[32:47], v[100:103], v[12:15], v[32:47]
  ds_read_b128 v[104:107], v5 offset:45056
  v_cvt_pk_bf16_f32 v82, v52, v53
  v_exp_f32 v56, v56
  v_cvt_pk_bf16_f32 v83, v54, v55
  v_exp_f32 v57, v57
  ds_read_b128 v[108:111], v5 offset:46080
  v_mfma_f32_32x32x16_bf16 v[64:79], v[120:123], v[80:83], v[64:79]
  v_exp_f32 v58, v58
  v_exp_f32 v59, v59
  v_cvt_pk_bf16_f32 v84, v56, v57
  v_exp_f32 v60, v60
  v_mfma_f32_16x16x32_bf16 v[88:91], v[92:95], v[80:83], v[88:91]
  v_exp_f32 v61, v61
  v_cvt_pk_bf16_f32 v85, v58, v59
  v_exp_f32 v62, v62
  v_exp_f32 v63, v63
  v_cvt_pk_bf16_f32 v86, v60, v61
  v_cvt_pk_bf16_f32 v87, v62, v63
  s_waitcnt lgkmcnt(0)
  s_waitcnt vmcnt(4)
  s_barrier
  v_exp_f32 v32, v32
  v_mfma_f32_32x32x16_bf16 v[64:79], v[124:127], v[84:87], v[64:79]
  v_exp_f32 v33, v33
  v_exp_f32 v34, v34
  v_exp_f32 v35, v35
  v_mfma_f32_32x32x16_bf16 v[48:63], v[104:107], v[8:11], v[16:31]
  ds_read_b128 v[120:123], v5 offset:47104
  v_cvt_pk_bf16_f32 v80, v32, v33
  v_exp_f32 v36, v36
  v_exp_f32 v37, v37
  v_cvt_pk_bf16_f32 v81, v34, v35
  v_mfma_f32_16x16x32_bf16 v[88:91], v[92:95], v[84:87], v[88:91]
  ds_read_b128 v[124:127], v5 offset:48128
  v_exp_f32 v38, v38
  v_exp_f32 v39, v39
  v_mfma_f32_32x32x16_bf16 v[48:63], v[108:111], v[12:15], v[48:63]
  ds_read_b128 v[96:99], v5 offset:49152
  v_cvt_pk_bf16_f32 v82, v36, v37
  v_exp_f32 v40, v40
  v_cvt_pk_bf16_f32 v83, v38, v39
  v_exp_f32 v41, v41
  ds_read_b128 v[100:103], v5 offset:50176
  v_mfma_f32_32x32x16_bf16 v[64:79], v[112:115], v[80:83], v[64:79]
  v_exp_f32 v42, v42
  v_exp_f32 v43, v43
  v_cvt_pk_bf16_f32 v84, v40, v41
  v_exp_f32 v44, v44
  v_mfma_f32_16x16x32_bf16 v[88:91], v[92:95], v[80:83], v[88:91]
  v_exp_f32 v45, v45
  v_cvt_pk_bf16_f32 v85, v42, v43
  v_exp_f32 v46, v46
  v_exp_f32 v47, v47
  v_cvt_pk_bf16_f32 v86, v44, v45
  v_cvt_pk_bf16_f32 v87, v46, v47
  s_waitcnt lgkmcnt(0)
  v_exp_f32 v48, v48
  v_mfma_f32_32x32x16_bf16 v[64:79], v[116:119], v[84:87], v[64:79]
  v_exp_f32 v49, v49
  v_exp_f32 v50, v50
  v_exp_f32 v51, v51
  v_mfma_f32_32x32x16_bf16 v[32:47], v[96:99], v[8:11], v[16:31]
  ds_read_b128 v[112:115], v5 offset:51200
  v_cvt_pk_bf16_f32 v80, v48, v49
  v_exp_f32 v52, v52
  v_exp_f32 v53, v53
  v_cvt_pk_bf16_f32 v81, v50, v51
  v_mfma_f32_16x16x32_bf16 v[88:91], v[92:95], v[84:87], v[88:91]
  ds_read_b128 v[116:119], v5 offset:52224
  ds_read_b64_tr_b16 v[240:241], v2 offset:32768
  ds_read_b64_tr_b16 v[242:243], v2 offset:34816
  v_exp_f32 v54, v54
  v_exp_f32 v55, v55
  v_mfma_f32_32x32x16_bf16 v[32:47], v[100:103], v[12:15], v[32:47]
  ds_read_b128 v[104:107], v5 offset:53248
  v_cvt_pk_bf16_f32 v82, v52, v53
  v_exp_f32 v56, v56
  v_cvt_pk_bf16_f32 v83, v54, v55
  v_exp_f32 v57, v57
  ds_read_b128 v[108:111], v5 offset:54272
  ds_read_b64_tr_b16 v[244:245], v2 offset:36864
  ds_read_b64_tr_b16 v[246:247], v2 offset:38912
  v_mfma_f32_32x32x16_bf16 v[64:79], v[120:123], v[80:83], v[64:79]
  v_exp_f32 v58, v58
  v_exp_f32 v59, v59
  v_cvt_pk_bf16_f32 v84, v56, v57
  v_exp_f32 v60, v60
  v_mfma_f32_16x16x32_bf16 v[88:91], v[92:95], v[80:83], v[88:91]
  v_exp_f32 v61, v61
  v_cvt_pk_bf16_f32 v85, v58, v59
  v_exp_f32 v62, v62
  v_exp_f32 v63, v63
  v_cvt_pk_bf16_f32 v86, v60, v61
  v_cvt_pk_bf16_f32 v87, v62, v63
  s_waitcnt lgkmcnt(0)
  v_exp_f32 v32, v32
  v_mfma_f32_32x32x16_bf16 v[64:79], v[124:127], v[84:87], v[64:79]
  v_exp_f32 v33, v33
  v_exp_f32 v34, v34
  v_exp_f32 v35, v35
  v_mfma_f32_32x32x16_bf16 v[48:63], v[104:107], v[8:11], v[16:31]
  ds_read_b128 v[120:123], v5 offset:55296
  v_cvt_pk_bf16_f32 v80, v32, v33
  v_exp_f32 v36, v36
  v_exp_f32 v37, v37
  v_cvt_pk_bf16_f32 v81, v34, v35
  v_mfma_f32_16x16x32_bf16 v[88:91], v[92:95], v[84:87], v[88:91]
  ds_read_b128 v[124:127], v5 offset:56320
  v_exp_f32 v38, v38
  v_exp_f32 v39, v39
  v_mfma_f32_32x32x16_bf16 v[48:63], v[108:111], v[12:15], v[48:63]
  ds_read_b128 v[96:99], v5 offset:57344
  v_cvt_pk_bf16_f32 v82, v36, v37
  v_exp_f32 v40, v40
  v_cvt_pk_bf16_f32 v83, v38, v39
  v_exp_f32 v41, v41
  ds_read_b128 v[100:103], v5 offset:58368
  v_mfma_f32_32x32x16_bf16 v[64:79], v[112:115], v[80:83], v[64:79]
  v_exp_f32 v42, v42
  v_exp_f32 v43, v43
  v_cvt_pk_bf16_f32 v84, v40, v41
  v_exp_f32 v44, v44
  v_mfma_f32_16x16x32_bf16 v[88:91], v[92:95], v[80:83], v[88:91]
  v_exp_f32 v45, v45
  v_cvt_pk_bf16_f32 v85, v42, v43
  v_exp_f32 v46, v46
  v_exp_f32 v47, v47
  v_cvt_pk_bf16_f32 v86, v44, v45
  v_cvt_pk_bf16_f32 v87, v46, v47
  s_waitcnt lgkmcnt(0)
  v_exp_f32 v48, v48
  v_mfma_f32_32x32x16_bf16 v[64:79], v[116:119], v[84:87], v[64:79]
  v_exp_f32 v49, v49
  v_exp_f32 v50, v50
  v_exp_f32 v51, v51
  v_mfma_f32_32x32x16_bf16 v[32:47], v[96:99], v[8:11], v[16:31]
  ds_read_b128 v[112:115], v5 offset:59392
  v_cvt_pk_bf16_f32 v80, v48, v49
  v_exp_f32 v52, v52
  v_exp_f32 v53, v53
  v_cvt_pk_bf16_f32 v81, v50, v51
  v_mfma_f32_16x16x32_bf16 v[88:91], v[92:95], v[84:87], v[88:91]
  ds_read_b128 v[116:119], v5 offset:60416
  v_exp_f32 v54, v54
  v_exp_f32 v55, v55
  v_mfma_f32_32x32x16_bf16 v[32:47], v[100:103], v[12:15], v[32:47]
  ds_read_b128 v[104:107], v5 offset:61440
  v_cvt_pk_bf16_f32 v82, v52, v53
  v_exp_f32 v56, v56
  v_cvt_pk_bf16_f32 v83, v54, v55
  v_exp_f32 v57, v57
  ds_read_b128 v[108:111], v5 offset:62464
  v_mfma_f32_32x32x16_bf16 v[64:79], v[120:123], v[80:83], v[64:79]
  v_exp_f32 v58, v58
  v_exp_f32 v59, v59
  v_cvt_pk_bf16_f32 v84, v56, v57
  v_exp_f32 v60, v60
  v_mfma_f32_16x16x32_bf16 v[88:91], v[92:95], v[80:83], v[88:91]
  v_exp_f32 v61, v61
  v_cvt_pk_bf16_f32 v85, v58, v59
  v_exp_f32 v62, v62
  v_exp_f32 v63, v63
  v_cvt_pk_bf16_f32 v86, v60, v61
  v_cvt_pk_bf16_f32 v87, v62, v63
  s_waitcnt lgkmcnt(0)
  s_waitcnt vmcnt(0)
  s_barrier
  v_exp_f32 v32, v32
  v_mfma_f32_32x32x16_bf16 v[64:79], v[124:127], v[84:87], v[64:79]
  v_exp_f32 v33, v33
  v_exp_f32 v34, v34
  v_exp_f32 v35, v35
  v_mfma_f32_32x32x16_bf16 v[48:63], v[104:107], v[8:11], v[16:31]
  ds_read_b128 v[120:123], v5 offset:63488
  v_cvt_pk_bf16_f32 v80, v32, v33
  v_exp_f32 v36, v36
  v_exp_f32 v37, v37
  v_cvt_pk_bf16_f32 v81, v34, v35
  v_mfma_f32_16x16x32_bf16 v[88:91], v[92:95], v[84:87], v[88:91]
  ds_read_b128 v[124:127], v5 offset:64512
  v_exp_f32 v38, v38
  v_exp_f32 v39, v39
  v_mfma_f32_32x32x16_bf16 v[48:63], v[108:111], v[12:15], v[48:63]
  s_nop 0
  v_cvt_pk_bf16_f32 v82, v36, v37
  v_exp_f32 v40, v40
  v_cvt_pk_bf16_f32 v83, v38, v39
  v_exp_f32 v41, v41
  s_nop 0
  v_mfma_f32_32x32x16_bf16 v[64:79], v[112:115], v[80:83], v[64:79]
  v_exp_f32 v42, v42
  v_exp_f32 v43, v43
  v_cvt_pk_bf16_f32 v84, v40, v41
  v_exp_f32 v44, v44
  v_mfma_f32_16x16x32_bf16 v[88:91], v[92:95], v[80:83], v[88:91]
  v_exp_f32 v45, v45
  v_cvt_pk_bf16_f32 v85, v42, v43
  v_exp_f32 v46, v46
  v_exp_f32 v47, v47
  v_cvt_pk_bf16_f32 v86, v44, v45
  v_cvt_pk_bf16_f32 v87, v46, v47
  s_waitcnt lgkmcnt(0)
  v_exp_f32 v48, v48
  v_mfma_f32_32x32x16_bf16 v[64:79], v[116:119], v[84:87], v[64:79]
  v_exp_f32 v49, v49
  v_exp_f32 v50, v50
  v_exp_f32 v51, v51
  s_nop 0
  s_nop 0
  v_cvt_pk_bf16_f32 v80, v48, v49
  v_exp_f32 v52, v52
  v_exp_f32 v53, v53
  v_cvt_pk_bf16_f32 v81, v50, v51
  v_mfma_f32_16x16x32_bf16 v[88:91], v[92:95], v[84:87], v[88:91]
  s_nop 0
  ds_read_b64_tr_b16 v[248:249], v2 offset:0
  ds_read_b64_tr_b16 v[250:251], v2 offset:2048
  v_exp_f32 v54, v54
  v_exp_f32 v55, v55
  s_nop 0
  s_nop 0
  v_cvt_pk_bf16_f32 v82, v52, v53
  v_exp_f32 v56, v56
  v_cvt_pk_bf16_f32 v83, v54, v55
  v_exp_f32 v57, v57
  s_nop 0
  ds_read_b64_tr_b16 v[252:253], v2 offset:4096
  ds_read_b64_tr_b16 v[254:255], v2 offset:6144
  v_mfma_f32_32x32x16_bf16 v[64:79], v[120:123], v[80:83], v[64:79]
  v_exp_f32 v58, v58
  v_exp_f32 v59, v59
  v_cvt_pk_bf16_f32 v84, v56, v57
  v_exp_f32 v60, v60
  v_mfma_f32_16x16x32_bf16 v[88:91], v[92:95], v[80:83], v[88:91]
  v_exp_f32 v61, v61
  v_cvt_pk_bf16_f32 v85, v58, v59
  v_exp_f32 v62, v62
  v_exp_f32 v63, v63
  v_cvt_pk_bf16_f32 v86, v60, v61
  v_cvt_pk_bf16_f32 v87, v62, v63
  s_branch concat_heads__mha_block__spectral_fnet__prompt_kernel_tail
.p2align 6
concat_heads__mha_block__spectral_fnet__prompt_kernel_loop_y:
  s_waitcnt lgkmcnt(0)
  v_exp_f32 v32, v32
  v_mfma_f32_32x32x16_bf16 v[64:79], v[124:127], v[84:87], v[64:79]
  v_exp_f32 v33, v33
  v_exp_f32 v34, v34
  v_exp_f32 v35, v35
  v_mfma_f32_32x32x16_bf16 v[48:63], v[104:107], v[8:11], v[16:31]
  ds_read_b128 v[120:123], v5 offset:6144
  v_cvt_pk_bf16_f32 v80, v32, v33
  v_exp_f32 v36, v36
  v_exp_f32 v37, v37
  v_cvt_pk_bf16_f32 v81, v34, v35
  v_mfma_f32_16x16x32_bf16 v[88:91], v[92:95], v[84:87], v[88:91]
  ds_read_b128 v[124:127], v5 offset:7168
  v_exp_f32 v38, v38
  v_exp_f32 v39, v39
  v_mfma_f32_32x32x16_bf16 v[48:63], v[108:111], v[12:15], v[48:63]
  s_setprio 0
  ds_read_b128 v[96:99], v5 offset:8192
  v_cvt_pk_bf16_f32 v82, v36, v37
  v_exp_f32 v40, v40
  v_cvt_pk_bf16_f32 v83, v38, v39
  v_exp_f32 v41, v41
  ds_read_b128 v[100:103], v5 offset:9216
  v_mfma_f32_32x32x16_bf16 v[64:79], v[112:115], v[80:83], v[64:79]
  v_exp_f32 v42, v42
  v_exp_f32 v43, v43
  v_cvt_pk_bf16_f32 v84, v40, v41
  v_exp_f32 v44, v44
  v_mfma_f32_16x16x32_bf16 v[88:91], v[92:95], v[80:83], v[88:91]
  v_exp_f32 v45, v45
  v_cvt_pk_bf16_f32 v85, v42, v43
  v_exp_f32 v46, v46
  v_exp_f32 v47, v47
  v_cvt_pk_bf16_f32 v86, v44, v45
  v_cvt_pk_bf16_f32 v87, v46, v47
  s_waitcnt lgkmcnt(0)
  v_exp_f32 v48, v48
  v_mfma_f32_32x32x16_bf16 v[64:79], v[116:119], v[84:87], v[64:79]
  v_exp_f32 v49, v49
  v_exp_f32 v50, v50
  v_exp_f32 v51, v51
  v_mfma_f32_32x32x16_bf16 v[32:47], v[96:99], v[8:11], v[16:31]
  ds_read_b128 v[112:115], v5 offset:10240
  v_cvt_pk_bf16_f32 v80, v48, v49
  v_exp_f32 v52, v52
  v_exp_f32 v53, v53
  v_cvt_pk_bf16_f32 v81, v50, v51
  v_mfma_f32_16x16x32_bf16 v[88:91], v[92:95], v[84:87], v[88:91]
  ds_read_b128 v[116:119], v5 offset:11264
  v_exp_f32 v54, v54
  v_exp_f32 v55, v55
  v_mfma_f32_32x32x16_bf16 v[32:47], v[100:103], v[12:15], v[32:47]
  ds_read_b128 v[104:107], v5 offset:12288
  v_cvt_pk_bf16_f32 v82, v52, v53
  v_exp_f32 v56, v56
  v_cvt_pk_bf16_f32 v83, v54, v55
  v_exp_f32 v57, v57
  ds_read_b128 v[108:111], v5 offset:13312
  v_mfma_f32_32x32x16_bf16 v[64:79], v[120:123], v[80:83], v[64:79]
  v_exp_f32 v58, v58
  v_exp_f32 v59, v59
  v_cvt_pk_bf16_f32 v84, v56, v57
  v_exp_f32 v60, v60
  v_mfma_f32_16x16x32_bf16 v[88:91], v[92:95], v[80:83], v[88:91]
  v_exp_f32 v61, v61
  v_cvt_pk_bf16_f32 v85, v58, v59
  v_exp_f32 v62, v62
  v_exp_f32 v63, v63
  v_cvt_pk_bf16_f32 v86, v60, v61
  v_cvt_pk_bf16_f32 v87, v62, v63
  s_waitcnt lgkmcnt(0)
  s_waitcnt vmcnt(8)
  s_barrier
  s_setprio 1
  v_exp_f32 v32, v32
  v_mfma_f32_32x32x16_bf16 v[64:79], v[124:127], v[84:87], v[64:79]
  v_exp_f32 v33, v33
  v_exp_f32 v34, v34
  v_exp_f32 v35, v35
  v_mfma_f32_32x32x16_bf16 v[48:63], v[104:107], v[8:11], v[16:31]
  ds_read_b128 v[120:123], v5 offset:14336
  v_cvt_pk_bf16_f32 v80, v32, v33
  v_exp_f32 v36, v36
  v_exp_f32 v37, v37
  v_cvt_pk_bf16_f32 v81, v34, v35
  v_mfma_f32_16x16x32_bf16 v[88:91], v[92:95], v[84:87], v[88:91]
  ds_read_b128 v[124:127], v5 offset:15360
  v_exp_f32 v38, v38
  v_exp_f32 v39, v39
  v_mfma_f32_32x32x16_bf16 v[48:63], v[108:111], v[12:15], v[48:63]
  ds_read_b128 v[96:99], v5 offset:16384
  v_cvt_pk_bf16_f32 v82, v36, v37
  v_exp_f32 v40, v40
  v_cvt_pk_bf16_f32 v83, v38, v39
  v_exp_f32 v41, v41
  ds_read_b128 v[100:103], v5 offset:17408
  v_mfma_f32_32x32x16_bf16 v[64:79], v[112:115], v[80:83], v[64:79]
  v_exp_f32 v42, v42
  v_exp_f32 v43, v43
  v_cvt_pk_bf16_f32 v84, v40, v41
  v_exp_f32 v44, v44
  v_mfma_f32_16x16x32_bf16 v[88:91], v[92:95], v[80:83], v[88:91]
  v_exp_f32 v45, v45
  v_cvt_pk_bf16_f32 v85, v42, v43
  v_exp_f32 v46, v46
  v_exp_f32 v47, v47
  v_cvt_pk_bf16_f32 v86, v44, v45
  v_cvt_pk_bf16_f32 v87, v46, v47
  s_waitcnt lgkmcnt(0)
  v_exp_f32 v48, v48
  v_mfma_f32_32x32x16_bf16 v[64:79], v[116:119], v[84:87], v[64:79]
  v_exp_f32 v49, v49
  v_exp_f32 v50, v50
  v_exp_f32 v51, v51
  v_mfma_f32_32x32x16_bf16 v[32:47], v[96:99], v[8:11], v[16:31]
  ds_read_b128 v[112:115], v5 offset:18432
  v_cvt_pk_bf16_f32 v80, v48, v49
  v_exp_f32 v52, v52
  v_exp_f32 v53, v53
  v_cvt_pk_bf16_f32 v81, v50, v51
  v_mfma_f32_16x16x32_bf16 v[88:91], v[92:95], v[84:87], v[88:91]
  ds_read_b128 v[116:119], v5 offset:19456
  ds_read_b64_tr_b16 v[128:129], v2 offset:0
  ds_read_b64_tr_b16 v[130:131], v2 offset:2048
  v_exp_f32 v54, v54
  v_exp_f32 v55, v55
  v_mfma_f32_32x32x16_bf16 v[32:47], v[100:103], v[12:15], v[32:47]
  ds_read_b128 v[104:107], v5 offset:20480
  v_cvt_pk_bf16_f32 v82, v52, v53
  v_exp_f32 v56, v56
  v_cvt_pk_bf16_f32 v83, v54, v55
  v_exp_f32 v57, v57
  ds_read_b128 v[108:111], v5 offset:21504
  ds_read_b64_tr_b16 v[132:133], v2 offset:4096
  ds_read_b64_tr_b16 v[134:135], v2 offset:6144
  v_mfma_f32_32x32x16_bf16 v[64:79], v[120:123], v[80:83], v[64:79]
  v_exp_f32 v58, v58
  v_exp_f32 v59, v59
  v_cvt_pk_bf16_f32 v84, v56, v57
  v_exp_f32 v60, v60
  v_mfma_f32_16x16x32_bf16 v[88:91], v[92:95], v[80:83], v[88:91]
  v_exp_f32 v61, v61
  v_cvt_pk_bf16_f32 v85, v58, v59
  v_exp_f32 v62, v62
  v_exp_f32 v63, v63
  v_cvt_pk_bf16_f32 v86, v60, v61
  v_cvt_pk_bf16_f32 v87, v62, v63
  s_waitcnt lgkmcnt(0)
  v_exp_f32 v32, v32
  v_mfma_f32_32x32x16_bf16 v[64:79], v[124:127], v[84:87], v[64:79]
  v_exp_f32 v33, v33
  v_exp_f32 v34, v34
  v_exp_f32 v35, v35
  v_mfma_f32_32x32x16_bf16 v[48:63], v[104:107], v[8:11], v[16:31]
  ds_read_b128 v[120:123], v5 offset:22528
  v_cvt_pk_bf16_f32 v80, v32, v33
  v_exp_f32 v36, v36
  v_exp_f32 v37, v37
  v_cvt_pk_bf16_f32 v81, v34, v35
  v_mfma_f32_16x16x32_bf16 v[88:91], v[92:95], v[84:87], v[88:91]
  ds_read_b128 v[124:127], v5 offset:23552
  v_exp_f32 v38, v38
  v_exp_f32 v39, v39
  v_mfma_f32_32x32x16_bf16 v[48:63], v[108:111], v[12:15], v[48:63]
  s_setprio 0
  ds_read_b128 v[96:99], v5 offset:24576
  v_cvt_pk_bf16_f32 v82, v36, v37
  v_exp_f32 v40, v40
  v_cvt_pk_bf16_f32 v83, v38, v39
  v_exp_f32 v41, v41
  ds_read_b128 v[100:103], v5 offset:25600
  v_mfma_f32_32x32x16_bf16 v[64:79], v[112:115], v[80:83], v[64:79]
  v_exp_f32 v42, v42
  v_exp_f32 v43, v43
  v_cvt_pk_bf16_f32 v84, v40, v41
  v_exp_f32 v44, v44
  v_mfma_f32_16x16x32_bf16 v[88:91], v[92:95], v[80:83], v[88:91]
  v_exp_f32 v45, v45
  v_cvt_pk_bf16_f32 v85, v42, v43
  v_exp_f32 v46, v46
  v_exp_f32 v47, v47
  v_cvt_pk_bf16_f32 v86, v44, v45
  v_cvt_pk_bf16_f32 v87, v46, v47
  s_waitcnt lgkmcnt(0)
  v_exp_f32 v48, v48
  v_mfma_f32_32x32x16_bf16 v[64:79], v[116:119], v[84:87], v[64:79]
  v_exp_f32 v49, v49
  v_exp_f32 v50, v50
  v_exp_f32 v51, v51
  v_mfma_f32_32x32x16_bf16 v[32:47], v[96:99], v[8:11], v[16:31]
  ds_read_b128 v[112:115], v5 offset:26624
  v_cvt_pk_bf16_f32 v80, v48, v49
  v_exp_f32 v52, v52
  v_exp_f32 v53, v53
  v_cvt_pk_bf16_f32 v81, v50, v51
  v_mfma_f32_16x16x32_bf16 v[88:91], v[92:95], v[84:87], v[88:91]
  ds_read_b128 v[116:119], v5 offset:27648
  v_exp_f32 v54, v54
  v_exp_f32 v55, v55
  v_mfma_f32_32x32x16_bf16 v[32:47], v[100:103], v[12:15], v[32:47]
  ds_read_b128 v[104:107], v5 offset:28672
  v_cvt_pk_bf16_f32 v82, v52, v53
  v_exp_f32 v56, v56
  v_cvt_pk_bf16_f32 v83, v54, v55
  v_exp_f32 v57, v57
  ds_read_b128 v[108:111], v5 offset:29696
  v_mfma_f32_32x32x16_bf16 v[64:79], v[120:123], v[80:83], v[64:79]
  v_exp_f32 v58, v58
  v_exp_f32 v59, v59
  v_cvt_pk_bf16_f32 v84, v56, v57
  v_exp_f32 v60, v60
  v_mfma_f32_16x16x32_bf16 v[88:91], v[92:95], v[80:83], v[88:91]
  v_exp_f32 v61, v61
  v_cvt_pk_bf16_f32 v85, v58, v59
  v_exp_f32 v62, v62
  v_exp_f32 v63, v63
  v_cvt_pk_bf16_f32 v86, v60, v61
  v_cvt_pk_bf16_f32 v87, v62, v63
  s_waitcnt lgkmcnt(0)
  s_waitcnt vmcnt(0)
  s_barrier
  s_setprio 1
  s_cmp_lg_u32 s27, 0
  s_cbranch_scc1 concat_heads__mha_block__spectral_fnet__prompt_kernel_nosf1
  v_mov_b32 v248, -1
  v_mov_b32 v249, -1
  v_mov_b32 v250, -1
  v_mov_b32 v251, -1
  s_lshl_b32 s28, s23, 6
  s_lshl_b32 s29, s20, 1
  s_add_u32 s28, s28, s29
  s_lshl_b32 s28, s28, 10
  s_add_u32 s28, s28, 0xc00000
  buffer_store_dwordx4 v[248:251], v5, s[12:15], s28 offen sc1
  buffer_store_dwordx4 v[248:251], v5, s[12:15], s28 offen offset:1024 sc1
concat_heads__mha_block__spectral_fnet__prompt_kernel_nosf1b:
  v_exp_f32 v32, v32
  v_mfma_f32_32x32x16_bf16 v[64:79], v[124:127], v[84:87], v[64:79]
  v_exp_f32 v33, v33
  v_exp_f32 v34, v34
  v_exp_f32 v35, v35
  v_mfma_f32_32x32x16_bf16 v[48:63], v[104:107], v[8:11], v[16:31]
  ds_read_b128 v[120:123], v5 offset:30720
  v_cvt_pk_bf16_f32 v80, v32, v33
  v_exp_f32 v36, v36
  v_exp_f32 v37, v37
  v_cvt_pk_bf16_f32 v81, v34, v35
  v_mfma_f32_16x16x32_bf16 v[88:91], v[92:95], v[84:87], v[88:91]
  ds_read_b128 v[124:127], v5 offset:31744
  v_exp_f32 v38, v38
  v_exp_f32 v39, v39
  v_mfma_f32_32x32x16_bf16 v[48:63], v[108:111], v[12:15], v[48:63]
  ds_read_b128 v[96:99], v5 offset:32768
  v_cvt_pk_bf16_f32 v82, v36, v37
  v_exp_f32 v40, v40
  v_cvt_pk_bf16_f32 v83, v38, v39
  v_exp_f32 v41, v41
  ds_read_b128 v[100:103], v5 offset:33792
  v_mfma_f32_32x32x16_bf16 v[64:79], v[112:115], v[80:83], v[64:79]
  v_exp_f32 v42, v42
  v_exp_f32 v43, v43
  v_cvt_pk_bf16_f32 v84, v40, v41
  v_exp_f32 v44, v44
  v_mfma_f32_16x16x32_bf16 v[88:91], v[92:95], v[80:83], v[88:91]
  v_exp_f32 v45, v45
  v_cvt_pk_bf16_f32 v85, v42, v43
  v_exp_f32 v46, v46
  v_exp_f32 v47, v47
  v_cvt_pk_bf16_f32 v86, v44, v45
  v_cvt_pk_bf16_f32 v87, v46, v47
  s_waitcnt lgkmcnt(0)
  v_exp_f32 v48, v48
  v_mfma_f32_32x32x16_bf16 v[64:79], v[116:119], v[84:87], v[64:79]
  v_exp_f32 v49, v49
  v_exp_f32 v50, v50
  v_exp_f32 v51, v51
  v_mfma_f32_32x32x16_bf16 v[32:47], v[96:99], v[8:11], v[16:31]
  ds_read_b128 v[112:115], v5 offset:34816
  v_cvt_pk_bf16_f32 v80, v48, v49
  v_exp_f32 v52, v52
  v_exp_f32 v53, v53
  v_cvt_pk_bf16_f32 v81, v50, v51
  v_mfma_f32_16x16x32_bf16 v[88:91], v[92:95], v[84:87], v[88:91]
  ds_read_b128 v[116:119], v5 offset:35840
  ds_read_b64_tr_b16 v[136:137], v2 offset:16384
  ds_read_b64_tr_b16 v[138:139], v2 offset:18432
  v_exp_f32 v54, v54
  v_exp_f32 v55, v55
  v_mfma_f32_32x32x16_bf16 v[32:47], v[100:103], v[12:15], v[32:47]
  ds_read_b128 v[104:107], v5 offset:36864
  v_cvt_pk_bf16_f32 v82, v52, v53
  v_exp_f32 v56, v56
  v_cvt_pk_bf16_f32 v83, v54, v55
  v_exp_f32 v57, v57
  ds_read_b128 v[108:111], v5 offset:37888
  ds_read_b64_tr_b16 v[140:141], v2 offset:20480
  ds_read_b64_tr_b16 v[142:143], v2 offset:22528
  v_mfma_f32_32x32x16_bf16 v[64:79], v[120:123], v[80:83], v[64:79]
  v_exp_f32 v58, v58
  v_exp_f32 v59, v59
  v_cvt_pk_bf16_f32 v84, v56, v57
  v_exp_f32 v60, v60
  v_mfma_f32_16x16x32_bf16 v[88:91], v[92:95], v[80:83], v[88:91]
  v_exp_f32 v61, v61
  v_cvt_pk_bf16_f32 v85, v58, v59
  v_exp_f32 v62, v62
  v_exp_f32 v63, v63
  v_cvt_pk_bf16_f32 v86, v60, v61
  v_cvt_pk_bf16_f32 v87, v62, v63
  s_waitcnt lgkmcnt(0)
  v_exp_f32 v32, v32
  v_mfma_f32_32x32x16_bf16 v[64:79], v[124:127], v[84:87], v[64:79]
  v_exp_f32 v33, v33
  v_exp_f32 v34, v34
  v_exp_f32 v35, v35
  v_mfma_f32_32x32x16_bf16 v[48:63], v[104:107], v[8:11], v[16:31]
  ds_read_b128 v[120:123], v5 offset:38912
  v_cvt_pk_bf16_f32 v80, v32, v33
  v_exp_f32 v36, v36
  v_exp_f32 v37, v37
  v_cvt_pk_bf16_f32 v81, v34, v35
  v_mfma_f32_16x16x32_bf16 v[88:91], v[92:95], v[84:87], v[88:91]
  ds_read_b128 v[124:127], v5 offset:39936
  v_exp_f32 v38, v38
  v_exp_f32 v39, v39
  v_mfma_f32_32x32x16_bf16 v[48:63], v[108:111], v[12:15], v[48:63]
  s_setprio 0
  ds_read_b128 v[96:99], v5 offset:40960
  v_cvt_pk_bf16_f32 v82, v36, v37
  v_exp_f32 v40, v40
  v_cvt_pk_bf16_f32 v83, v38, v39
  v_exp_f32 v41, v41
  ds_read_b128 v[100:103], v5 offset:41984
  v_mfma_f32_32x32x16_bf16 v[64:79], v[112:115], v[80:83], v[64:79]
  v_exp_f32 v42, v42
  v_exp_f32 v43, v43
  v_cvt_pk_bf16_f32 v84, v40, v41
  v_exp_f32 v44, v44
  v_mfma_f32_16x16x32_bf16 v[88:91], v[92:95], v[80:83], v[88:91]
  v_exp_f32 v45, v45
  v_cvt_pk_bf16_f32 v85, v42, v43
  v_exp_f32 v46, v46
  v_exp_f32 v47, v47
  v_cvt_pk_bf16_f32 v86, v44, v45
  v_cvt_pk_bf16_f32 v87, v46, v47
  s_waitcnt lgkmcnt(0)
  v_exp_f32 v48, v48
  v_mfma_f32_32x32x16_bf16 v[64:79], v[116:119], v[84:87], v[64:79]
  v_exp_f32 v49, v49
  v_exp_f32 v50, v50
  v_exp_f32 v51, v51
  v_mfma_f32_32x32x16_bf16 v[32:47], v[96:99], v[8:11], v[16:31]
  ds_read_b128 v[112:115], v5 offset:43008
  v_cvt_pk_bf16_f32 v80, v48, v49
  v_exp_f32 v52, v52
  v_exp_f32 v53, v53
  v_cvt_pk_bf16_f32 v81, v50, v51
  v_mfma_f32_16x16x32_bf16 v[88:91], v[92:95], v[84:87], v[88:91]
  ds_read_b128 v[116:119], v5 offset:44032
  v_exp_f32 v54, v54
  v_exp_f32 v55, v55
  v_mfma_f32_32x32x16_bf16 v[32:47], v[100:103], v[12:15], v[32:47]
  ds_read_b128 v[104:107], v5 offset:45056
  v_cvt_pk_bf16_f32 v82, v52, v53
  v_exp_f32 v56, v56
  v_cvt_pk_bf16_f32 v83, v54, v55
  v_exp_f32 v57, v57
  ds_read_b128 v[108:111], v5 offset:46080
  v_mfma_f32_32x32x16_bf16 v[64:79], v[120:123], v[80:83], v[64:79]
  v_exp_f32 v58, v58
  v_exp_f32 v59, v59
  v_cvt_pk_bf16_f32 v84, v56, v57
  v_exp_f32 v60, v60
  v_mfma_f32_16x16x32_bf16 v[88:91], v[92:95], v[80:83], v[88:91]
  v_exp_f32 v61, v61
  v_cvt_pk_bf16_f32 v85, v58, v59
  v_exp_f32 v62, v62
  v_exp_f32 v63, v63
  v_cvt_pk_bf16_f32 v86, v60, v61
  v_cvt_pk_bf16_f32 v87, v62, v63
  s_waitcnt lgkmcnt(0)
  s_barrier
  s_setprio 1
  s_cmp_lg_u32 s27, 0
  s_cbranch_scc1 concat_heads__mha_block__spectral_fnet__prompt_kernel_nozs1
  buffer_store_dwordx4 v[224:227], v245, s[76:79], 0 offen sc1
  buffer_store_dwordx4 v[228:231], v245, s[76:79], 0 offen offset:1024 sc1
  v_add_u32 v240, 131072, v245
  buffer_store_dwordx4 v[232:235], v240, s[76:79], 0 offen sc1
  buffer_store_dwordx4 v[236:239], v240, s[76:79], 0 offen offset:1024 sc1
concat_heads__mha_block__spectral_fnet__prompt_kernel_nozs1b:
  s_add_u32 m0, s55, 0
  s_mov_b32 s28, 0
  buffer_load_dwordx4 v6, s[84:87], s28 offen lds
  v_exp_f32 v32, v32
  v_mfma_f32_32x32x16_bf16 v[64:79], v[124:127], v[84:87], v[64:79]
  v_exp_f32 v33, v33
  v_exp_f32 v34, v34
  v_exp_f32 v35, v35
  v_mfma_f32_32x32x16_bf16 v[48:63], v[104:107], v[8:11], v[16:31]
  ds_read_b128 v[120:123], v5 offset:47104
  v_cvt_pk_bf16_f32 v80, v32, v33
  v_exp_f32 v36, v36
  v_exp_f32 v37, v37
  v_cvt_pk_bf16_f32 v81, v34, v35
  v_mfma_f32_16x16x32_bf16 v[88:91], v[92:95], v[84:87], v[88:91]
  ds_read_b128 v[124:127], v5 offset:48128
  v_exp_f32 v38, v38
  v_exp_f32 v39, v39
  v_mfma_f32_32x32x16_bf16 v[48:63], v[108:111], v[12:15], v[48:63]
  ds_read_b128 v[96:99], v5 offset:49152
  v_cvt_pk_bf16_f32 v82, v36, v37
  v_exp_f32 v40, v40
  v_cvt_pk_bf16_f32 v83, v38, v39
  v_exp_f32 v41, v41
  ds_read_b128 v[100:103], v5 offset:50176
  v_mfma_f32_32x32x16_bf16 v[64:79], v[112:115], v[80:83], v[64:79]
  v_exp_f32 v42, v42
  v_exp_f32 v43, v43
  v_cvt_pk_bf16_f32 v84, v40, v41
  v_exp_f32 v44, v44
  v_mfma_f32_16x16x32_bf16 v[88:91], v[92:95], v[80:83], v[88:91]
  v_exp_f32 v45, v45
  v_cvt_pk_bf16_f32 v85, v42, v43
  v_exp_f32 v46, v46
  v_exp_f32 v47, v47
  v_cvt_pk_bf16_f32 v86, v44, v45
  v_cvt_pk_bf16_f32 v87, v46, v47
  s_waitcnt lgkmcnt(0)
  v_exp_f32 v48, v48
  v_mfma_f32_32x32x16_bf16 v[64:79], v[116:119], v[84:87], v[64:79]
  v_exp_f32 v49, v49
  v_exp_f32 v50, v50
  v_exp_f32 v51, v51
  v_mfma_f32_32x32x16_bf16 v[32:47], v[96:99], v[8:11], v[16:31]
  ds_read_b128 v[112:115], v5 offset:51200
  v_cvt_pk_bf16_f32 v80, v48, v49
  v_exp_f32 v52, v52
  v_exp_f32 v53, v53
  v_cvt_pk_bf16_f32 v81, v50, v51
  v_mfma_f32_16x16x32_bf16 v[88:91], v[92:95], v[84:87], v[88:91]
  ds_read_b128 v[116:119], v5 offset:52224
  ds_read_b64_tr_b16 v[144:145], v2 offset:32768
  ds_read_b64_tr_b16 v[146:147], v2 offset:34816
  v_exp_f32 v54, v54
  v_exp_f32 v55, v55
  v_mfma_f32_32x32x16_bf16 v[32:47], v[100:103], v[12:15], v[32:47]
  ds_read_b128 v[104:107], v5 offset:53248
  v_cvt_pk_bf16_f32 v82, v52, v53
  v_exp_f32 v56, v56
  v_cvt_pk_bf16_f32 v83, v54, v55
  v_exp_f32 v57, v57
  ds_read_b128 v[108:111], v5 offset:54272
  ds_read_b64_tr_b16 v[148:149], v2 offset:36864
  ds_read_b64_tr_b16 v[150:151], v2 offset:38912
  v_mfma_f32_32x32x16_bf16 v[64:79], v[120:123], v[80:83], v[64:79]
  v_exp_f32 v58, v58
  v_exp_f32 v59, v59
  v_cvt_pk_bf16_f32 v84, v56, v57
  v_exp_f32 v60, v60
  v_mfma_f32_16x16x32_bf16 v[88:91], v[92:95], v[80:83], v[88:91]
  v_exp_f32 v61, v61
  v_cvt_pk_bf16_f32 v85, v58, v59
  v_exp_f32 v62, v62
  v_exp_f32 v63, v63
  v_cvt_pk_bf16_f32 v86, v60, v61
  v_cvt_pk_bf16_f32 v87, v62, v63
  s_waitcnt lgkmcnt(0)
  v_exp_f32 v32, v32
  v_mfma_f32_32x32x16_bf16 v[64:79], v[124:127], v[84:87], v[64:79]
  v_exp_f32 v33, v33
  v_exp_f32 v34, v34
  v_exp_f32 v35, v35
  v_mfma_f32_32x32x16_bf16 v[48:63], v[104:107], v[8:11], v[16:31]
  ds_read_b128 v[120:123], v5 offset:55296
  v_cvt_pk_bf16_f32 v80, v32, v33
  v_exp_f32 v36, v36
  v_exp_f32 v37, v37
  v_cvt_pk_bf16_f32 v81, v34, v35
  v_mfma_f32_16x16x32_bf16 v[88:91], v[92:95], v[84:87], v[88:91]
  ds_read_b128 v[124:127], v5 offset:56320
  v_exp_f32 v38, v38
  v_exp_f32 v39, v39
  v_mfma_f32_32x32x16_bf16 v[48:63], v[108:111], v[12:15], v[48:63]
  s_setprio 0
  ds_read_b128 v[96:99], v5 offset:57344
  v_cvt_pk_bf16_f32 v82, v36, v37
  v_exp_f32 v40, v40
  v_cvt_pk_bf16_f32 v83, v38, v39
  v_exp_f32 v41, v41
  ds_read_b128 v[100:103], v5 offset:58368
  v_mfma_f32_32x32x16_bf16 v[64:79], v[112:115], v[80:83], v[64:79]
  v_exp_f32 v42, v42
  v_exp_f32 v43, v43
  v_cvt_pk_bf16_f32 v84, v40, v41
  v_exp_f32 v44, v44
  v_mfma_f32_16x16x32_bf16 v[88:91], v[92:95], v[80:83], v[88:91]
  v_exp_f32 v45, v45
  v_cvt_pk_bf16_f32 v85, v42, v43
  v_exp_f32 v46, v46
  v_exp_f32 v47, v47
  v_cvt_pk_bf16_f32 v86, v44, v45
  v_cvt_pk_bf16_f32 v87, v46, v47
  s_waitcnt lgkmcnt(0)
  v_exp_f32 v48, v48
  v_mfma_f32_32x32x16_bf16 v[64:79], v[116:119], v[84:87], v[64:79]
  v_exp_f32 v49, v49
  v_exp_f32 v50, v50
  v_exp_f32 v51, v51
  v_mfma_f32_32x32x16_bf16 v[32:47], v[96:99], v[8:11], v[16:31]
  ds_read_b128 v[112:115], v5 offset:59392
  v_cvt_pk_bf16_f32 v80, v48, v49
  v_exp_f32 v52, v52
  v_exp_f32 v53, v53
  v_cvt_pk_bf16_f32 v81, v50, v51
  v_mfma_f32_16x16x32_bf16 v[88:91], v[92:95], v[84:87], v[88:91]
  ds_read_b128 v[116:119], v5 offset:60416
  v_exp_f32 v54, v54
  v_exp_f32 v55, v55
  v_mfma_f32_32x32x16_bf16 v[32:47], v[100:103], v[12:15], v[32:47]
  ds_read_b128 v[104:107], v5 offset:61440
  v_cvt_pk_bf16_f32 v82, v52, v53
  v_exp_f32 v56, v56
  v_cvt_pk_bf16_f32 v83, v54, v55
  v_exp_f32 v57, v57
  ds_read_b128 v[108:111], v5 offset:62464
  v_mfma_f32_32x32x16_bf16 v[64:79], v[120:123], v[80:83], v[64:79]
  v_exp_f32 v58, v58
  v_exp_f32 v59, v59
  v_cvt_pk_bf16_f32 v84, v56, v57
  v_exp_f32 v60, v60
  v_mfma_f32_16x16x32_bf16 v[88:91], v[92:95], v[80:83], v[88:91]
  v_exp_f32 v61, v61
  v_cvt_pk_bf16_f32 v85, v58, v59
  v_exp_f32 v62, v62
  v_exp_f32 v63, v63
  v_cvt_pk_bf16_f32 v86, v60, v61
  v_cvt_pk_bf16_f32 v87, v62, v63
  s_waitcnt lgkmcnt(0)
  s_barrier
  s_setprio 1
  v_xor_b32 v6, 64, v6
  s_add_u32 m0, s55, 1024
  s_mov_b32 s28, 1048576
  buffer_load_dwordx4 v6, s[84:87], s28 offen lds
  v_exp_f32 v32, v32
  v_mfma_f32_32x32x16_bf16 v[64:79], v[124:127], v[84:87], v[64:79]
  v_exp_f32 v33, v33
  v_exp_f32 v34, v34
  v_exp_f32 v35, v35
  v_mfma_f32_32x32x16_bf16 v[48:63], v[104:107], v[8:11], v[16:31]
  ds_read_b128 v[120:123], v5 offset:63488
  v_cvt_pk_bf16_f32 v80, v32, v33
  v_exp_f32 v36, v36
  v_exp_f32 v37, v37
  v_cvt_pk_bf16_f32 v81, v34, v35
  v_mfma_f32_16x16x32_bf16 v[88:91], v[92:95], v[84:87], v[88:91]
  ds_read_b128 v[124:127], v5 offset:64512
  v_exp_f32 v38, v38
  v_exp_f32 v39, v39
  v_mfma_f32_32x32x16_bf16 v[48:63], v[108:111], v[12:15], v[48:63]
  ds_read_b128 v[96:99], v5 offset:0
  v_cvt_pk_bf16_f32 v82, v36, v37
  v_exp_f32 v40, v40
  v_cvt_pk_bf16_f32 v83, v38, v39
  v_exp_f32 v41, v41
  ds_read_b128 v[100:103], v5 offset:1024
  v_mfma_f32_32x32x16_bf16 v[64:79], v[112:115], v[80:83], v[64:79]
  v_exp_f32 v42, v42
  v_exp_f32 v43, v43
  v_cvt_pk_bf16_f32 v84, v40, v41
  v_exp_f32 v44, v44
  v_mfma_f32_16x16x32_bf16 v[88:91], v[92:95], v[80:83], v[88:91]
  v_exp_f32 v45, v45
  v_cvt_pk_bf16_f32 v85, v42, v43
  v_exp_f32 v46, v46
  v_exp_f32 v47, v47
  v_cvt_pk_bf16_f32 v86, v44, v45
  v_cvt_pk_bf16_f32 v87, v46, v47
  s_waitcnt lgkmcnt(0)
  v_exp_f32 v48, v48
  v_mfma_f32_32x32x16_bf16 v[64:79], v[116:119], v[84:87], v[64:79]
  v_exp_f32 v49, v49
  v_exp_f32 v50, v50
  v_exp_f32 v51, v51
  v_mfma_f32_32x32x16_bf16 v[32:47], v[96:99], v[8:11], v[16:31]
  ds_read_b128 v[112:115], v5 offset:2048
  v_cvt_pk_bf16_f32 v80, v48, v49
  v_exp_f32 v52, v52
  v_exp_f32 v53, v53
  v_cvt_pk_bf16_f32 v81, v50, v51
  v_mfma_f32_16x16x32_bf16 v[88:91], v[92:95], v[84:87], v[88:91]
  ds_read_b128 v[116:119], v5 offset:3072
  ds_read_b64_tr_b16 v[152:153], v2 offset:0
  ds_read_b64_tr_b16 v[154:155], v2 offset:2048
  v_exp_f32 v54, v54
  v_exp_f32 v55, v55
  v_mfma_f32_32x32x16_bf16 v[32:47], v[100:103], v[12:15], v[32:47]
  ds_read_b128 v[104:107], v5 offset:4096
  v_cvt_pk_bf16_f32 v82, v52, v53
  v_exp_f32 v56, v56
  v_cvt_pk_bf16_f32 v83, v54, v55
  v_exp_f32 v57, v57
  ds_read_b128 v[108:111], v5 offset:5120
  ds_read_b64_tr_b16 v[156:157], v2 offset:4096
  ds_read_b64_tr_b16 v[158:159], v2 offset:6144
  v_mfma_f32_32x32x16_bf16 v[64:79], v[120:123], v[80:83], v[64:79]
  v_exp_f32 v58, v58
  v_exp_f32 v59, v59
  v_cvt_pk_bf16_f32 v84, v56, v57
  v_exp_f32 v60, v60
  v_mfma_f32_16x16x32_bf16 v[88:91], v[92:95], v[80:83], v[88:91]
  v_exp_f32 v61, v61
  v_cvt_pk_bf16_f32 v85, v58, v59
  v_exp_f32 v62, v62
  v_exp_f32 v63, v63
  v_cvt_pk_bf16_f32 v86, v60, v61
  v_cvt_pk_bf16_f32 v87, v62, v63
  s_waitcnt lgkmcnt(0)
  v_exp_f32 v32, v32
  v_mfma_f32_32x32x16_bf16 v[64:79], v[124:127], v[84:87], v[64:79]
  v_exp_f32 v33, v33
  v_exp_f32 v34, v34
  v_exp_f32 v35, v35
  v_mfma_f32_32x32x16_bf16 v[48:63], v[104:107], v[8:11], v[16:31]
  ds_read_b128 v[120:123], v5 offset:6144
  v_cvt_pk_bf16_f32 v80, v32, v33
  v_exp_f32 v36, v36
  v_exp_f32 v37, v37
  v_cvt_pk_bf16_f32 v81, v34, v35
  v_mfma_f32_16x16x32_bf16 v[88:91], v[92:95], v[84:87], v[88:91]
  ds_read_b128 v[124:127], v5 offset:7168
  v_exp_f32 v38, v38
  v_exp_f32 v39, v39
  v_mfma_f32_32x32x16_bf16 v[48:63], v[108:111], v[12:15], v[48:63]
  s_setprio 0
  ds_read_b128 v[96:99], v5 offset:8192
  v_cvt_pk_bf16_f32 v82, v36, v37
  v_exp_f32 v40, v40
  v_cvt_pk_bf16_f32 v83, v38, v39
  v_exp_f32 v41, v41
  ds_read_b128 v[100:103], v5 offset:9216
  v_mfma_f32_32x32x16_bf16 v[64:79], v[112:115], v[80:83], v[64:79]
  v_exp_f32 v42, v42
  v_exp_f32 v43, v43
  v_cvt_pk_bf16_f32 v84, v40, v41
  v_exp_f32 v44, v44
  v_mfma_f32_16x16x32_bf16 v[88:91], v[92:95], v[80:83], v[88:91]
  v_exp_f32 v45, v45
  v_cvt_pk_bf16_f32 v85, v42, v43
  v_exp_f32 v46, v46
  v_exp_f32 v47, v47
  v_cvt_pk_bf16_f32 v86, v44, v45
  v_cvt_pk_bf16_f32 v87, v46, v47
  s_waitcnt lgkmcnt(0)
  v_exp_f32 v48, v48
  v_mfma_f32_32x32x16_bf16 v[64:79], v[116:119], v[84:87], v[64:79]
  v_exp_f32 v49, v49
  v_exp_f32 v50, v50
  v_exp_f32 v51, v51
  v_mfma_f32_32x32x16_bf16 v[32:47], v[96:99], v[8:11], v[16:31]
  ds_read_b128 v[112:115], v5 offset:10240
  v_cvt_pk_bf16_f32 v80, v48, v49
  v_exp_f32 v52, v52
  v_exp_f32 v53, v53
  v_cvt_pk_bf16_f32 v81, v50, v51
  v_mfma_f32_16x16x32_bf16 v[88:91], v[92:95], v[84:87], v[88:91]
  ds_read_b128 v[116:119], v5 offset:11264
  v_exp_f32 v54, v54
  v_exp_f32 v55, v55
  v_mfma_f32_32x32x16_bf16 v[32:47], v[100:103], v[12:15], v[32:47]
  ds_read_b128 v[104:107], v5 offset:12288
  v_cvt_pk_bf16_f32 v82, v52, v53
  v_exp_f32 v56, v56
  v_cvt_pk_bf16_f32 v83, v54, v55
  v_exp_f32 v57, v57
  ds_read_b128 v[108:111], v5 offset:13312
  v_mfma_f32_32x32x16_bf16 v[64:79], v[120:123], v[80:83], v[64:79]
  v_exp_f32 v58, v58
  v_exp_f32 v59, v59
  v_cvt_pk_bf16_f32 v84, v56, v57
  v_exp_f32 v60, v60
  v_mfma_f32_16x16x32_bf16 v[88:91], v[92:95], v[80:83], v[88:91]
  v_exp_f32 v61, v61
  v_cvt_pk_bf16_f32 v85, v58, v59
  v_exp_f32 v62, v62
  v_exp_f32 v63, v63
  v_cvt_pk_bf16_f32 v86, v60, v61
  v_cvt_pk_bf16_f32 v87, v62, v63
  s_waitcnt lgkmcnt(0)
  s_barrier
  s_setprio 1
  v_xor_b32 v6, 64, v6
  s_add_u32 m0, s55, 2048
  s_mov_b32 s28, 2097152
  buffer_load_dwordx4 v6, s[84:87], s28 offen lds
  v_exp_f32 v32, v32
  v_mfma_f32_32x32x16_bf16 v[64:79], v[124:127], v[84:87], v[64:79]
  v_exp_f32 v33, v33
  v_exp_f32 v34, v34
  v_exp_f32 v35, v35
  v_mfma_f32_32x32x16_bf16 v[48:63], v[104:107], v[8:11], v[16:31]
  ds_read_b128 v[120:123], v5 offset:14336
  v_cvt_pk_bf16_f32 v80, v32, v33
  v_exp_f32 v36, v36
  v_exp_f32 v37, v37
  v_cvt_pk_bf16_f32 v81, v34, v35
  v_mfma_f32_16x16x32_bf16 v[88:91], v[92:95], v[84:87], v[88:91]
  ds_read_b128 v[124:127], v5 offset:15360
  v_exp_f32 v38, v38
  v_exp_f32 v39, v39
  v_mfma_f32_32x32x16_bf16 v[48:63], v[108:111], v[12:15], v[48:63]
  ds_read_b128 v[96:99], v5 offset:16384
  v_cvt_pk_bf16_f32 v82, v36, v37
  v_exp_f32 v40, v40
  v_cvt_pk_bf16_f32 v83, v38, v39
  v_exp_f32 v41, v41
  ds_read_b128 v[100:103], v5 offset:17408
  v_mfma_f32_32x32x16_bf16 v[64:79], v[112:115], v[80:83], v[64:79]
  v_exp_f32 v42, v42
  v_exp_f32 v43, v43
  v_cvt_pk_bf16_f32 v84, v40, v41
  v_exp_f32 v44, v44
  v_mfma_f32_16x16x32_bf16 v[88:91], v[92:95], v[80:83], v[88:91]
  v_exp_f32 v45, v45
  v_cvt_pk_bf16_f32 v85, v42, v43
  v_exp_f32 v46, v46
  v_exp_f32 v47, v47
  v_cvt_pk_bf16_f32 v86, v44, v45
  v_cvt_pk_bf16_f32 v87, v46, v47
  s_waitcnt lgkmcnt(0)
  v_exp_f32 v48, v48
  v_mfma_f32_32x32x16_bf16 v[64:79], v[116:119], v[84:87], v[64:79]
  v_exp_f32 v49, v49
  v_exp_f32 v50, v50
  v_exp_f32 v51, v51
  v_mfma_f32_32x32x16_bf16 v[32:47], v[96:99], v[8:11], v[16:31]
  ds_read_b128 v[112:115], v5 offset:18432
  v_cvt_pk_bf16_f32 v80, v48, v49
  v_exp_f32 v52, v52
  v_exp_f32 v53, v53
  v_cvt_pk_bf16_f32 v81, v50, v51
  v_mfma_f32_16x16x32_bf16 v[88:91], v[92:95], v[84:87], v[88:91]
  ds_read_b128 v[116:119], v5 offset:19456
  ds_read_b64_tr_b16 v[160:161], v2 offset:16384
  ds_read_b64_tr_b16 v[162:163], v2 offset:18432
  v_exp_f32 v54, v54
  v_exp_f32 v55, v55
  v_mfma_f32_32x32x16_bf16 v[32:47], v[100:103], v[12:15], v[32:47]
  ds_read_b128 v[104:107], v5 offset:20480
  v_cvt_pk_bf16_f32 v82, v52, v53
  v_exp_f32 v56, v56
  v_cvt_pk_bf16_f32 v83, v54, v55
  v_exp_f32 v57, v57
  ds_read_b128 v[108:111], v5 offset:21504
  ds_read_b64_tr_b16 v[164:165], v2 offset:20480
  ds_read_b64_tr_b16 v[166:167], v2 offset:22528
  v_mfma_f32_32x32x16_bf16 v[64:79], v[120:123], v[80:83], v[64:79]
  v_exp_f32 v58, v58
  v_exp_f32 v59, v59
  v_cvt_pk_bf16_f32 v84, v56, v57
  v_exp_f32 v60, v60
  v_mfma_f32_16x16x32_bf16 v[88:91], v[92:95], v[80:83], v[88:91]
  v_exp_f32 v61, v61
  v_cvt_pk_bf16_f32 v85, v58, v59
  v_exp_f32 v62, v62
  v_exp_f32 v63, v63
  v_cvt_pk_bf16_f32 v86, v60, v61
  v_cvt_pk_bf16_f32 v87, v62, v63
  s_waitcnt lgkmcnt(0)
  v_exp_f32 v32, v32
  v_mfma_f32_32x32x16_bf16 v[64:79], v[124:127], v[84:87], v[64:79]
  v_exp_f32 v33, v33
  v_exp_f32 v34, v34
  v_exp_f32 v35, v35
  v_mfma_f32_32x32x16_bf16 v[48:63], v[104:107], v[8:11], v[16:31]
  ds_read_b128 v[120:123], v5 offset:22528
  v_cvt_pk_bf16_f32 v80, v32, v33
  v_exp_f32 v36, v36
  v_exp_f32 v37, v37
  v_cvt_pk_bf16_f32 v81, v34, v35
  v_mfma_f32_16x16x32_bf16 v[88:91], v[92:95], v[84:87], v[88:91]
  ds_read_b128 v[124:127], v5 offset:23552
  v_exp_f32 v38, v38
  v_exp_f32 v39, v39
  v_mfma_f32_32x32x16_bf16 v[48:63], v[108:111], v[12:15], v[48:63]
  s_setprio 0
  ds_read_b128 v[96:99], v5 offset:24576
  v_cvt_pk_bf16_f32 v82, v36, v37
  v_exp_f32 v40, v40
  v_cvt_pk_bf16_f32 v83, v38, v39
  v_exp_f32 v41, v41
  ds_read_b128 v[100:103], v5 offset:25600
  v_mfma_f32_32x32x16_bf16 v[64:79], v[112:115], v[80:83], v[64:79]
  v_exp_f32 v42, v42
  v_exp_f32 v43, v43
  v_cvt_pk_bf16_f32 v84, v40, v41
  v_exp_f32 v44, v44
  v_mfma_f32_16x16x32_bf16 v[88:91], v[92:95], v[80:83], v[88:91]
  v_exp_f32 v45, v45
  v_cvt_pk_bf16_f32 v85, v42, v43
  v_exp_f32 v46, v46
  v_exp_f32 v47, v47
  v_cvt_pk_bf16_f32 v86, v44, v45
  v_cvt_pk_bf16_f32 v87, v46, v47
  s_waitcnt lgkmcnt(0)
  v_exp_f32 v48, v48
  v_mfma_f32_32x32x16_bf16 v[64:79], v[116:119], v[84:87], v[64:79]
  v_exp_f32 v49, v49
  v_exp_f32 v50, v50
  v_exp_f32 v51, v51
  v_mfma_f32_32x32x16_bf16 v[32:47], v[96:99], v[8:11], v[16:31]
  ds_read_b128 v[112:115], v5 offset:26624
  v_cvt_pk_bf16_f32 v80, v48, v49
  v_exp_f32 v52, v52
  v_exp_f32 v53, v53
  v_cvt_pk_bf16_f32 v81, v50, v51
  v_mfma_f32_16x16x32_bf16 v[88:91], v[92:95], v[84:87], v[88:91]
  ds_read_b128 v[116:119], v5 offset:27648
  v_exp_f32 v54, v54
  v_exp_f32 v55, v55
  v_mfma_f32_32x32x16_bf16 v[32:47], v[100:103], v[12:15], v[32:47]
  ds_read_b128 v[104:107], v5 offset:28672
  v_cvt_pk_bf16_f32 v82, v52, v53
  v_exp_f32 v56, v56
  v_cvt_pk_bf16_f32 v83, v54, v55
  v_exp_f32 v57, v57
  ds_read_b128 v[108:111], v5 offset:29696
  v_mfma_f32_32x32x16_bf16 v[64:79], v[120:123], v[80:83], v[64:79]
  v_exp_f32 v58, v58
  v_exp_f32 v59, v59
  v_cvt_pk_bf16_f32 v84, v56, v57
  v_exp_f32 v60, v60
  v_mfma_f32_16x16x32_bf16 v[88:91], v[92:95], v[80:83], v[88:91]
  v_exp_f32 v61, v61
  v_cvt_pk_bf16_f32 v85, v58, v59
  v_exp_f32 v62, v62
  v_exp_f32 v63, v63
  v_cvt_pk_bf16_f32 v86, v60, v61
  v_cvt_pk_bf16_f32 v87, v62, v63
  s_waitcnt lgkmcnt(0)
  s_waitcnt vmcnt(3)
  s_barrier
  s_setprio 1
  v_mov_b32 v255, s89
  s_lshl_b32 s28, s2, 2
  s_add_u32 s28, s28, 0x3000
  s_mov_b64 exec, 1
  buffer_store_dword v255, off, s[92:95], s28 sc1
  s_mov_b64 exec, -1
  v_xor_b32 v6, 64, v6
  s_add_u32 m0, s55, 3072
  s_mov_b32 s28, 3145728
  buffer_load_dwordx4 v6, s[84:87], s28 offen lds
  v_exp_f32 v32, v32
  v_mfma_f32_32x32x16_bf16 v[64:79], v[124:127], v[84:87], v[64:79]
  v_exp_f32 v33, v33
  v_exp_f32 v34, v34
  v_exp_f32 v35, v35
  v_mfma_f32_32x32x16_bf16 v[48:63], v[104:107], v[8:11], v[16:31]
  ds_read_b128 v[120:123], v5 offset:30720
  v_cvt_pk_bf16_f32 v80, v32, v33
  v_exp_f32 v36, v36
  v_exp_f32 v37, v37
  v_cvt_pk_bf16_f32 v81, v34, v35
  v_mfma_f32_16x16x32_bf16 v[88:91], v[92:95], v[84:87], v[88:91]
  ds_read_b128 v[124:127], v5 offset:31744
  v_exp_f32 v38, v38
  v_exp_f32 v39, v39
  v_mfma_f32_32x32x16_bf16 v[48:63], v[108:111], v[12:15], v[48:63]
  ds_read_b128 v[96:99], v5 offset:32768
  v_cvt_pk_bf16_f32 v82, v36, v37
  v_exp_f32 v40, v40
  v_cvt_pk_bf16_f32 v83, v38, v39
  v_exp_f32 v41, v41
  ds_read_b128 v[100:103], v5 offset:33792
  v_mfma_f32_32x32x16_bf16 v[64:79], v[112:115], v[80:83], v[64:79]
  v_exp_f32 v42, v42
  v_exp_f32 v43, v43
  v_cvt_pk_bf16_f32 v84, v40, v41
  v_exp_f32 v44, v44
  v_mfma_f32_16x16x32_bf16 v[88:91], v[92:95], v[80:83], v[88:91]
  v_exp_f32 v45, v45
  v_cvt_pk_bf16_f32 v85, v42, v43
  v_exp_f32 v46, v46
  v_exp_f32 v47, v47
  v_cvt_pk_bf16_f32 v86, v44, v45
  v_cvt_pk_bf16_f32 v87, v46, v47
  s_waitcnt lgkmcnt(0)
  v_exp_f32 v48, v48
  v_mfma_f32_32x32x16_bf16 v[64:79], v[116:119], v[84:87], v[64:79]
  v_exp_f32 v49, v49
  v_exp_f32 v50, v50
  v_exp_f32 v51, v51
  v_mfma_f32_32x32x16_bf16 v[32:47], v[96:99], v[8:11], v[16:31]
  ds_read_b128 v[112:115], v5 offset:34816
  v_cvt_pk_bf16_f32 v80, v48, v49
  v_exp_f32 v52, v52
  v_exp_f32 v53, v53
  v_cvt_pk_bf16_f32 v81, v50, v51
  v_mfma_f32_16x16x32_bf16 v[88:91], v[92:95], v[84:87], v[88:91]
  ds_read_b128 v[116:119], v5 offset:35840
  ds_read_b64_tr_b16 v[168:169], v2 offset:32768
  ds_read_b64_tr_b16 v[170:171], v2 offset:34816
  v_exp_f32 v54, v54
  v_exp_f32 v55, v55
  v_mfma_f32_32x32x16_bf16 v[32:47], v[100:103], v[12:15], v[32:47]
  ds_read_b128 v[104:107], v5 offset:36864
  v_cvt_pk_bf16_f32 v82, v52, v53
  v_exp_f32 v56, v56
  v_cvt_pk_bf16_f32 v83, v54, v55
  v_exp_f32 v57, v57
  ds_read_b128 v[108:111], v5 offset:37888
  ds_read_b64_tr_b16 v[172:173], v2 offset:36864
  ds_read_b64_tr_b16 v[174:175], v2 offset:38912
  v_mfma_f32_32x32x16_bf16 v[64:79], v[120:123], v[80:83], v[64:79]
  v_exp_f32 v58, v58
  v_exp_f32 v59, v59
  v_cvt_pk_bf16_f32 v84, v56, v57
  v_exp_f32 v60, v60
  v_mfma_f32_16x16x32_bf16 v[88:91], v[92:95], v[80:83], v[88:91]
  v_exp_f32 v61, v61
  v_cvt_pk_bf16_f32 v85, v58, v59
  v_exp_f32 v62, v62
  v_exp_f32 v63, v63
  v_cvt_pk_bf16_f32 v86, v60, v61
  v_cvt_pk_bf16_f32 v87, v62, v63
  s_waitcnt lgkmcnt(0)
  v_exp_f32 v32, v32
  v_mfma_f32_32x32x16_bf16 v[64:79], v[124:127], v[84:87], v[64:79]
  v_exp_f32 v33, v33
  v_exp_f32 v34, v34
  v_exp_f32 v35, v35
  v_mfma_f32_32x32x16_bf16 v[48:63], v[104:107], v[8:11], v[16:31]
  ds_read_b128 v[120:123], v5 offset:38912
  v_cvt_pk_bf16_f32 v80, v32, v33
  v_exp_f32 v36, v36
  v_exp_f32 v37, v37
  v_cvt_pk_bf16_f32 v81, v34, v35
  v_mfma_f32_16x16x32_bf16 v[88:91], v[92:95], v[84:87], v[88:91]
  ds_read_b128 v[124:127], v5 offset:39936
  v_exp_f32 v38, v38
  v_exp_f32 v39, v39
  v_mfma_f32_32x32x16_bf16 v[48:63], v[108:111], v[12:15], v[48:63]
  s_setprio 0
  ds_read_b128 v[96:99], v5 offset:40960
  v_cvt_pk_bf16_f32 v82, v36, v37
  v_exp_f32 v40, v40
  v_cvt_pk_bf16_f32 v83, v38, v39
  v_exp_f32 v41, v41
  ds_read_b128 v[100:103], v5 offset:41984
  v_mfma_f32_32x32x16_bf16 v[64:79], v[112:115], v[80:83], v[64:79]
  v_exp_f32 v42, v42
  v_exp_f32 v43, v43
  v_cvt_pk_bf16_f32 v84, v40, v41
  v_exp_f32 v44, v44
  v_mfma_f32_16x16x32_bf16 v[88:91], v[92:95], v[80:83], v[88:91]
  v_exp_f32 v45, v45
  v_cvt_pk_bf16_f32 v85, v42, v43
  v_exp_f32 v46, v46
  v_exp_f32 v47, v47
  v_cvt_pk_bf16_f32 v86, v44, v45
  v_cvt_pk_bf16_f32 v87, v46, v47
  s_waitcnt lgkmcnt(0)
  v_exp_f32 v48, v48
  v_mfma_f32_32x32x16_bf16 v[64:79], v[116:119], v[84:87], v[64:79]
  v_exp_f32 v49, v49
  v_exp_f32 v50, v50
  v_exp_f32 v51, v51
  v_mfma_f32_32x32x16_bf16 v[32:47], v[96:99], v[8:11], v[16:31]
  ds_read_b128 v[112:115], v5 offset:43008
  v_cvt_pk_bf16_f32 v80, v48, v49
  v_exp_f32 v52, v52
  v_exp_f32 v53, v53
  v_cvt_pk_bf16_f32 v81, v50, v51
  v_mfma_f32_16x16x32_bf16 v[88:91], v[92:95], v[84:87], v[88:91]
  ds_read_b128 v[116:119], v5 offset:44032
  v_exp_f32 v54, v54
  v_exp_f32 v55, v55
  v_mfma_f32_32x32x16_bf16 v[32:47], v[100:103], v[12:15], v[32:47]
  ds_read_b128 v[104:107], v5 offset:45056
  v_cvt_pk_bf16_f32 v82, v52, v53
  v_exp_f32 v56, v56
  v_cvt_pk_bf16_f32 v83, v54, v55
  v_exp_f32 v57, v57
  ds_read_b128 v[108:111], v5 offset:46080
  v_mfma_f32_32x32x16_bf16 v[64:79], v[120:123], v[80:83], v[64:79]
  v_exp_f32 v58, v58
  v_exp_f32 v59, v59
  v_cvt_pk_bf16_f32 v84, v56, v57
  v_exp_f32 v60, v60
  v_mfma_f32_16x16x32_bf16 v[88:91], v[92:95], v[80:83], v[88:91]
  v_exp_f32 v61, v61
  v_cvt_pk_bf16_f32 v85, v58, v59
  v_exp_f32 v62, v62
  v_exp_f32 v63, v63
  v_cvt_pk_bf16_f32 v86, v60, v61
  v_cvt_pk_bf16_f32 v87, v62, v63
  s_waitcnt lgkmcnt(0)
  s_barrier
  s_setprio 1
  v_exp_f32 v32, v32
  v_mfma_f32_32x32x16_bf16 v[64:79], v[124:127], v[84:87], v[64:79]
  v_exp_f32 v33, v33
  v_exp_f32 v34, v34
  v_exp_f32 v35, v35
  v_mfma_f32_32x32x16_bf16 v[48:63], v[104:107], v[8:11], v[16:31]
  ds_read_b128 v[120:123], v5 offset:47104
  v_cvt_pk_bf16_f32 v80, v32, v33
  v_exp_f32 v36, v36
  v_exp_f32 v37, v37
  v_cvt_pk_bf16_f32 v81, v34, v35
  v_mfma_f32_16x16x32_bf16 v[88:91], v[92:95], v[84:87], v[88:91]
  ds_read_b128 v[124:127], v5 offset:48128
  v_exp_f32 v38, v38
  v_exp_f32 v39, v39
  v_mfma_f32_32x32x16_bf16 v[48:63], v[108:111], v[12:15], v[48:63]
  ds_read_b128 v[96:99], v5 offset:49152
  v_cvt_pk_bf16_f32 v82, v36, v37
  v_exp_f32 v40, v40
  v_cvt_pk_bf16_f32 v83, v38, v39
  v_exp_f32 v41, v41
  ds_read_b128 v[100:103], v5 offset:50176
  v_mfma_f32_32x32x16_bf16 v[64:79], v[112:115], v[80:83], v[64:79]
  v_exp_f32 v42, v42
  v_exp_f32 v43, v43
  v_cvt_pk_bf16_f32 v84, v40, v41
  v_exp_f32 v44, v44
  v_mfma_f32_16x16x32_bf16 v[88:91], v[92:95], v[80:83], v[88:91]
  v_exp_f32 v45, v45
  v_cvt_pk_bf16_f32 v85, v42, v43
  v_exp_f32 v46, v46
  v_exp_f32 v47, v47
  v_cvt_pk_bf16_f32 v86, v44, v45
  v_cvt_pk_bf16_f32 v87, v46, v47
  s_waitcnt lgkmcnt(0)
  v_exp_f32 v48, v48
  v_mfma_f32_32x32x16_bf16 v[64:79], v[116:119], v[84:87], v[64:79]
  v_exp_f32 v49, v49
  v_exp_f32 v50, v50
  v_exp_f32 v51, v51
  v_mfma_f32_32x32x16_bf16 v[32:47], v[96:99], v[8:11], v[16:31]
  ds_read_b128 v[112:115], v5 offset:51200
  v_cvt_pk_bf16_f32 v80, v48, v49
  v_exp_f32 v52, v52
  v_exp_f32 v53, v53
  v_cvt_pk_bf16_f32 v81, v50, v51
  v_mfma_f32_16x16x32_bf16 v[88:91], v[92:95], v[84:87], v[88:91]
  ds_read_b128 v[116:119], v5 offset:52224
  ds_read_b64_tr_b16 v[176:177], v2 offset:0
  ds_read_b64_tr_b16 v[178:179], v2 offset:2048
  v_exp_f32 v54, v54
  v_exp_f32 v55, v55
  v_mfma_f32_32x32x16_bf16 v[32:47], v[100:103], v[12:15], v[32:47]
  ds_read_b128 v[104:107], v5 offset:53248
  v_cvt_pk_bf16_f32 v82, v52, v53
  v_exp_f32 v56, v56
  v_cvt_pk_bf16_f32 v83, v54, v55
  v_exp_f32 v57, v57
  ds_read_b128 v[108:111], v5 offset:54272
  ds_read_b64_tr_b16 v[180:181], v2 offset:4096
  ds_read_b64_tr_b16 v[182:183], v2 offset:6144
  v_mfma_f32_32x32x16_bf16 v[64:79], v[120:123], v[80:83], v[64:79]
  v_exp_f32 v58, v58
  v_exp_f32 v59, v59
  v_cvt_pk_bf16_f32 v84, v56, v57
  v_exp_f32 v60, v60
  v_mfma_f32_16x16x32_bf16 v[88:91], v[92:95], v[80:83], v[88:91]
  v_exp_f32 v61, v61
  v_cvt_pk_bf16_f32 v85, v58, v59
  v_exp_f32 v62, v62
  v_exp_f32 v63, v63
  v_cvt_pk_bf16_f32 v86, v60, v61
  v_cvt_pk_bf16_f32 v87, v62, v63
  s_waitcnt lgkmcnt(0)
  v_exp_f32 v32, v32
  v_mfma_f32_32x32x16_bf16 v[64:79], v[124:127], v[84:87], v[64:79]
  v_exp_f32 v33, v33
  v_exp_f32 v34, v34
  v_exp_f32 v35, v35
  v_mfma_f32_32x32x16_bf16 v[48:63], v[104:107], v[8:11], v[16:31]
  ds_read_b128 v[120:123], v5 offset:55296
  v_cvt_pk_bf16_f32 v80, v32, v33
  v_exp_f32 v36, v36
  v_exp_f32 v37, v37
  v_cvt_pk_bf16_f32 v81, v34, v35
  v_mfma_f32_16x16x32_bf16 v[88:91], v[92:95], v[84:87], v[88:91]
  ds_read_b128 v[124:127], v5 offset:56320
  v_exp_f32 v38, v38
  v_exp_f32 v39, v39
  v_mfma_f32_32x32x16_bf16 v[48:63], v[108:111], v[12:15], v[48:63]
  s_setprio 0
  ds_read_b128 v[96:99], v5 offset:57344
  v_cvt_pk_bf16_f32 v82, v36, v37
  v_exp_f32 v40, v40
  v_cvt_pk_bf16_f32 v83, v38, v39
  v_exp_f32 v41, v41
  ds_read_b128 v[100:103], v5 offset:58368
  v_mfma_f32_32x32x16_bf16 v[64:79], v[112:115], v[80:83], v[64:79]
  v_exp_f32 v42, v42
  v_exp_f32 v43, v43
  v_cvt_pk_bf16_f32 v84, v40, v41
  v_exp_f32 v44, v44
  v_mfma_f32_16x16x32_bf16 v[88:91], v[92:95], v[80:83], v[88:91]
  v_exp_f32 v45, v45
  v_cvt_pk_bf16_f32 v85, v42, v43
  v_exp_f32 v46, v46
  v_exp_f32 v47, v47
  v_cvt_pk_bf16_f32 v86, v44, v45
  v_cvt_pk_bf16_f32 v87, v46, v47
  s_waitcnt lgkmcnt(0)
  v_exp_f32 v48, v48
  v_mfma_f32_32x32x16_bf16 v[64:79], v[116:119], v[84:87], v[64:79]
  v_exp_f32 v49, v49
  v_exp_f32 v50, v50
  v_exp_f32 v51, v51
  v_mfma_f32_32x32x16_bf16 v[32:47], v[96:99], v[8:11], v[16:31]
  ds_read_b128 v[112:115], v5 offset:59392
  v_cvt_pk_bf16_f32 v80, v48, v49
  v_exp_f32 v52, v52
  v_exp_f32 v53, v53
  v_cvt_pk_bf16_f32 v81, v50, v51
  v_mfma_f32_16x16x32_bf16 v[88:91], v[92:95], v[84:87], v[88:91]
  ds_read_b128 v[116:119], v5 offset:60416
  v_exp_f32 v54, v54
  v_exp_f32 v55, v55
  v_mfma_f32_32x32x16_bf16 v[32:47], v[100:103], v[12:15], v[32:47]
  ds_read_b128 v[104:107], v5 offset:61440
  v_cvt_pk_bf16_f32 v82, v52, v53
  v_exp_f32 v56, v56
  v_cvt_pk_bf16_f32 v83, v54, v55
  v_exp_f32 v57, v57
  ds_read_b128 v[108:111], v5 offset:62464
  v_mfma_f32_32x32x16_bf16 v[64:79], v[120:123], v[80:83], v[64:79]
  v_exp_f32 v58, v58
  v_exp_f32 v59, v59
  v_cvt_pk_bf16_f32 v84, v56, v57
  v_exp_f32 v60, v60
  v_mfma_f32_16x16x32_bf16 v[88:91], v[92:95], v[80:83], v[88:91]
  v_exp_f32 v61, v61
  v_cvt_pk_bf16_f32 v85, v58, v59
  v_exp_f32 v62, v62
  v_exp_f32 v63, v63
  v_cvt_pk_bf16_f32 v86, v60, v61
  v_cvt_pk_bf16_f32 v87, v62, v63
  s_waitcnt lgkmcnt(0)
  s_barrier
  s_setprio 1
  v_exp_f32 v32, v32
  v_mfma_f32_32x32x16_bf16 v[64:79], v[124:127], v[84:87], v[64:79]
  v_exp_f32 v33, v33
  v_exp_f32 v34, v34
  v_exp_f32 v35, v35
  v_mfma_f32_32x32x16_bf16 v[48:63], v[104:107], v[8:11], v[16:31]
  ds_read_b128 v[120:123], v5 offset:63488
  v_cvt_pk_bf16_f32 v80, v32, v33
  v_exp_f32 v36, v36
  v_exp_f32 v37, v37
  v_cvt_pk_bf16_f32 v81, v34, v35
  v_mfma_f32_16x16x32_bf16 v[88:91], v[92:95], v[84:87], v[88:91]
  ds_read_b128 v[124:127], v5 offset:64512
  v_exp_f32 v38, v38
  v_exp_f32 v39, v39
  v_mfma_f32_32x32x16_bf16 v[48:63], v[108:111], v[12:15], v[48:63]
  ds_read_b128 v[96:99], v5 offset:0
  v_cvt_pk_bf16_f32 v82, v36, v37
  v_exp_f32 v40, v40
  v_cvt_pk_bf16_f32 v83, v38, v39
  v_exp_f32 v41, v41
  ds_read_b128 v[100:103], v5 offset:1024
  v_mfma_f32_32x32x16_bf16 v[64:79], v[112:115], v[80:83], v[64:79]
  v_exp_f32 v42, v42
  v_exp_f32 v43, v43
  v_cvt_pk_bf16_f32 v84, v40, v41
  v_exp_f32 v44, v44
  v_mfma_f32_16x16x32_bf16 v[88:91], v[92:95], v[80:83], v[88:91]
  v_exp_f32 v45, v45
  v_cvt_pk_bf16_f32 v85, v42, v43
  v_exp_f32 v46, v46
  v_exp_f32 v47, v47
  v_cvt_pk_bf16_f32 v86, v44, v45
  v_cvt_pk_bf16_f32 v87, v46, v47
  s_waitcnt lgkmcnt(0)
  v_exp_f32 v48, v48
  v_mfma_f32_32x32x16_bf16 v[64:79], v[116:119], v[84:87], v[64:79]
  v_exp_f32 v49, v49
  v_exp_f32 v50, v50
  v_exp_f32 v51, v51
  v_mfma_f32_32x32x16_bf16 v[32:47], v[96:99], v[8:11], v[16:31]
  ds_read_b128 v[112:115], v5 offset:2048
  v_cvt_pk_bf16_f32 v80, v48, v49
  v_exp_f32 v52, v52
  v_exp_f32 v53, v53
  v_cvt_pk_bf16_f32 v81, v50, v51
  v_mfma_f32_16x16x32_bf16 v[88:91], v[92:95], v[84:87], v[88:91]
  ds_read_b128 v[116:119], v5 offset:3072
  ds_read_b64_tr_b16 v[184:185], v2 offset:16384
  ds_read_b64_tr_b16 v[186:187], v2 offset:18432
  v_exp_f32 v54, v54
  v_exp_f32 v55, v55
  v_mfma_f32_32x32x16_bf16 v[32:47], v[100:103], v[12:15], v[32:47]
  ds_read_b128 v[104:107], v5 offset:4096
  v_cvt_pk_bf16_f32 v82, v52, v53
  v_exp_f32 v56, v56
  v_cvt_pk_bf16_f32 v83, v54, v55
  v_exp_f32 v57, v57
  ds_read_b128 v[108:111], v5 offset:5120
  ds_read_b64_tr_b16 v[188:189], v2 offset:20480
  ds_read_b64_tr_b16 v[190:191], v2 offset:22528
  v_mfma_f32_32x32x16_bf16 v[64:79], v[120:123], v[80:83], v[64:79]
  v_exp_f32 v58, v58
  v_exp_f32 v59, v59
  v_cvt_pk_bf16_f32 v84, v56, v57
  v_exp_f32 v60, v60
  v_mfma_f32_16x16x32_bf16 v[88:91], v[92:95], v[80:83], v[88:91]
  v_exp_f32 v61, v61
  v_cvt_pk_bf16_f32 v85, v58, v59
  v_exp_f32 v62, v62
  v_exp_f32 v63, v63
  v_cvt_pk_bf16_f32 v86, v60, v61
  v_cvt_pk_bf16_f32 v87, v62, v63
  s_waitcnt lgkmcnt(0)
  v_exp_f32 v32, v32
  v_mfma_f32_32x32x16_bf16 v[64:79], v[124:127], v[84:87], v[64:79]
  v_exp_f32 v33, v33
  v_exp_f32 v34, v34
  v_exp_f32 v35, v35
  v_mfma_f32_32x32x16_bf16 v[48:63], v[104:107], v[8:11], v[16:31]
  ds_read_b128 v[120:123], v5 offset:6144
  v_cvt_pk_bf16_f32 v80, v32, v33
  v_exp_f32 v36, v36
  v_exp_f32 v37, v37
  v_cvt_pk_bf16_f32 v81, v34, v35
  v_mfma_f32_16x16x32_bf16 v[88:91], v[92:95], v[84:87], v[88:91]
  ds_read_b128 v[124:127], v5 offset:7168
  v_exp_f32 v38, v38
  v_exp_f32 v39, v39
  v_mfma_f32_32x32x16_bf16 v[48:63], v[108:111], v[12:15], v[48:63]
  s_setprio 0
  ds_read_b128 v[96:99], v5 offset:8192
  v_cvt_pk_bf16_f32 v82, v36, v37
  v_exp_f32 v40, v40
  v_cvt_pk_bf16_f32 v83, v38, v39
  v_exp_f32 v41, v41
  ds_read_b128 v[100:103], v5 offset:9216
  v_mfma_f32_32x32x16_bf16 v[64:79], v[112:115], v[80:83], v[64:79]
  v_exp_f32 v42, v42
  v_exp_f32 v43, v43
  v_cvt_pk_bf16_f32 v84, v40, v41
  v_exp_f32 v44, v44
  v_mfma_f32_16x16x32_bf16 v[88:91], v[92:95], v[80:83], v[88:91]
  v_exp_f32 v45, v45
  v_cvt_pk_bf16_f32 v85, v42, v43
  v_exp_f32 v46, v46
  v_exp_f32 v47, v47
  v_cvt_pk_bf16_f32 v86, v44, v45
  v_cvt_pk_bf16_f32 v87, v46, v47
  s_waitcnt lgkmcnt(0)
  v_exp_f32 v48, v48
  v_mfma_f32_32x32x16_bf16 v[64:79], v[116:119], v[84:87], v[64:79]
  v_exp_f32 v49, v49
  v_exp_f32 v50, v50
  v_exp_f32 v51, v51
  v_mfma_f32_32x32x16_bf16 v[32:47], v[96:99], v[8:11], v[16:31]
  ds_read_b128 v[112:115], v5 offset:10240
  v_cvt_pk_bf16_f32 v80, v48, v49
  v_exp_f32 v52, v52
  v_exp_f32 v53, v53
  v_cvt_pk_bf16_f32 v81, v50, v51
  v_mfma_f32_16x16x32_bf16 v[88:91], v[92:95], v[84:87], v[88:91]
  ds_read_b128 v[116:119], v5 offset:11264
  v_exp_f32 v54, v54
  v_exp_f32 v55, v55
  v_mfma_f32_32x32x16_bf16 v[32:47], v[100:103], v[12:15], v[32:47]
  ds_read_b128 v[104:107], v5 offset:12288
  v_cvt_pk_bf16_f32 v82, v52, v53
  v_exp_f32 v56, v56
  v_cvt_pk_bf16_f32 v83, v54, v55
  v_exp_f32 v57, v57
  ds_read_b128 v[108:111], v5 offset:13312
  v_mfma_f32_32x32x16_bf16 v[64:79], v[120:123], v[80:83], v[64:79]
  v_exp_f32 v58, v58
  v_exp_f32 v59, v59
  v_cvt_pk_bf16_f32 v84, v56, v57
  v_exp_f32 v60, v60
  v_mfma_f32_16x16x32_bf16 v[88:91], v[92:95], v[80:83], v[88:91]
  v_exp_f32 v61, v61
  v_cvt_pk_bf16_f32 v85, v58, v59
  v_exp_f32 v62, v62
  v_exp_f32 v63, v63
  v_cvt_pk_bf16_f32 v86, v60, v61
  v_cvt_pk_bf16_f32 v87, v62, v63
  s_waitcnt lgkmcnt(0)
  s_barrier
  s_setprio 1
  v_exp_f32 v32, v32
  v_mfma_f32_32x32x16_bf16 v[64:79], v[124:127], v[84:87], v[64:79]
  v_exp_f32 v33, v33
  v_exp_f32 v34, v34
  v_exp_f32 v35, v35
  v_mfma_f32_32x32x16_bf16 v[48:63], v[104:107], v[8:11], v[16:31]
  ds_read_b128 v[120:123], v5 offset:14336
  v_cvt_pk_bf16_f32 v80, v32, v33
  v_exp_f32 v36, v36
  v_exp_f32 v37, v37
  v_cvt_pk_bf16_f32 v81, v34, v35
  v_mfma_f32_16x16x32_bf16 v[88:91], v[92:95], v[84:87], v[88:91]
  ds_read_b128 v[124:127], v5 offset:15360
  v_exp_f32 v38, v38
  v_exp_f32 v39, v39
  v_mfma_f32_32x32x16_bf16 v[48:63], v[108:111], v[12:15], v[48:63]
  ds_read_b128 v[96:99], v5 offset:16384
  v_cvt_pk_bf16_f32 v82, v36, v37
  v_exp_f32 v40, v40
  v_cvt_pk_bf16_f32 v83, v38, v39
  v_exp_f32 v41, v41
  ds_read_b128 v[100:103], v5 offset:17408
  v_mfma_f32_32x32x16_bf16 v[64:79], v[112:115], v[80:83], v[64:79]
  v_exp_f32 v42, v42
  v_exp_f32 v43, v43
  v_cvt_pk_bf16_f32 v84, v40, v41
  v_exp_f32 v44, v44
  v_mfma_f32_16x16x32_bf16 v[88:91], v[92:95], v[80:83], v[88:91]
  v_exp_f32 v45, v45
  v_cvt_pk_bf16_f32 v85, v42, v43
  v_exp_f32 v46, v46
  v_exp_f32 v47, v47
  v_cvt_pk_bf16_f32 v86, v44, v45
  v_cvt_pk_bf16_f32 v87, v46, v47
  s_waitcnt lgkmcnt(0)
  v_exp_f32 v48, v48
  v_mfma_f32_32x32x16_bf16 v[64:79], v[116:119], v[84:87], v[64:79]
  v_exp_f32 v49, v49
  v_exp_f32 v50, v50
  v_exp_f32 v51, v51
  v_mfma_f32_32x32x16_bf16 v[32:47], v[96:99], v[8:11], v[16:31]
  ds_read_b128 v[112:115], v5 offset:18432
  v_cvt_pk_bf16_f32 v80, v48, v49
  v_exp_f32 v52, v52
  v_exp_f32 v53, v53
  v_cvt_pk_bf16_f32 v81, v50, v51
  v_mfma_f32_16x16x32_bf16 v[88:91], v[92:95], v[84:87], v[88:91]
  ds_read_b128 v[116:119], v5 offset:19456
  ds_read_b64_tr_b16 v[192:193], v2 offset:32768
  ds_read_b64_tr_b16 v[194:195], v2 offset:34816
  v_exp_f32 v54, v54
  v_exp_f32 v55, v55
  v_mfma_f32_32x32x16_bf16 v[32:47], v[100:103], v[12:15], v[32:47]
  ds_read_b128 v[104:107], v5 offset:20480
  v_cvt_pk_bf16_f32 v82, v52, v53
  v_exp_f32 v56, v56
  v_cvt_pk_bf16_f32 v83, v54, v55
  v_exp_f32 v57, v57
  ds_read_b128 v[108:111], v5 offset:21504
  ds_read_b64_tr_b16 v[196:197], v2 offset:36864
  ds_read_b64_tr_b16 v[198:199], v2 offset:38912
  v_mfma_f32_32x32x16_bf16 v[64:79], v[120:123], v[80:83], v[64:79]
  v_exp_f32 v58, v58
  v_exp_f32 v59, v59
  v_cvt_pk_bf16_f32 v84, v56, v57
  v_exp_f32 v60, v60
  v_mfma_f32_16x16x32_bf16 v[88:91], v[92:95], v[80:83], v[88:91]
  v_exp_f32 v61, v61
  v_cvt_pk_bf16_f32 v85, v58, v59
  v_exp_f32 v62, v62
  v_exp_f32 v63, v63
  v_cvt_pk_bf16_f32 v86, v60, v61
  v_cvt_pk_bf16_f32 v87, v62, v63
  s_waitcnt lgkmcnt(0)
  v_exp_f32 v32, v32
  v_mfma_f32_32x32x16_bf16 v[64:79], v[124:127], v[84:87], v[64:79]
  v_exp_f32 v33, v33
  v_exp_f32 v34, v34
  v_exp_f32 v35, v35
  v_mfma_f32_32x32x16_bf16 v[48:63], v[104:107], v[8:11], v[16:31]
  ds_read_b128 v[120:123], v5 offset:22528
  v_cvt_pk_bf16_f32 v80, v32, v33
  v_exp_f32 v36, v36
  v_exp_f32 v37, v37
  v_cvt_pk_bf16_f32 v81, v34, v35
  v_mfma_f32_16x16x32_bf16 v[88:91], v[92:95], v[84:87], v[88:91]
  ds_read_b128 v[124:127], v5 offset:23552
  v_exp_f32 v38, v38
  v_exp_f32 v39, v39
  v_mfma_f32_32x32x16_bf16 v[48:63], v[108:111], v[12:15], v[48:63]
  s_setprio 0
  ds_read_b128 v[96:99], v5 offset:24576
  v_cvt_pk_bf16_f32 v82, v36, v37
  v_exp_f32 v40, v40
  v_cvt_pk_bf16_f32 v83, v38, v39
  v_exp_f32 v41, v41
  ds_read_b128 v[100:103], v5 offset:25600
  v_mfma_f32_32x32x16_bf16 v[64:79], v[112:115], v[80:83], v[64:79]
  v_exp_f32 v42, v42
  v_exp_f32 v43, v43
  v_cvt_pk_bf16_f32 v84, v40, v41
  v_exp_f32 v44, v44
  v_mfma_f32_16x16x32_bf16 v[88:91], v[92:95], v[80:83], v[88:91]
  v_exp_f32 v45, v45
  v_cvt_pk_bf16_f32 v85, v42, v43
  v_exp_f32 v46, v46
  v_exp_f32 v47, v47
  v_cvt_pk_bf16_f32 v86, v44, v45
  v_cvt_pk_bf16_f32 v87, v46, v47
  s_waitcnt lgkmcnt(0)
  v_exp_f32 v48, v48
  v_mfma_f32_32x32x16_bf16 v[64:79], v[116:119], v[84:87], v[64:79]
  v_exp_f32 v49, v49
  v_exp_f32 v50, v50
  v_exp_f32 v51, v51
  v_mfma_f32_32x32x16_bf16 v[32:47], v[96:99], v[8:11], v[16:31]
  ds_read_b128 v[112:115], v5 offset:26624
  v_cvt_pk_bf16_f32 v80, v48, v49
  v_exp_f32 v52, v52
  v_exp_f32 v53, v53
  v_cvt_pk_bf16_f32 v81, v50, v51
  v_mfma_f32_16x16x32_bf16 v[88:91], v[92:95], v[84:87], v[88:91]
  ds_read_b128 v[116:119], v5 offset:27648
  v_exp_f32 v54, v54
  v_exp_f32 v55, v55
  v_mfma_f32_32x32x16_bf16 v[32:47], v[100:103], v[12:15], v[32:47]
  ds_read_b128 v[104:107], v5 offset:28672
  v_cvt_pk_bf16_f32 v82, v52, v53
  v_exp_f32 v56, v56
  v_cvt_pk_bf16_f32 v83, v54, v55
  v_exp_f32 v57, v57
  ds_read_b128 v[108:111], v5 offset:29696
  v_mfma_f32_32x32x16_bf16 v[64:79], v[120:123], v[80:83], v[64:79]
  v_exp_f32 v58, v58
  v_exp_f32 v59, v59
  v_cvt_pk_bf16_f32 v84, v56, v57
  v_exp_f32 v60, v60
  v_mfma_f32_16x16x32_bf16 v[88:91], v[92:95], v[80:83], v[88:91]
  v_exp_f32 v61, v61
  v_cvt_pk_bf16_f32 v85, v58, v59
  v_exp_f32 v62, v62
  v_exp_f32 v63, v63
  v_cvt_pk_bf16_f32 v86, v60, v61
  v_cvt_pk_bf16_f32 v87, v62, v63
  s_waitcnt lgkmcnt(0)
  s_barrier
  s_setprio 1
  v_lshrrev_b32 v252, 3, v0
  v_lshlrev_b32 v252, 7, v252
  v_and_b32 v253, 7, v0
  v_lshlrev_b32 v253, 2, v253
  v_add_u32 v252, v252, v253
  s_lshl_b32 s28, s45, 5
  s_add_u32 s28, s28, 0x3000
  v_add_u32 v252, s28, v252
  v_and_b32 v253, 31, v0
  v_lshlrev_b32 v253, 2, v253
  s_lshl_b32 s28, s44, 7
  s_add_u32 s28, s28, 0x3000
  v_add_u32 v253, s28, v253
  buffer_load_dword v250, v252, s[92:95], 0 offen sc1
  buffer_load_dword v251, v253, s[92:95], 0 offen sc1
  v_exp_f32 v32, v32
  v_mfma_f32_32x32x16_bf16 v[64:79], v[124:127], v[84:87], v[64:79]
  v_exp_f32 v33, v33
  v_exp_f32 v34, v34
  v_exp_f32 v35, v35
  v_mfma_f32_32x32x16_bf16 v[48:63], v[104:107], v[8:11], v[16:31]
  ds_read_b128 v[120:123], v5 offset:30720
  v_cvt_pk_bf16_f32 v80, v32, v33
  v_exp_f32 v36, v36
  v_exp_f32 v37, v37
  v_cvt_pk_bf16_f32 v81, v34, v35
  v_mfma_f32_16x16x32_bf16 v[88:91], v[92:95], v[84:87], v[88:91]
  ds_read_b128 v[124:127], v5 offset:31744
  v_exp_f32 v38, v38
  v_exp_f32 v39, v39
  v_mfma_f32_32x32x16_bf16 v[48:63], v[108:111], v[12:15], v[48:63]
  ds_read_b128 v[96:99], v5 offset:32768
  v_cvt_pk_bf16_f32 v82, v36, v37
  v_exp_f32 v40, v40
  v_cvt_pk_bf16_f32 v83, v38, v39
  v_exp_f32 v41, v41
  ds_read_b128 v[100:103], v5 offset:33792
  v_mfma_f32_32x32x16_bf16 v[64:79], v[112:115], v[80:83], v[64:79]
  v_exp_f32 v42, v42
  v_exp_f32 v43, v43
  v_cvt_pk_bf16_f32 v84, v40, v41
  v_exp_f32 v44, v44
  v_mfma_f32_16x16x32_bf16 v[88:91], v[92:95], v[80:83], v[88:91]
  v_exp_f32 v45, v45
  v_cvt_pk_bf16_f32 v85, v42, v43
  v_exp_f32 v46, v46
  v_exp_f32 v47, v47
  v_cvt_pk_bf16_f32 v86, v44, v45
  v_cvt_pk_bf16_f32 v87, v46, v47
  s_waitcnt lgkmcnt(0)
  v_exp_f32 v48, v48
  v_mfma_f32_32x32x16_bf16 v[64:79], v[116:119], v[84:87], v[64:79]
  v_exp_f32 v49, v49
  v_exp_f32 v50, v50
  v_exp_f32 v51, v51
  v_mfma_f32_32x32x16_bf16 v[32:47], v[96:99], v[8:11], v[16:31]
  ds_read_b128 v[112:115], v5 offset:34816
  v_cvt_pk_bf16_f32 v80, v48, v49
  v_exp_f32 v52, v52
  v_exp_f32 v53, v53
  v_cvt_pk_bf16_f32 v81, v50, v51
  v_mfma_f32_16x16x32_bf16 v[88:91], v[92:95], v[84:87], v[88:91]
  ds_read_b128 v[116:119], v5 offset:35840
  ds_read_b64_tr_b16 v[200:201], v2 offset:0
  ds_read_b64_tr_b16 v[202:203], v2 offset:2048
  v_exp_f32 v54, v54
  v_exp_f32 v55, v55
  v_mfma_f32_32x32x16_bf16 v[32:47], v[100:103], v[12:15], v[32:47]
  ds_read_b128 v[104:107], v5 offset:36864
  v_cvt_pk_bf16_f32 v82, v52, v53
  v_exp_f32 v56, v56
  v_cvt_pk_bf16_f32 v83, v54, v55
  v_exp_f32 v57, v57
  ds_read_b128 v[108:111], v5 offset:37888
  ds_read_b64_tr_b16 v[204:205], v2 offset:4096
  ds_read_b64_tr_b16 v[206:207], v2 offset:6144
  v_mfma_f32_32x32x16_bf16 v[64:79], v[120:123], v[80:83], v[64:79]
  v_exp_f32 v58, v58
  v_exp_f32 v59, v59
  v_cvt_pk_bf16_f32 v84, v56, v57
  v_exp_f32 v60, v60
  v_mfma_f32_16x16x32_bf16 v[88:91], v[92:95], v[80:83], v[88:91]
  v_exp_f32 v61, v61
  v_cvt_pk_bf16_f32 v85, v58, v59
  v_exp_f32 v62, v62
  v_exp_f32 v63, v63
  v_cvt_pk_bf16_f32 v86, v60, v61
  v_cvt_pk_bf16_f32 v87, v62, v63
  s_waitcnt lgkmcnt(0)
  v_exp_f32 v32, v32
  v_mfma_f32_32x32x16_bf16 v[64:79], v[124:127], v[84:87], v[64:79]
  v_exp_f32 v33, v33
  v_exp_f32 v34, v34
  v_exp_f32 v35, v35
  v_mfma_f32_32x32x16_bf16 v[48:63], v[104:107], v[8:11], v[16:31]
  ds_read_b128 v[120:123], v5 offset:38912
  v_cvt_pk_bf16_f32 v80, v32, v33
  v_exp_f32 v36, v36
  v_exp_f32 v37, v37
  v_cvt_pk_bf16_f32 v81, v34, v35
  v_mfma_f32_16x16x32_bf16 v[88:91], v[92:95], v[84:87], v[88:91]
  ds_read_b128 v[124:127], v5 offset:39936
  v_exp_f32 v38, v38
  v_exp_f32 v39, v39
  v_mfma_f32_32x32x16_bf16 v[48:63], v[108:111], v[12:15], v[48:63]
  s_setprio 0
  ds_read_b128 v[96:99], v5 offset:40960
  v_cvt_pk_bf16_f32 v82, v36, v37
  v_exp_f32 v40, v40
  v_cvt_pk_bf16_f32 v83, v38, v39
  v_exp_f32 v41, v41
  ds_read_b128 v[100:103], v5 offset:41984
  v_mfma_f32_32x32x16_bf16 v[64:79], v[112:115], v[80:83], v[64:79]
  v_exp_f32 v42, v42
  v_exp_f32 v43, v43
  v_cvt_pk_bf16_f32 v84, v40, v41
  v_exp_f32 v44, v44
  v_mfma_f32_16x16x32_bf16 v[88:91], v[92:95], v[80:83], v[88:91]
  v_exp_f32 v45, v45
  v_cvt_pk_bf16_f32 v85, v42, v43
  v_exp_f32 v46, v46
  v_exp_f32 v47, v47
  v_cvt_pk_bf16_f32 v86, v44, v45
  v_cvt_pk_bf16_f32 v87, v46, v47
  s_waitcnt lgkmcnt(0)
  v_exp_f32 v48, v48
  v_mfma_f32_32x32x16_bf16 v[64:79], v[116:119], v[84:87], v[64:79]
  v_exp_f32 v49, v49
  v_exp_f32 v50, v50
  v_exp_f32 v51, v51
  v_mfma_f32_32x32x16_bf16 v[32:47], v[96:99], v[8:11], v[16:31]
  ds_read_b128 v[112:115], v5 offset:43008
  v_cvt_pk_bf16_f32 v80, v48, v49
  v_exp_f32 v52, v52
  v_exp_f32 v53, v53
  v_cvt_pk_bf16_f32 v81, v50, v51
  v_mfma_f32_16x16x32_bf16 v[88:91], v[92:95], v[84:87], v[88:91]
  ds_read_b128 v[116:119], v5 offset:44032
  v_exp_f32 v54, v54
  v_exp_f32 v55, v55
  v_mfma_f32_32x32x16_bf16 v[32:47], v[100:103], v[12:15], v[32:47]
  ds_read_b128 v[104:107], v5 offset:45056
  v_cvt_pk_bf16_f32 v82, v52, v53
  v_exp_f32 v56, v56
  v_cvt_pk_bf16_f32 v83, v54, v55
  v_exp_f32 v57, v57
  ds_read_b128 v[108:111], v5 offset:46080
  v_mfma_f32_32x32x16_bf16 v[64:79], v[120:123], v[80:83], v[64:79]
  v_exp_f32 v58, v58
  v_exp_f32 v59, v59
  v_cvt_pk_bf16_f32 v84, v56, v57
  v_exp_f32 v60, v60
  v_mfma_f32_16x16x32_bf16 v[88:91], v[92:95], v[80:83], v[88:91]
  v_exp_f32 v61, v61
  v_cvt_pk_bf16_f32 v85, v58, v59
  v_exp_f32 v62, v62
  v_exp_f32 v63, v63
  v_cvt_pk_bf16_f32 v86, v60, v61
  v_cvt_pk_bf16_f32 v87, v62, v63
  s_waitcnt lgkmcnt(0)
  s_barrier
  s_setprio 1
  s_waitcnt vmcnt(0)
  s_mov_b32 s34, 0
concat_heads__mha_block__spectral_fnet__prompt_kernel_zchk:
  v_cmp_ne_u32 vcc, s89, v250
  v_cmp_ne_u32 s[32:33], s89, v251
  s_nop 3
  s_or_b64 s[32:33], s[32:33], vcc
  s_cbranch_scc1 concat_heads__mha_block__spectral_fnet__prompt_kernel_zspin
concat_heads__mha_block__spectral_fnet__prompt_kernel_zok:
  s_add_u32 m0, s49, 0
  s_mov_b32 s28, 0
  buffer_load_dwordx4 v3, s[56:59], s28 offen sc1 lds
  s_add_u32 m0, s49, 1024
  s_mov_b32 s28, 8192
  buffer_load_dwordx4 v3, s[56:59], s28 offen sc1 lds
  v_exp_f32 v32, v32
  v_mfma_f32_32x32x16_bf16 v[64:79], v[124:127], v[84:87], v[64:79]
  v_exp_f32 v33, v33
  v_exp_f32 v34, v34
  v_exp_f32 v35, v35
  v_mfma_f32_32x32x16_bf16 v[48:63], v[104:107], v[8:11], v[16:31]
  ds_read_b128 v[120:123], v5 offset:47104
  v_cvt_pk_bf16_f32 v80, v32, v33
  v_exp_f32 v36, v36
  v_exp_f32 v37, v37
  v_cvt_pk_bf16_f32 v81, v34, v35
  v_mfma_f32_16x16x32_bf16 v[88:91], v[92:95], v[84:87], v[88:91]
  ds_read_b128 v[124:127], v5 offset:48128
  v_exp_f32 v38, v38
  v_exp_f32 v39, v39
  v_mfma_f32_32x32x16_bf16 v[48:63], v[108:111], v[12:15], v[48:63]
  ds_read_b128 v[96:99], v5 offset:49152
  v_cvt_pk_bf16_f32 v82, v36, v37
  v_exp_f32 v40, v40
  v_cvt_pk_bf16_f32 v83, v38, v39
  v_exp_f32 v41, v41
  ds_read_b128 v[100:103], v5 offset:50176
  v_mfma_f32_32x32x16_bf16 v[64:79], v[112:115], v[80:83], v[64:79]
  v_exp_f32 v42, v42
  v_exp_f32 v43, v43
  v_cvt_pk_bf16_f32 v84, v40, v41
  v_exp_f32 v44, v44
  v_mfma_f32_16x16x32_bf16 v[88:91], v[92:95], v[80:83], v[88:91]
  v_exp_f32 v45, v45
  v_cvt_pk_bf16_f32 v85, v42, v43
  v_exp_f32 v46, v46
  v_exp_f32 v47, v47
  v_cvt_pk_bf16_f32 v86, v44, v45
  v_cvt_pk_bf16_f32 v87, v46, v47
  s_waitcnt lgkmcnt(0)
  v_exp_f32 v48, v48
  v_mfma_f32_32x32x16_bf16 v[64:79], v[116:119], v[84:87], v[64:79]
  v_exp_f32 v49, v49
  v_exp_f32 v50, v50
  v_exp_f32 v51, v51
  v_mfma_f32_32x32x16_bf16 v[32:47], v[96:99], v[8:11], v[16:31]
  ds_read_b128 v[112:115], v5 offset:51200
  v_cvt_pk_bf16_f32 v80, v48, v49
  v_exp_f32 v52, v52
  v_exp_f32 v53, v53
  v_cvt_pk_bf16_f32 v81, v50, v51
  v_mfma_f32_16x16x32_bf16 v[88:91], v[92:95], v[84:87], v[88:91]
  ds_read_b128 v[116:119], v5 offset:52224
  ds_read_b64_tr_b16 v[208:209], v2 offset:16384
  ds_read_b64_tr_b16 v[210:211], v2 offset:18432
  v_exp_f32 v54, v54
  v_exp_f32 v55, v55
  v_mfma_f32_32x32x16_bf16 v[32:47], v[100:103], v[12:15], v[32:47]
  ds_read_b128 v[104:107], v5 offset:53248
  v_cvt_pk_bf16_f32 v82, v52, v53
  v_exp_f32 v56, v56
  v_cvt_pk_bf16_f32 v83, v54, v55
  v_exp_f32 v57, v57
  ds_read_b128 v[108:111], v5 offset:54272
  ds_read_b64_tr_b16 v[212:213], v2 offset:20480
  ds_read_b64_tr_b16 v[214:215], v2 offset:22528
  v_mfma_f32_32x32x16_bf16 v[64:79], v[120:123], v[80:83], v[64:79]
  v_exp_f32 v58, v58
  v_exp_f32 v59, v59
  v_cvt_pk_bf16_f32 v84, v56, v57
  v_exp_f32 v60, v60
  v_mfma_f32_16x16x32_bf16 v[88:91], v[92:95], v[80:83], v[88:91]
  v_exp_f32 v61, v61
  v_cvt_pk_bf16_f32 v85, v58, v59
  v_exp_f32 v62, v62
  v_exp_f32 v63, v63
  v_cvt_pk_bf16_f32 v86, v60, v61
  v_cvt_pk_bf16_f32 v87, v62, v63
  s_waitcnt lgkmcnt(0)
  v_exp_f32 v32, v32
  v_mfma_f32_32x32x16_bf16 v[64:79], v[124:127], v[84:87], v[64:79]
  v_exp_f32 v33, v33
  v_exp_f32 v34, v34
  v_exp_f32 v35, v35
  v_mfma_f32_32x32x16_bf16 v[48:63], v[104:107], v[8:11], v[16:31]
  ds_read_b128 v[120:123], v5 offset:55296
  v_cvt_pk_bf16_f32 v80, v32, v33
  v_exp_f32 v36, v36
  v_exp_f32 v37, v37
  v_cvt_pk_bf16_f32 v81, v34, v35
  v_mfma_f32_16x16x32_bf16 v[88:91], v[92:95], v[84:87], v[88:91]
  ds_read_b128 v[124:127], v5 offset:56320
  v_exp_f32 v38, v38
  v_exp_f32 v39, v39
  v_mfma_f32_32x32x16_bf16 v[48:63], v[108:111], v[12:15], v[48:63]
  s_setprio 0
  ds_read_b128 v[96:99], v5 offset:57344
  v_cvt_pk_bf16_f32 v82, v36, v37
  v_exp_f32 v40, v40
  v_cvt_pk_bf16_f32 v83, v38, v39
  v_exp_f32 v41, v41
  ds_read_b128 v[100:103], v5 offset:58368
  v_mfma_f32_32x32x16_bf16 v[64:79], v[112:115], v[80:83], v[64:79]
  v_exp_f32 v42, v42
  v_exp_f32 v43, v43
  v_cvt_pk_bf16_f32 v84, v40, v41
  v_exp_f32 v44, v44
  v_mfma_f32_16x16x32_bf16 v[88:91], v[92:95], v[80:83], v[88:91]
  v_exp_f32 v45, v45
  v_cvt_pk_bf16_f32 v85, v42, v43
  v_exp_f32 v46, v46
  v_exp_f32 v47, v47
  v_cvt_pk_bf16_f32 v86, v44, v45
  v_cvt_pk_bf16_f32 v87, v46, v47
  s_waitcnt lgkmcnt(0)
  v_exp_f32 v48, v48
  v_mfma_f32_32x32x16_bf16 v[64:79], v[116:119], v[84:87], v[64:79]
  v_exp_f32 v49, v49
  v_exp_f32 v50, v50
  v_exp_f32 v51, v51
  v_mfma_f32_32x32x16_bf16 v[32:47], v[96:99], v[8:11], v[16:31]
  ds_read_b128 v[112:115], v5 offset:59392
  v_cvt_pk_bf16_f32 v80, v48, v49
  v_exp_f32 v52, v52
  v_exp_f32 v53, v53
  v_cvt_pk_bf16_f32 v81, v50, v51
  v_mfma_f32_16x16x32_bf16 v[88:91], v[92:95], v[84:87], v[88:91]
  ds_read_b128 v[116:119], v5 offset:60416
  v_exp_f32 v54, v54
  v_exp_f32 v55, v55
  v_mfma_f32_32x32x16_bf16 v[32:47], v[100:103], v[12:15], v[32:47]
  ds_read_b128 v[104:107], v5 offset:61440
  v_cvt_pk_bf16_f32 v82, v52, v53
  v_exp_f32 v56, v56
  v_cvt_pk_bf16_f32 v83, v54, v55
  v_exp_f32 v57, v57
  ds_read_b128 v[108:111], v5 offset:62464
  v_mfma_f32_32x32x16_bf16 v[64:79], v[120:123], v[80:83], v[64:79]
  v_exp_f32 v58, v58
  v_exp_f32 v59, v59
  v_cvt_pk_bf16_f32 v84, v56, v57
  v_exp_f32 v60, v60
  v_mfma_f32_16x16x32_bf16 v[88:91], v[92:95], v[80:83], v[88:91]
  v_exp_f32 v61, v61
  v_cvt_pk_bf16_f32 v85, v58, v59
  v_exp_f32 v62, v62
  v_exp_f32 v63, v63
  v_cvt_pk_bf16_f32 v86, v60, v61
  v_cvt_pk_bf16_f32 v87, v62, v63
  s_waitcnt lgkmcnt(0)
  s_barrier
  s_setprio 1
  s_add_u32 m0, s49, 2048
  s_mov_b32 s28, 16384
  buffer_load_dwordx4 v3, s[56:59], s28 offen sc1 lds
  s_add_u32 m0, s49, 3072
  s_mov_b32 s28, 24576
  buffer_load_dwordx4 v3, s[56:59], s28 offen sc1 lds
  v_exp_f32 v32, v32
  v_mfma_f32_32x32x16_bf16 v[64:79], v[124:127], v[84:87], v[64:79]
  v_exp_f32 v33, v33
  v_exp_f32 v34, v34
  v_exp_f32 v35, v35
  v_mfma_f32_32x32x16_bf16 v[48:63], v[104:107], v[8:11], v[16:31]
  ds_read_b128 v[120:123], v5 offset:63488
  v_cvt_pk_bf16_f32 v80, v32, v33
  v_exp_f32 v36, v36
  v_exp_f32 v37, v37
  v_cvt_pk_bf16_f32 v81, v34, v35
  v_mfma_f32_16x16x32_bf16 v[88:91], v[92:95], v[84:87], v[88:91]
  ds_read_b128 v[124:127], v5 offset:64512
  v_exp_f32 v38, v38
  v_exp_f32 v39, v39
  v_mfma_f32_32x32x16_bf16 v[48:63], v[108:111], v[12:15], v[48:63]
  ds_read_b128 v[96:99], v5 offset:0
  v_cvt_pk_bf16_f32 v82, v36, v37
  v_exp_f32 v40, v40
  v_cvt_pk_bf16_f32 v83, v38, v39
  v_exp_f32 v41, v41
  ds_read_b128 v[100:103], v5 offset:1024
  v_mfma_f32_32x32x16_bf16 v[64:79], v[112:115], v[80:83], v[64:79]
  v_exp_f32 v42, v42
  v_exp_f32 v43, v43
  v_cvt_pk_bf16_f32 v84, v40, v41
  v_exp_f32 v44, v44
  v_mfma_f32_16x16x32_bf16 v[88:91], v[92:95], v[80:83], v[88:91]
  v_exp_f32 v45, v45
  v_cvt_pk_bf16_f32 v85, v42, v43
  v_exp_f32 v46, v46
  v_exp_f32 v47, v47
  v_cvt_pk_bf16_f32 v86, v44, v45
  v_cvt_pk_bf16_f32 v87, v46, v47
  s_waitcnt lgkmcnt(0)
  v_exp_f32 v48, v48
  v_mfma_f32_32x32x16_bf16 v[64:79], v[116:119], v[84:87], v[64:79]
  v_exp_f32 v49, v49
  v_exp_f32 v50, v50
  v_exp_f32 v51, v51
  v_mfma_f32_32x32x16_bf16 v[32:47], v[96:99], v[8:11], v[16:31]
  ds_read_b128 v[112:115], v5 offset:2048
  v_cvt_pk_bf16_f32 v80, v48, v49
  v_exp_f32 v52, v52
  v_exp_f32 v53, v53
  v_cvt_pk_bf16_f32 v81, v50, v51
  v_mfma_f32_16x16x32_bf16 v[88:91], v[92:95], v[84:87], v[88:91]
  ds_read_b128 v[116:119], v5 offset:3072
  ds_read_b64_tr_b16 v[216:217], v2 offset:32768
  ds_read_b64_tr_b16 v[218:219], v2 offset:34816
  v_exp_f32 v54, v54
  v_exp_f32 v55, v55
  v_mfma_f32_32x32x16_bf16 v[32:47], v[100:103], v[12:15], v[32:47]
  ds_read_b128 v[104:107], v5 offset:4096
  v_cvt_pk_bf16_f32 v82, v52, v53
  v_exp_f32 v56, v56
  v_cvt_pk_bf16_f32 v83, v54, v55
  v_exp_f32 v57, v57
  ds_read_b128 v[108:111], v5 offset:5120
  ds_read_b64_tr_b16 v[220:221], v2 offset:36864
  ds_read_b64_tr_b16 v[222:223], v2 offset:38912
  v_mfma_f32_32x32x16_bf16 v[64:79], v[120:123], v[80:83], v[64:79]
  v_exp_f32 v58, v58
  v_exp_f32 v59, v59
  v_cvt_pk_bf16_f32 v84, v56, v57
  v_exp_f32 v60, v60
  v_mfma_f32_16x16x32_bf16 v[88:91], v[92:95], v[80:83], v[88:91]
  v_exp_f32 v61, v61
  v_cvt_pk_bf16_f32 v85, v58, v59
  v_exp_f32 v62, v62
  v_exp_f32 v63, v63
  v_cvt_pk_bf16_f32 v86, v60, v61
  v_cvt_pk_bf16_f32 v87, v62, v63
  s_waitcnt lgkmcnt(0)
  v_exp_f32 v32, v32
  v_mfma_f32_32x32x16_bf16 v[64:79], v[124:127], v[84:87], v[64:79]
  v_exp_f32 v33, v33
  v_exp_f32 v34, v34
  v_exp_f32 v35, v35
  v_mfma_f32_32x32x16_bf16 v[48:63], v[104:107], v[8:11], v[16:31]
  ds_read_b128 v[120:123], v5 offset:6144
  v_cvt_pk_bf16_f32 v80, v32, v33
  v_exp_f32 v36, v36
  v_exp_f32 v37, v37
  v_cvt_pk_bf16_f32 v81, v34, v35
  v_mfma_f32_16x16x32_bf16 v[88:91], v[92:95], v[84:87], v[88:91]
  ds_read_b128 v[124:127], v5 offset:7168
  v_exp_f32 v38, v38
  v_exp_f32 v39, v39
  v_mfma_f32_32x32x16_bf16 v[48:63], v[108:111], v[12:15], v[48:63]
  s_setprio 0
  ds_read_b128 v[96:99], v5 offset:8192
  v_cvt_pk_bf16_f32 v82, v36, v37
  v_exp_f32 v40, v40
  v_cvt_pk_bf16_f32 v83, v38, v39
  v_exp_f32 v41, v41
  ds_read_b128 v[100:103], v5 offset:9216
  v_mfma_f32_32x32x16_bf16 v[64:79], v[112:115], v[80:83], v[64:79]
  v_exp_f32 v42, v42
  v_exp_f32 v43, v43
  v_cvt_pk_bf16_f32 v84, v40, v41
  v_exp_f32 v44, v44
  v_mfma_f32_16x16x32_bf16 v[88:91], v[92:95], v[80:83], v[88:91]
  v_exp_f32 v45, v45
  v_cvt_pk_bf16_f32 v85, v42, v43
  v_exp_f32 v46, v46
  v_exp_f32 v47, v47
  v_cvt_pk_bf16_f32 v86, v44, v45
  v_cvt_pk_bf16_f32 v87, v46, v47
  s_waitcnt lgkmcnt(0)
  v_exp_f32 v48, v48
  v_mfma_f32_32x32x16_bf16 v[64:79], v[116:119], v[84:87], v[64:79]
  v_exp_f32 v49, v49
  v_exp_f32 v50, v50
  v_exp_f32 v51, v51
  v_mfma_f32_32x32x16_bf16 v[32:47], v[96:99], v[8:11], v[16:31]
  ds_read_b128 v[112:115], v5 offset:10240
  v_cvt_pk_bf16_f32 v80, v48, v49
  v_exp_f32 v52, v52
  v_exp_f32 v53, v53
  v_cvt_pk_bf16_f32 v81, v50, v51
  v_mfma_f32_16x16x32_bf16 v[88:91], v[92:95], v[84:87], v[88:91]
  ds_read_b128 v[116:119], v5 offset:11264
  v_exp_f32 v54, v54
  v_exp_f32 v55, v55
  v_mfma_f32_32x32x16_bf16 v[32:47], v[100:103], v[12:15], v[32:47]
  ds_read_b128 v[104:107], v5 offset:12288
  v_cvt_pk_bf16_f32 v82, v52, v53
  v_exp_f32 v56, v56
  v_cvt_pk_bf16_f32 v83, v54, v55
  v_exp_f32 v57, v57
  ds_read_b128 v[108:111], v5 offset:13312
  v_mfma_f32_32x32x16_bf16 v[64:79], v[120:123], v[80:83], v[64:79]
  v_exp_f32 v58, v58
  v_exp_f32 v59, v59
  v_cvt_pk_bf16_f32 v84, v56, v57
  v_exp_f32 v60, v60
  v_mfma_f32_16x16x32_bf16 v[88:91], v[92:95], v[80:83], v[88:91]
  v_exp_f32 v61, v61
  v_cvt_pk_bf16_f32 v85, v58, v59
  v_exp_f32 v62, v62
  v_exp_f32 v63, v63
  v_cvt_pk_bf16_f32 v86, v60, v61
  v_cvt_pk_bf16_f32 v87, v62, v63
  s_waitcnt lgkmcnt(0)
  s_barrier
  s_setprio 1
  s_add_u32 m0, s49, 4096
  s_mov_b32 s28, 32768
  buffer_load_dwordx4 v3, s[56:59], s28 offen sc1 lds
  s_add_u32 m0, s49, 5120
  s_mov_b32 s28, 40960
  buffer_load_dwordx4 v3, s[56:59], s28 offen sc1 lds
  v_exp_f32 v32, v32
  v_mfma_f32_32x32x16_bf16 v[64:79], v[124:127], v[84:87], v[64:79]
  v_exp_f32 v33, v33
  v_exp_f32 v34, v34
  v_exp_f32 v35, v35
  v_mfma_f32_32x32x16_bf16 v[48:63], v[104:107], v[8:11], v[16:31]
  ds_read_b128 v[120:123], v5 offset:14336
  v_cvt_pk_bf16_f32 v80, v32, v33
  v_exp_f32 v36, v36
  v_exp_f32 v37, v37
  v_cvt_pk_bf16_f32 v81, v34, v35
  v_mfma_f32_16x16x32_bf16 v[88:91], v[92:95], v[84:87], v[88:91]
  ds_read_b128 v[124:127], v5 offset:15360
  v_exp_f32 v38, v38
  v_exp_f32 v39, v39
  v_mfma_f32_32x32x16_bf16 v[48:63], v[108:111], v[12:15], v[48:63]
  ds_read_b128 v[96:99], v5 offset:16384
  v_cvt_pk_bf16_f32 v82, v36, v37
  v_exp_f32 v40, v40
  v_cvt_pk_bf16_f32 v83, v38, v39
  v_exp_f32 v41, v41
  ds_read_b128 v[100:103], v5 offset:17408
  v_mfma_f32_32x32x16_bf16 v[64:79], v[112:115], v[80:83], v[64:79]
  v_exp_f32 v42, v42
  v_exp_f32 v43, v43
  v_cvt_pk_bf16_f32 v84, v40, v41
  v_exp_f32 v44, v44
  v_mfma_f32_16x16x32_bf16 v[88:91], v[92:95], v[80:83], v[88:91]
  v_exp_f32 v45, v45
  v_cvt_pk_bf16_f32 v85, v42, v43
  v_exp_f32 v46, v46
  v_exp_f32 v47, v47
  v_cvt_pk_bf16_f32 v86, v44, v45
  v_cvt_pk_bf16_f32 v87, v46, v47
  s_waitcnt lgkmcnt(0)
  v_exp_f32 v48, v48
  v_mfma_f32_32x32x16_bf16 v[64:79], v[116:119], v[84:87], v[64:79]
  v_exp_f32 v49, v49
  v_exp_f32 v50, v50
  v_exp_f32 v51, v51
  v_mfma_f32_32x32x16_bf16 v[32:47], v[96:99], v[8:11], v[16:31]
  ds_read_b128 v[112:115], v5 offset:18432
  v_cvt_pk_bf16_f32 v80, v48, v49
  v_exp_f32 v52, v52
  v_exp_f32 v53, v53
  v_cvt_pk_bf16_f32 v81, v50, v51
  v_mfma_f32_16x16x32_bf16 v[88:91], v[92:95], v[84:87], v[88:91]
  ds_read_b128 v[116:119], v5 offset:19456
  ds_read_b64_tr_b16 v[224:225], v2 offset:0
  ds_read_b64_tr_b16 v[226:227], v2 offset:2048
  v_exp_f32 v54, v54
  v_exp_f32 v55, v55
  v_mfma_f32_32x32x16_bf16 v[32:47], v[100:103], v[12:15], v[32:47]
  ds_read_b128 v[104:107], v5 offset:20480
  v_cvt_pk_bf16_f32 v82, v52, v53
  v_exp_f32 v56, v56
  v_cvt_pk_bf16_f32 v83, v54, v55
  v_exp_f32 v57, v57
  ds_read_b128 v[108:111], v5 offset:21504
  ds_read_b64_tr_b16 v[228:229], v2 offset:4096
  ds_read_b64_tr_b16 v[230:231], v2 offset:6144
  v_mfma_f32_32x32x16_bf16 v[64:79], v[120:123], v[80:83], v[64:79]
  v_exp_f32 v58, v58
  v_exp_f32 v59, v59
  v_cvt_pk_bf16_f32 v84, v56, v57
  v_exp_f32 v60, v60
  v_mfma_f32_16x16x32_bf16 v[88:91], v[92:95], v[80:83], v[88:91]
  v_exp_f32 v61, v61
  v_cvt_pk_bf16_f32 v85, v58, v59
  v_exp_f32 v62, v62
  v_exp_f32 v63, v63
  v_cvt_pk_bf16_f32 v86, v60, v61
  v_cvt_pk_bf16_f32 v87, v62, v63
  s_waitcnt lgkmcnt(0)
  v_exp_f32 v32, v32
  v_mfma_f32_32x32x16_bf16 v[64:79], v[124:127], v[84:87], v[64:79]
  v_exp_f32 v33, v33
  v_exp_f32 v34, v34
  v_exp_f32 v35, v35
  v_mfma_f32_32x32x16_bf16 v[48:63], v[104:107], v[8:11], v[16:31]
  ds_read_b128 v[120:123], v5 offset:22528
  v_cvt_pk_bf16_f32 v80, v32, v33
  v_exp_f32 v36, v36
  v_exp_f32 v37, v37
  v_cvt_pk_bf16_f32 v81, v34, v35
  v_mfma_f32_16x16x32_bf16 v[88:91], v[92:95], v[84:87], v[88:91]
  ds_read_b128 v[124:127], v5 offset:23552
  v_exp_f32 v38, v38
  v_exp_f32 v39, v39
  v_mfma_f32_32x32x16_bf16 v[48:63], v[108:111], v[12:15], v[48:63]
  s_setprio 0
  ds_read_b128 v[96:99], v5 offset:24576
  v_cvt_pk_bf16_f32 v82, v36, v37
  v_exp_f32 v40, v40
  v_cvt_pk_bf16_f32 v83, v38, v39
  v_exp_f32 v41, v41
  ds_read_b128 v[100:103], v5 offset:25600
  v_mfma_f32_32x32x16_bf16 v[64:79], v[112:115], v[80:83], v[64:79]
  v_exp_f32 v42, v42
  v_exp_f32 v43, v43
  v_cvt_pk_bf16_f32 v84, v40, v41
  v_exp_f32 v44, v44
  v_mfma_f32_16x16x32_bf16 v[88:91], v[92:95], v[80:83], v[88:91]
  v_exp_f32 v45, v45
  v_cvt_pk_bf16_f32 v85, v42, v43
  v_exp_f32 v46, v46
  v_exp_f32 v47, v47
  v_cvt_pk_bf16_f32 v86, v44, v45
  v_cvt_pk_bf16_f32 v87, v46, v47
  s_waitcnt lgkmcnt(0)
  v_exp_f32 v48, v48
  v_mfma_f32_32x32x16_bf16 v[64:79], v[116:119], v[84:87], v[64:79]
  v_exp_f32 v49, v49
  v_exp_f32 v50, v50
  v_exp_f32 v51, v51
  v_mfma_f32_32x32x16_bf16 v[32:47], v[96:99], v[8:11], v[16:31]
  ds_read_b128 v[112:115], v5 offset:26624
  v_cvt_pk_bf16_f32 v80, v48, v49
  v_exp_f32 v52, v52
  v_exp_f32 v53, v53
  v_cvt_pk_bf16_f32 v81, v50, v51
  v_mfma_f32_16x16x32_bf16 v[88:91], v[92:95], v[84:87], v[88:91]
  ds_read_b128 v[116:119], v5 offset:27648
  v_exp_f32 v54, v54
  v_exp_f32 v55, v55
  v_mfma_f32_32x32x16_bf16 v[32:47], v[100:103], v[12:15], v[32:47]
  ds_read_b128 v[104:107], v5 offset:28672
  v_cvt_pk_bf16_f32 v82, v52, v53
  v_exp_f32 v56, v56
  v_cvt_pk_bf16_f32 v83, v54, v55
  v_exp_f32 v57, v57
  ds_read_b128 v[108:111], v5 offset:29696
  v_mfma_f32_32x32x16_bf16 v[64:79], v[120:123], v[80:83], v[64:79]
  v_exp_f32 v58, v58
  v_exp_f32 v59, v59
  v_cvt_pk_bf16_f32 v84, v56, v57
  v_exp_f32 v60, v60
  v_mfma_f32_16x16x32_bf16 v[88:91], v[92:95], v[80:83], v[88:91]
  v_exp_f32 v61, v61
  v_cvt_pk_bf16_f32 v85, v58, v59
  v_exp_f32 v62, v62
  v_exp_f32 v63, v63
  v_cvt_pk_bf16_f32 v86, v60, v61
  v_cvt_pk_bf16_f32 v87, v62, v63
  s_waitcnt lgkmcnt(0)
  s_barrier
  s_setprio 1
  s_add_u32 m0, s49, 6144
  s_mov_b32 s28, 49152
  buffer_load_dwordx4 v3, s[56:59], s28 offen sc1 lds
  s_add_u32 m0, s49, 7168
  s_mov_b32 s28, 57344
  buffer_load_dwordx4 v3, s[56:59], s28 offen sc1 lds
  v_exp_f32 v32, v32
  v_mfma_f32_32x32x16_bf16 v[64:79], v[124:127], v[84:87], v[64:79]
  v_exp_f32 v33, v33
  v_exp_f32 v34, v34
  v_exp_f32 v35, v35
  v_mfma_f32_32x32x16_bf16 v[48:63], v[104:107], v[8:11], v[16:31]
  ds_read_b128 v[120:123], v5 offset:30720
  v_cvt_pk_bf16_f32 v80, v32, v33
  v_exp_f32 v36, v36
  v_exp_f32 v37, v37
  v_cvt_pk_bf16_f32 v81, v34, v35
  v_mfma_f32_16x16x32_bf16 v[88:91], v[92:95], v[84:87], v[88:91]
  ds_read_b128 v[124:127], v5 offset:31744
  v_exp_f32 v38, v38
  v_exp_f32 v39, v39
  v_mfma_f32_32x32x16_bf16 v[48:63], v[108:111], v[12:15], v[48:63]
  ds_read_b128 v[96:99], v5 offset:32768
  v_cvt_pk_bf16_f32 v82, v36, v37
  v_exp_f32 v40, v40
  v_cvt_pk_bf16_f32 v83, v38, v39
  v_exp_f32 v41, v41
  ds_read_b128 v[100:103], v5 offset:33792
  v_mfma_f32_32x32x16_bf16 v[64:79], v[112:115], v[80:83], v[64:79]
  v_exp_f32 v42, v42
  v_exp_f32 v43, v43
  v_cvt_pk_bf16_f32 v84, v40, v41
  v_exp_f32 v44, v44
  v_mfma_f32_16x16x32_bf16 v[88:91], v[92:95], v[80:83], v[88:91]
  v_exp_f32 v45, v45
  v_cvt_pk_bf16_f32 v85, v42, v43
  v_exp_f32 v46, v46
  v_exp_f32 v47, v47
  v_cvt_pk_bf16_f32 v86, v44, v45
  v_cvt_pk_bf16_f32 v87, v46, v47
  s_waitcnt lgkmcnt(0)
  v_exp_f32 v48, v48
  v_mfma_f32_32x32x16_bf16 v[64:79], v[116:119], v[84:87], v[64:79]
  v_exp_f32 v49, v49
  v_exp_f32 v50, v50
  v_exp_f32 v51, v51
  v_mfma_f32_32x32x16_bf16 v[32:47], v[96:99], v[8:11], v[16:31]
  ds_read_b128 v[112:115], v5 offset:34816
  v_cvt_pk_bf16_f32 v80, v48, v49
  v_exp_f32 v52, v52
  v_exp_f32 v53, v53
  v_cvt_pk_bf16_f32 v81, v50, v51
  v_mfma_f32_16x16x32_bf16 v[88:91], v[92:95], v[84:87], v[88:91]
  ds_read_b128 v[116:119], v5 offset:35840
  ds_read_b64_tr_b16 v[232:233], v2 offset:16384
  ds_read_b64_tr_b16 v[234:235], v2 offset:18432
  v_exp_f32 v54, v54
  v_exp_f32 v55, v55
  v_mfma_f32_32x32x16_bf16 v[32:47], v[100:103], v[12:15], v[32:47]
  ds_read_b128 v[104:107], v5 offset:36864
  v_cvt_pk_bf16_f32 v82, v52, v53
  v_exp_f32 v56, v56
  v_cvt_pk_bf16_f32 v83, v54, v55
  v_exp_f32 v57, v57
  ds_read_b128 v[108:111], v5 offset:37888
  ds_read_b64_tr_b16 v[236:237], v2 offset:20480
  ds_read_b64_tr_b16 v[238:239], v2 offset:22528
  v_mfma_f32_32x32x16_bf16 v[64:79], v[120:123], v[80:83], v[64:79]
  v_exp_f32 v58, v58
  v_exp_f32 v59, v59
  v_cvt_pk_bf16_f32 v84, v56, v57
  v_exp_f32 v60, v60
  v_mfma_f32_16x16x32_bf16 v[88:91], v[92:95], v[80:83], v[88:91]
  v_exp_f32 v61, v61
  v_cvt_pk_bf16_f32 v85, v58, v59
  v_exp_f32 v62, v62
  v_exp_f32 v63, v63
  v_cvt_pk_bf16_f32 v86, v60, v61
  v_cvt_pk_bf16_f32 v87, v62, v63
  s_waitcnt lgkmcnt(0)
  v_exp_f32 v32, v32
  v_mfma_f32_32x32x16_bf16 v[64:79], v[124:127], v[84:87], v[64:79]
  v_exp_f32 v33, v33
  v_exp_f32 v34, v34
  v_exp_f32 v35, v35
  v_mfma_f32_32x32x16_bf16 v[48:63], v[104:107], v[8:11], v[16:31]
  ds_read_b128 v[120:123], v5 offset:38912
  v_cvt_pk_bf16_f32 v80, v32, v33
  v_exp_f32 v36, v36
  v_exp_f32 v37, v37
  v_cvt_pk_bf16_f32 v81, v34, v35
  v_mfma_f32_16x16x32_bf16 v[88:91], v[92:95], v[84:87], v[88:91]
  ds_read_b128 v[124:127], v5 offset:39936
  v_exp_f32 v38, v38
  v_exp_f32 v39, v39
  v_mfma_f32_32x32x16_bf16 v[48:63], v[108:111], v[12:15], v[48:63]
  s_setprio 0
  ds_read_b128 v[96:99], v5 offset:40960
  v_cvt_pk_bf16_f32 v82, v36, v37
  v_exp_f32 v40, v40
  v_cvt_pk_bf16_f32 v83, v38, v39
  v_exp_f32 v41, v41
  ds_read_b128 v[100:103], v5 offset:41984
  v_mfma_f32_32x32x16_bf16 v[64:79], v[112:115], v[80:83], v[64:79]
  v_exp_f32 v42, v42
  v_exp_f32 v43, v43
  v_cvt_pk_bf16_f32 v84, v40, v41
  v_exp_f32 v44, v44
  v_mfma_f32_16x16x32_bf16 v[88:91], v[92:95], v[80:83], v[88:91]
  v_exp_f32 v45, v45
  v_cvt_pk_bf16_f32 v85, v42, v43
  v_exp_f32 v46, v46
  v_exp_f32 v47, v47
  v_cvt_pk_bf16_f32 v86, v44, v45
  v_cvt_pk_bf16_f32 v87, v46, v47
  s_waitcnt lgkmcnt(0)
  v_exp_f32 v48, v48
  v_mfma_f32_32x32x16_bf16 v[64:79], v[116:119], v[84:87], v[64:79]
  v_exp_f32 v49, v49
  v_exp_f32 v50, v50
  v_exp_f32 v51, v51
  v_mfma_f32_32x32x16_bf16 v[32:47], v[96:99], v[8:11], v[16:31]
  ds_read_b128 v[112:115], v5 offset:43008
  v_cvt_pk_bf16_f32 v80, v48, v49
  v_exp_f32 v52, v52
  v_exp_f32 v53, v53
  v_cvt_pk_bf16_f32 v81, v50, v51
  v_mfma_f32_16x16x32_bf16 v[88:91], v[92:95], v[84:87], v[88:91]
  ds_read_b128 v[116:119], v5 offset:44032
  v_exp_f32 v54, v54
  v_exp_f32 v55, v55
  v_mfma_f32_32x32x16_bf16 v[32:47], v[100:103], v[12:15], v[32:47]
  ds_read_b128 v[104:107], v5 offset:45056
  v_cvt_pk_bf16_f32 v82, v52, v53
  v_exp_f32 v56, v56
  v_cvt_pk_bf16_f32 v83, v54, v55
  v_exp_f32 v57, v57
  ds_read_b128 v[108:111], v5 offset:46080
  v_mfma_f32_32x32x16_bf16 v[64:79], v[120:123], v[80:83], v[64:79]
  v_exp_f32 v58, v58
  v_exp_f32 v59, v59
  v_cvt_pk_bf16_f32 v84, v56, v57
  v_exp_f32 v60, v60
  v_mfma_f32_16x16x32_bf16 v[88:91], v[92:95], v[80:83], v[88:91]
  v_exp_f32 v61, v61
  v_cvt_pk_bf16_f32 v85, v58, v59
  v_exp_f32 v62, v62
  v_exp_f32 v63, v63
  v_cvt_pk_bf16_f32 v86, v60, v61
  v_cvt_pk_bf16_f32 v87, v62, v63
  s_waitcnt lgkmcnt(0)
  s_barrier
  s_setprio 1
  v_exp_f32 v32, v32
  v_mfma_f32_32x32x16_bf16 v[64:79], v[124:127], v[84:87], v[64:79]
  v_exp_f32 v33, v33
  v_exp_f32 v34, v34
  v_exp_f32 v35, v35
  v_mfma_f32_32x32x16_bf16 v[48:63], v[104:107], v[8:11], v[16:31]
  ds_read_b128 v[120:123], v5 offset:47104
  v_cvt_pk_bf16_f32 v80, v32, v33
  v_exp_f32 v36, v36
  v_exp_f32 v37, v37
  v_cvt_pk_bf16_f32 v81, v34, v35
  v_mfma_f32_16x16x32_bf16 v[88:91], v[92:95], v[84:87], v[88:91]
  ds_read_b128 v[124:127], v5 offset:48128
  v_exp_f32 v38, v38
  v_exp_f32 v39, v39
  v_mfma_f32_32x32x16_bf16 v[48:63], v[108:111], v[12:15], v[48:63]
  ds_read_b128 v[96:99], v5 offset:49152
  v_cvt_pk_bf16_f32 v82, v36, v37
  v_exp_f32 v40, v40
  v_cvt_pk_bf16_f32 v83, v38, v39
  v_exp_f32 v41, v41
  ds_read_b128 v[100:103], v5 offset:50176
  v_mfma_f32_32x32x16_bf16 v[64:79], v[112:115], v[80:83], v[64:79]
  v_exp_f32 v42, v42
  v_exp_f32 v43, v43
  v_cvt_pk_bf16_f32 v84, v40, v41
  v_exp_f32 v44, v44
  v_mfma_f32_16x16x32_bf16 v[88:91], v[92:95], v[80:83], v[88:91]
  v_exp_f32 v45, v45
  v_cvt_pk_bf16_f32 v85, v42, v43
  v_exp_f32 v46, v46
  v_exp_f32 v47, v47
  v_cvt_pk_bf16_f32 v86, v44, v45
  v_cvt_pk_bf16_f32 v87, v46, v47
  s_waitcnt lgkmcnt(0)
  v_exp_f32 v48, v48
  v_mfma_f32_32x32x16_bf16 v[64:79], v[116:119], v[84:87], v[64:79]
  v_exp_f32 v49, v49
  v_exp_f32 v50, v50
  v_exp_f32 v51, v51
  v_mfma_f32_32x32x16_bf16 v[32:47], v[96:99], v[8:11], v[16:31]
  ds_read_b128 v[112:115], v5 offset:51200
  v_cvt_pk_bf16_f32 v80, v48, v49
  v_exp_f32 v52, v52
  v_exp_f32 v53, v53
  v_cvt_pk_bf16_f32 v81, v50, v51
  v_mfma_f32_16x16x32_bf16 v[88:91], v[92:95], v[84:87], v[88:91]
  ds_read_b128 v[116:119], v5 offset:52224
  ds_read_b64_tr_b16 v[240:241], v2 offset:32768
  ds_read_b64_tr_b16 v[242:243], v2 offset:34816
  v_exp_f32 v54, v54
  v_exp_f32 v55, v55
  v_mfma_f32_32x32x16_bf16 v[32:47], v[100:103], v[12:15], v[32:47]
  ds_read_b128 v[104:107], v5 offset:53248
  v_cvt_pk_bf16_f32 v82, v52, v53
  v_exp_f32 v56, v56
  v_cvt_pk_bf16_f32 v83, v54, v55
  v_exp_f32 v57, v57
  ds_read_b128 v[108:111], v5 offset:54272
  ds_read_b64_tr_b16 v[244:245], v2 offset:36864
  ds_read_b64_tr_b16 v[246:247], v2 offset:38912
  v_mfma_f32_32x32x16_bf16 v[64:79], v[120:123], v[80:83], v[64:79]
  v_exp_f32 v58, v58
  v_exp_f32 v59, v59
  v_cvt_pk_bf16_f32 v84, v56, v57
  v_exp_f32 v60, v60
  v_mfma_f32_16x16x32_bf16 v[88:91], v[92:95], v[80:83], v[88:91]
  v_exp_f32 v61, v61
  v_cvt_pk_bf16_f32 v85, v58, v59
  v_exp_f32 v62, v62
  v_exp_f32 v63, v63
  v_cvt_pk_bf16_f32 v86, v60, v61
  v_cvt_pk_bf16_f32 v87, v62, v63
  s_waitcnt lgkmcnt(0)
  v_exp_f32 v32, v32
  v_mfma_f32_32x32x16_bf16 v[64:79], v[124:127], v[84:87], v[64:79]
  v_exp_f32 v33, v33
  v_exp_f32 v34, v34
  v_exp_f32 v35, v35
  v_mfma_f32_32x32x16_bf16 v[48:63], v[104:107], v[8:11], v[16:31]
  ds_read_b128 v[120:123], v5 offset:55296
  v_cvt_pk_bf16_f32 v80, v32, v33
  v_exp_f32 v36, v36
  v_exp_f32 v37, v37
  v_cvt_pk_bf16_f32 v81, v34, v35
  v_mfma_f32_16x16x32_bf16 v[88:91], v[92:95], v[84:87], v[88:91]
  ds_read_b128 v[124:127], v5 offset:56320
  v_exp_f32 v38, v38
  v_exp_f32 v39, v39
  v_mfma_f32_32x32x16_bf16 v[48:63], v[108:111], v[12:15], v[48:63]
  s_setprio 0
  ds_read_b128 v[96:99], v5 offset:57344
  v_cvt_pk_bf16_f32 v82, v36, v37
  v_exp_f32 v40, v40
  v_cvt_pk_bf16_f32 v83, v38, v39
  v_exp_f32 v41, v41
  ds_read_b128 v[100:103], v5 offset:58368
  v_mfma_f32_32x32x16_bf16 v[64:79], v[112:115], v[80:83], v[64:79]
  v_exp_f32 v42, v42
  v_exp_f32 v43, v43
  v_cvt_pk_bf16_f32 v84, v40, v41
  v_exp_f32 v44, v44
  v_mfma_f32_16x16x32_bf16 v[88:91], v[92:95], v[80:83], v[88:91]
  v_exp_f32 v45, v45
  v_cvt_pk_bf16_f32 v85, v42, v43
  v_exp_f32 v46, v46
  v_exp_f32 v47, v47
  v_cvt_pk_bf16_f32 v86, v44, v45
  v_cvt_pk_bf16_f32 v87, v46, v47
  s_waitcnt lgkmcnt(0)
  v_exp_f32 v48, v48
  v_mfma_f32_32x32x16_bf16 v[64:79], v[116:119], v[84:87], v[64:79]
  v_exp_f32 v49, v49
  v_exp_f32 v50, v50
  v_exp_f32 v51, v51
  v_mfma_f32_32x32x16_bf16 v[32:47], v[96:99], v[8:11], v[16:31]
  ds_read_b128 v[112:115], v5 offset:59392
  v_cvt_pk_bf16_f32 v80, v48, v49
  v_exp_f32 v52, v52
  v_exp_f32 v53, v53
  v_cvt_pk_bf16_f32 v81, v50, v51
  v_mfma_f32_16x16x32_bf16 v[88:91], v[92:95], v[84:87], v[88:91]
  ds_read_b128 v[116:119], v5 offset:60416
  v_exp_f32 v54, v54
  v_exp_f32 v55, v55
  v_mfma_f32_32x32x16_bf16 v[32:47], v[100:103], v[12:15], v[32:47]
  ds_read_b128 v[104:107], v5 offset:61440
  v_cvt_pk_bf16_f32 v82, v52, v53
  v_exp_f32 v56, v56
  v_cvt_pk_bf16_f32 v83, v54, v55
  v_exp_f32 v57, v57
  ds_read_b128 v[108:111], v5 offset:62464
  v_mfma_f32_32x32x16_bf16 v[64:79], v[120:123], v[80:83], v[64:79]
  v_exp_f32 v58, v58
  v_exp_f32 v59, v59
  v_cvt_pk_bf16_f32 v84, v56, v57
  v_exp_f32 v60, v60
  v_mfma_f32_16x16x32_bf16 v[88:91], v[92:95], v[80:83], v[88:91]
  v_exp_f32 v61, v61
  v_cvt_pk_bf16_f32 v85, v58, v59
  v_exp_f32 v62, v62
  v_exp_f32 v63, v63
  v_cvt_pk_bf16_f32 v86, v60, v61
  v_cvt_pk_bf16_f32 v87, v62, v63
  s_waitcnt lgkmcnt(0)
  s_waitcnt vmcnt(0)
  s_barrier
  s_setprio 1
  v_exp_f32 v32, v32
  v_mfma_f32_32x32x16_bf16 v[64:79], v[124:127], v[84:87], v[64:79]
  v_exp_f32 v33, v33
  v_exp_f32 v34, v34
  v_exp_f32 v35, v35
  v_mfma_f32_32x32x16_bf16 v[48:63], v[104:107], v[8:11], v[16:31]
  ds_read_b128 v[120:123], v5 offset:63488
  v_cvt_pk_bf16_f32 v80, v32, v33
  v_exp_f32 v36, v36
  v_exp_f32 v37, v37
  v_cvt_pk_bf16_f32 v81, v34, v35
  v_mfma_f32_16x16x32_bf16 v[88:91], v[92:95], v[84:87], v[88:91]
  ds_read_b128 v[124:127], v5 offset:64512
  v_exp_f32 v38, v38
  v_exp_f32 v39, v39
  v_mfma_f32_32x32x16_bf16 v[48:63], v[108:111], v[12:15], v[48:63]
  s_nop 0
  v_cvt_pk_bf16_f32 v82, v36, v37
  v_exp_f32 v40, v40
  v_cvt_pk_bf16_f32 v83, v38, v39
  v_exp_f32 v41, v41
  s_nop 0
  v_mfma_f32_32x32x16_bf16 v[64:79], v[112:115], v[80:83], v[64:79]
  v_exp_f32 v42, v42
  v_exp_f32 v43, v43
  v_cvt_pk_bf16_f32 v84, v40, v41
  v_exp_f32 v44, v44
  v_mfma_f32_16x16x32_bf16 v[88:91], v[92:95], v[80:83], v[88:91]
  v_exp_f32 v45, v45
  v_cvt_pk_bf16_f32 v85, v42, v43
  v_exp_f32 v46, v46
  v_exp_f32 v47, v47
  v_cvt_pk_bf16_f32 v86, v44, v45
  v_cvt_pk_bf16_f32 v87, v46, v47
  s_waitcnt lgkmcnt(0)
  v_exp_f32 v48, v48
  v_mfma_f32_32x32x16_bf16 v[64:79], v[116:119], v[84:87], v[64:79]
  v_exp_f32 v49, v49
  v_exp_f32 v50, v50
  v_exp_f32 v51, v51
  s_nop 0
  s_nop 0
  v_cvt_pk_bf16_f32 v80, v48, v49
  v_exp_f32 v52, v52
  v_exp_f32 v53, v53
  v_cvt_pk_bf16_f32 v81, v50, v51
  v_mfma_f32_16x16x32_bf16 v[88:91], v[92:95], v[84:87], v[88:91]
  s_nop 0
  ds_read_b64_tr_b16 v[248:249], v2 offset:0
  ds_read_b64_tr_b16 v[250:251], v2 offset:2048
  v_exp_f32 v54, v54
  v_exp_f32 v55, v55
  s_nop 0
  s_nop 0
  v_cvt_pk_bf16_f32 v82, v52, v53
  v_exp_f32 v56, v56
  v_cvt_pk_bf16_f32 v83, v54, v55
  v_exp_f32 v57, v57
  s_nop 0
  ds_read_b64_tr_b16 v[252:253], v2 offset:4096
  ds_read_b64_tr_b16 v[254:255], v2 offset:6144
  v_mfma_f32_32x32x16_bf16 v[64:79], v[120:123], v[80:83], v[64:79]
  v_exp_f32 v58, v58
  v_exp_f32 v59, v59
  v_cvt_pk_bf16_f32 v84, v56, v57
  v_exp_f32 v60, v60
  v_mfma_f32_16x16x32_bf16 v[88:91], v[92:95], v[80:83], v[88:91]
  v_exp_f32 v61, v61
  v_cvt_pk_bf16_f32 v85, v58, v59
  v_exp_f32 v62, v62
  v_exp_f32 v63, v63
  v_cvt_pk_bf16_f32 v86, v60, v61
  v_cvt_pk_bf16_f32 v87, v62, v63
  s_branch concat_heads__mha_block__spectral_fnet__prompt_kernel_tail
concat_heads__mha_block__spectral_fnet__prompt_kernel_nozs0:
  buffer_load_dword v250, off, s[92:95], 0
  buffer_load_dword v250, off, s[92:95], 0
  buffer_load_dword v250, off, s[92:95], 0
  buffer_load_dword v250, off, s[92:95], 0
  s_branch concat_heads__mha_block__spectral_fnet__prompt_kernel_nozs0b
concat_heads__mha_block__spectral_fnet__prompt_kernel_nozs1:
  buffer_load_dword v250, off, s[92:95], 0
  buffer_load_dword v250, off, s[92:95], 0
  buffer_load_dword v250, off, s[92:95], 0
  buffer_load_dword v250, off, s[92:95], 0
  s_branch concat_heads__mha_block__spectral_fnet__prompt_kernel_nozs1b
concat_heads__mha_block__spectral_fnet__prompt_kernel_nosf0:
  buffer_load_dword v250, off, s[92:95], 0
  buffer_load_dword v250, off, s[92:95], 0
  s_branch concat_heads__mha_block__spectral_fnet__prompt_kernel_nosf0b
concat_heads__mha_block__spectral_fnet__prompt_kernel_nosf1:
  buffer_load_dword v250, off, s[92:95], 0
  buffer_load_dword v250, off, s[92:95], 0
  s_branch concat_heads__mha_block__spectral_fnet__prompt_kernel_nosf1b
concat_heads__mha_block__spectral_fnet__prompt_kernel_zspin:
  s_add_u32 s34, s34, 1
  s_cmp_ge_u32 s34, 0x20000
  s_cbranch_scc1 concat_heads__mha_block__spectral_fnet__prompt_kernel_zok
  buffer_load_dword v250, v252, s[92:95], 0 offen sc1
  buffer_load_dword v251, v253, s[92:95], 0 offen sc1
  s_waitcnt vmcnt(0)
  s_branch concat_heads__mha_block__spectral_fnet__prompt_kernel_zchk
concat_heads__mha_block__spectral_fnet__prompt_kernel_tail:
  s_setprio 0
  s_nop 1
  v_mfma_f32_32x32x16_bf16 v[64:79], v[124:127], v[84:87], v[64:79]
  v_mfma_f32_16x16x32_bf16 v[88:91], v[92:95], v[84:87], v[88:91]
  s_lshl_b32 s28, s23, 6
  s_lshl_b32 s29, s20, 1
  s_add_u32 s28, s28, s29
  s_lshl_b32 s28, s28, 10
  s_add_u32 s31, s28, 0xc00000
  s_nop 11
  v_rcp_f32 v97, v88
  v_add_f32 v96, |v64|, |v65|
  v_add_f32 v96, v96, |v66|
  v_add_f32 v96, v96, |v67|
  v_add_f32 v96, v96, |v68|
  v_add_f32 v96, v96, |v69|
  v_add_f32 v96, v96, |v70|
  v_add_f32 v96, v96, |v71|
  v_add_f32 v96, v96, |v72|
  v_add_f32 v96, v96, |v73|
  v_add_f32 v96, v96, |v74|
  v_add_f32 v96, v96, |v75|
  v_add_f32 v96, v96, |v76|
  v_add_f32 v96, v96, |v77|
  v_add_f32 v96, v96, |v78|
  v_add_f32 v96, v96, |v79|
  s_mov_b32 s28, 0x7e800000
  s_mov_b32 s29, 0xd800000
  v_cmp_nlt_f32 s[32:33], v96, s28
  v_cmp_lt_f32 s[34:35], v96, s29
  v_cmp_nlt_f32 s[50:51], v88, s28
  v_mul_f32 v64, v64, v97
  v_mul_f32 v65, v65, v97
  v_mul_f32 v66, v66, v97
  v_mul_f32 v67, v67, v97
  v_mul_f32 v68, v68, v97
  v_mul_f32 v69, v69, v97
  v_mul_f32 v70, v70, v97
  v_mul_f32 v71, v71, v97
  v_mul_f32 v72, v72, v97
  v_mul_f32 v73, v73, v97
  v_mul_f32 v74, v74, v97
  v_mul_f32 v75, v75, v97
  v_mul_f32 v76, v76, v97
  v_mul_f32 v77, v77, v97
  v_mul_f32 v78, v78, v97
  v_mul_f32 v79, v79, v97
  s_or_b64 s[32:33], s[32:33], s[34:35]
  s_or_b64 s[32:33], s[32:33], s[50:51]
  v_cvt_pk_bf16_f32 v80, v64, v65
  v_cvt_pk_bf16_f32 v81, v66, v67
  v_cvt_pk_bf16_f32 v82, v68, v69
  v_cvt_pk_bf16_f32 v83, v70, v71
  v_cvt_pk_bf16_f32 v84, v72, v73
  v_cvt_pk_bf16_f32 v85, v74, v75
  v_cvt_pk_bf16_f32 v86, v76, v77
  v_cvt_pk_bf16_f32 v87, v78, v79
  s_cmp_lg_u64 s[32:33], 0
  s_cselect_b32 s28, 1, 0
  s_cmp_lg_u32 s27, 0
  s_cselect_b32 s29, s54, s28
  s_xor_b32 s29, s29, s27
  s_mov_b32 s54, s28
  s_cmp_lg_u32 s29, 0
  s_cbranch_scc1 concat_heads__mha_block__spectral_fnet__prompt_kernel_nostore
  buffer_store_dwordx4 v[80:83], v5, s[12:15], s31 offen sc1
  buffer_store_dwordx4 v[84:87], v5, s[12:15], s31 offen offset:1024 sc1
  s_branch concat_heads__mha_block__spectral_fnet__prompt_kernel_stored
concat_heads__mha_block__spectral_fnet__prompt_kernel_nostore:
concat_heads__mha_block__spectral_fnet__prompt_kernel_stored:
  s_lshl_b32 s29, s22, 2
  s_add_u32 s29, s29, 98304
  v_mov_b32 v96, s28
  v_mov_b32 v97, s29
  ds_write_b32 v97, v96
  s_waitcnt lgkmcnt(0)
  s_barrier
  v_and_b32 v97, 7, v0
  v_lshlrev_b32 v97, 2, v97
  v_add_u32 v97, 98304, v97
  ds_read_b32 v96, v97
  s_waitcnt lgkmcnt(0)
  v_cmp_ne_u32 vcc, 0, v96
  s_nop 3
  s_cmp_eq_u64 vcc, 0
  s_cbranch_scc1 concat_heads__mha_block__spectral_fnet__prompt_kernel_fin
  s_cmp_lg_u32 s27, 0
  s_cbranch_scc1 concat_heads__mha_block__spectral_fnet__prompt_kernel_fin
  s_mov_b32 s27, 1
  v_mov_b32 v6, 0xff800000
  s_mov_b32 s30, 0
  s_waitcnt vmcnt(0)
concat_heads__mha_block__spectral_fnet__prompt_kernel_mx:
  s_barrier
  s_cmp_ge_u32 s22, 4
  s_cbranch_scc1 concat_heads__mha_block__spectral_fnet__prompt_kernel_mx_y
  s_lshl_b32 s28, s30, 14
  s_add_u32 s28, s28, s25
  s_mov_b32 m0, s26
  s_nop 0
  buffer_load_dwordx4 v4, s[12:15], s28 offen offset:0 lds
  buffer_load_dwordx4 v4, s[12:15], s28 offen offset:1024 lds
  buffer_load_dwordx4 v4, s[12:15], s28 offen offset:2048 lds
  buffer_load_dwordx4 v4, s[12:15], s28 offen offset:3072 lds
  s_waitcnt vmcnt(0)
concat_heads__mha_block__spectral_fnet__prompt_kernel_mx_y:
  s_barrier
  ds_read_b128 v[96:99], v5 offset:0
  ds_read_b128 v[100:103], v5 offset:1024
  s_waitcnt lgkmcnt(0)
  v_mfma_f32_32x32x16_bf16 v[32:47], v[96:99], v[8:11], 0
  v_mfma_f32_32x32x16_bf16 v[32:47], v[100:103], v[12:15], v[32:47]
  s_nop 15
  v_max3_f32 v6, v6, v32, v33
  v_max3_f32 v6, v6, v34, v35
  v_max3_f32 v6, v6, v36, v37
  v_max3_f32 v6, v6, v38, v39
  v_max3_f32 v6, v6, v40, v41
  v_max3_f32 v6, v6, v42, v43
  v_max3_f32 v6, v6, v44, v45
  v_max3_f32 v6, v6, v46, v47
  ds_read_b128 v[96:99], v5 offset:4096
  ds_read_b128 v[100:103], v5 offset:5120
  s_waitcnt lgkmcnt(0)
  v_mfma_f32_32x32x16_bf16 v[32:47], v[96:99], v[8:11], 0
  v_mfma_f32_32x32x16_bf16 v[32:47], v[100:103], v[12:15], v[32:47]
  s_nop 15
  v_max3_f32 v6, v6, v32, v33
  v_max3_f32 v6, v6, v34, v35
  v_max3_f32 v6, v6, v36, v37
  v_max3_f32 v6, v6, v38, v39
  v_max3_f32 v6, v6, v40, v41
  v_max3_f32 v6, v6, v42, v43
  v_max3_f32 v6, v6, v44, v45
  v_max3_f32 v6, v6, v46, v47
  ds_read_b128 v[96:99], v5 offset:8192
  ds_read_b128 v[100:103], v5 offset:9216
  s_waitcnt lgkmcnt(0)
  v_mfma_f32_32x32x16_bf16 v[32:47], v[96:99], v[8:11], 0
  v_mfma_f32_32x32x16_bf16 v[32:47], v[100:103], v[12:15], v[32:47]
  s_nop 15
  v_max3_f32 v6, v6, v32, v33
  v_max3_f32 v6, v6, v34, v35
  v_max3_f32 v6, v6, v36, v37
  v_max3_f32 v6, v6, v38, v39
  v_max3_f32 v6, v6, v40, v41
  v_max3_f32 v6, v6, v42, v43
  v_max3_f32 v6, v6, v44, v45
  v_max3_f32 v6, v6, v46, v47
  ds_read_b128 v[96:99], v5 offset:12288
  ds_read_b128 v[100:103], v5 offset:13312
  s_waitcnt lgkmcnt(0)
  v_mfma_f32_32x32x16_bf16 v[32:47], v[96:99], v[8:11], 0
  v_mfma_f32_32x32x16_bf16 v[32:47], v[100:103], v[12:15], v[32:47]
  s_nop 15
  v_max3_f32 v6, v6, v32, v33
  v_max3_f32 v6, v6, v34, v35
  v_max3_f32 v6, v6, v36, v37
  v_max3_f32 v6, v6, v38, v39
  v_max3_f32 v6, v6, v40, v41
  v_max3_f32 v6, v6, v42, v43
  v_max3_f32 v6, v6, v44, v45
  v_max3_f32 v6, v6, v46, v47
  s_add_u32 s30, s30, 1
  s_cmp_lt_u32 s30, 16
  s_cbranch_scc1 concat_heads__mha_block__spectral_fnet__prompt_kernel_mx
  v_mov_b32 v7, v6
  s_nop 1
  v_permlane32_swap_b32 v6, v7
  s_nop 1
  v_max_f32 v6, v6, v7
  v_sub_f32 v16, 0, v6
  v_sub_f32 v17, 0, v6
  v_sub_f32 v18, 0, v6
  v_sub_f32 v19, 0, v6
  v_sub_f32 v20, 0, v6
  v_sub_f32 v21, 0, v6
  v_sub_f32 v22, 0, v6
  v_sub_f32 v23, 0, v6
  v_sub_f32 v24, 0, v6
  v_sub_f32 v25, 0, v6
  v_sub_f32 v26, 0, v6
  v_sub_f32 v27, 0, v6
  v_sub_f32 v28, 0, v6
  v_sub_f32 v29, 0, v6
  v_sub_f32 v30, 0, v6
  v_sub_f32 v31, 0, v6
  s_barrier
  s_branch concat_heads__mha_block__spectral_fnet__prompt_kernel_start
concat_heads__mha_block__spectral_fnet__prompt_kernel_fin:
  v_and_b32 v6, 31, v0
  v_lshlrev_b32 v7, 7, v6
  v_bfe_u32 v90, v0, 1, 3
  v_lshrrev_b32 v91, 5, v0
  v_xor_b32 v90, v90, v91
  s_lshl_b32 s28, s52, 13
  s_add_u32 s28, s28, 114688
  v_add_u32 v7, s28, v7
  v_xor_b32 v93, 0, v90
  v_lshlrev_b32 v93, 4, v93
  v_add_u32 v93, v93, v7
  ds_read_b128 v[16:19], v93
  ds_read_b128 v[32:35], v93 offset:4096
  v_xor_b32 v93, 2, v90
  v_lshlrev_b32 v93, 4, v93
  v_add_u32 v93, v93, v7
  ds_read_b128 v[20:23], v93
  ds_read_b128 v[36:39], v93 offset:4096
  v_xor_b32 v93, 4, v90
  v_lshlrev_b32 v93, 4, v93
  v_add_u32 v93, v93, v7
  ds_read_b128 v[24:27], v93
  ds_read_b128 v[40:43], v93 offset:4096
  v_xor_b32 v93, 6, v90
  v_lshlrev_b32 v93, 4, v93
  v_add_u32 v93, v93, v7
  ds_read_b128 v[28:31], v93
  ds_read_b128 v[44:47], v93 offset:4096
  s_lshl_b32 s28, s44, 3
  s_lshl_b32 s29, s45, 1
  s_add_u32 s28, s28, s29
  s_lshl_b32 s28, s28, 16
  s_add_u32 s30, s28, 0xc00000
  s_bfe_u32 s28, s22, 0x10001
  s_lshl_b32 s28, s28, 16
  s_lshl_b32 s29, s52, 15
  s_add_u32 s28, s28, s29
  s_and_b32 s29, s22, 1
  s_lshl_b32 s29, s29, 10
  s_add_u32 s31, s28, s29
  s_add_u32 s30, s30, s31
  s_waitcnt lgkmcnt(0)
  s_barrier
  s_add_u32 m0, s31, 0
  s_add_u32 s29, s30, 0
  buffer_load_dwordx4 v5, s[12:15], s29 offen sc1 lds
  s_add_u32 m0, s31, 2048
  s_add_u32 s29, s30, 2048
  buffer_load_dwordx4 v5, s[12:15], s29 offen sc1 lds
  s_add_u32 m0, s31, 4096
  s_add_u32 s29, s30, 4096
  buffer_load_dwordx4 v5, s[12:15], s29 offen sc1 lds
  s_add_u32 m0, s31, 6144
  s_add_u32 s29, s30, 6144
  buffer_load_dwordx4 v5, s[12:15], s29 offen sc1 lds
  s_add_u32 m0, s31, 8192
  s_add_u32 s29, s30, 8192
  buffer_load_dwordx4 v5, s[12:15], s29 offen sc1 lds
  s_add_u32 m0, s31, 10240
  s_add_u32 s29, s30, 10240
  buffer_load_dwordx4 v5, s[12:15], s29 offen sc1 lds
  s_add_u32 m0, s31, 12288
  s_add_u32 s29, s30, 12288
  buffer_load_dwordx4 v5, s[12:15], s29 offen sc1 lds
  s_add_u32 m0, s31, 14336
  s_add_u32 s29, s30, 14336
  buffer_load_dwordx4 v5, s[12:15], s29 offen sc1 lds
  s_add_u32 m0, s31, 16384
  s_add_u32 s29, s30, 16384
  buffer_load_dwordx4 v5, s[12:15], s29 offen sc1 lds
  s_add_u32 m0, s31, 18432
  s_add_u32 s29, s30, 18432
  buffer_load_dwordx4 v5, s[12:15], s29 offen sc1 lds
  s_add_u32 m0, s31, 20480
  s_add_u32 s29, s30, 20480
  buffer_load_dwordx4 v5, s[12:15], s29 offen sc1 lds
  s_add_u32 m0, s31, 22528
  s_add_u32 s29, s30, 22528
  buffer_load_dwordx4 v5, s[12:15], s29 offen sc1 lds
  s_add_u32 m0, s31, 24576
  s_add_u32 s29, s30, 24576
  buffer_load_dwordx4 v5, s[12:15], s29 offen sc1 lds
  s_add_u32 m0, s31, 26624
  s_add_u32 s29, s30, 26624
  buffer_load_dwordx4 v5, s[12:15], s29 offen sc1 lds
  s_add_u32 m0, s31, 28672
  s_add_u32 s29, s30, 28672
  buffer_load_dwordx4 v5, s[12:15], s29 offen sc1 lds
  s_add_u32 m0, s31, 30720
  s_add_u32 s29, s30, 30720
  buffer_load_dwordx4 v5, s[12:15], s29 offen sc1 lds
  s_lshl_b32 s28, s52, 5
  v_add_u32 v6, s28, v6
  v_lshlrev_b32 v6, 5, v6
  v_add_u32 v6, s48, v6
  v_lshlrev_b32 v6, 12, v6
  v_lshlrev_b32 v91, 4, v91
  v_add_u32 v6, v6, v91
  s_lshl_b32 s28, s21, 2
  s_add_u32 s28, s28, s46
  s_lshl_b32 s28, s28, 6
  s_add_u32 s28, s28, 2048
  v_add_u32 v94, s28, v6
  v_lshrrev_b32 v6, 5, v0
  v_lshlrev_b32 v6, 3, v6
  v_bfe_u32 v7, v0, 2, 2
  v_add_u32 v6, v6, v7
  v_lshlrev_b32 v6, 8, v6
  v_lshlrev_b32 v7, 1, v7
  v_bfe_u32 v90, v0, 4, 1
  v_lshlrev_b32 v90, 3, v90
  v_bfe_u32 v91, v0, 1, 1
  v_add_u32 v90, v90, v91
  s_lshl_b32 s28, s46, 1
  v_add_u32 v90, s28, v90
  v_xor_b32 v90, v90, v7
  v_lshlrev_b32 v90, 4, v90
  v_add_u32 v6, v6, v90
  v_and_b32 v7, 1, v0
  v_lshlrev_b32 v7, 3, v7
  v_add_u32 v6, v6, v7
  v_add_u32 v92, 131072, v6
  ds_read_b64_tr_b16 v[96:97], v92 offset:0
  ds_read_b64_tr_b16 v[98:99], v92 offset:1024
  ds_read_b64_tr_b16 v[100:101], v92 offset:4096
  ds_read_b64_tr_b16 v[102:103], v92 offset:5120
  ds_read_b64_tr_b16 v[104:105], v92 offset:8192
  ds_read_b64_tr_b16 v[106:107], v92 offset:9216
  ds_read_b64_tr_b16 v[108:109], v92 offset:12288
  ds_read_b64_tr_b16 v[110:111], v92 offset:13312
  ds_read_b64_tr_b16 v[112:113], v92 offset:16384
  ds_read_b64_tr_b16 v[114:115], v92 offset:17408
  ds_read_b64_tr_b16 v[116:117], v92 offset:20480
  ds_read_b64_tr_b16 v[118:119], v92 offset:21504
  ds_read_b64_tr_b16 v[120:121], v92 offset:24576
  ds_read_b64_tr_b16 v[122:123], v92 offset:25600
  ds_read_b64_tr_b16 v[124:125], v92 offset:28672
  ds_read_b64_tr_b16 v[126:127], v92 offset:29696
  v_and_b32 v95, 31, v0
  s_lshl_b32 s28, s44, 8
  s_lshl_b32 s29, s45, 6
  s_add_u32 s28, s28, s29
  s_lshl_b32 s29, s52, 5
  s_add_u32 s28, s28, s29
  v_add_u32 v95, s28, v95
  v_lshlrev_b32 v95, 12, v95
  v_lshrrev_b32 v6, 5, v0
  v_lshlrev_b32 v6, 4, v6
  v_add_u32 v95, v95, v6
  s_lshl_b32 s28, s21, 8
  s_lshl_b32 s29, s46, 6
  s_add_u32 s28, s28, s29
  v_add_u32 v95, s28, v95
  s_lshl_b32 s28, s52, 15
  v_add_u32 v88, s28, v5
  v_add_u32 v89, 65536, v88
  s_waitcnt lgkmcnt(0)
concat_heads__mha_block__spectral_fnet__prompt_kernel_p2:
  v_mfma_f32_32x32x16_bf16 v[48:63], v[96:99], v[16:19], 0
  v_mfma_f32_32x32x16_bf16 v[48:63], v[100:103], v[20:23], v[48:63]
  v_mfma_f32_32x32x16_bf16 v[48:63], v[104:107], v[24:27], v[48:63]
  v_mfma_f32_32x32x16_bf16 v[48:63], v[108:111], v[28:31], v[48:63]
  v_mfma_f32_32x32x16_bf16 v[48:63], v[112:115], v[32:35], v[48:63]
  v_mfma_f32_32x32x16_bf16 v[48:63], v[116:119], v[36:39], v[48:63]
  v_mfma_f32_32x32x16_bf16 v[48:63], v[120:123], v[40:43], v[48:63]
  v_mfma_f32_32x32x16_bf16 v[48:63], v[124:127], v[44:47], v[48:63]
  s_mov_b32 s16, s36
  s_mov_b32 s17, s37
  s_mov_b32 s18, 0x800000
  s_mov_b32 s19, 0x00020000
  s_nop 10
  v_cvt_pk_bf16_f32 v80, v48, v49
  v_cvt_pk_bf16_f32 v81, v50, v51
  v_cvt_pk_bf16_f32 v82, v52, v53
  v_cvt_pk_bf16_f32 v83, v54, v55
  v_cvt_pk_bf16_f32 v84, v56, v57
  v_cvt_pk_bf16_f32 v85, v58, v59
  v_cvt_pk_bf16_f32 v86, v60, v61
  v_cvt_pk_bf16_f32 v87, v62, v63
  v_and_b32 v6, 15, v0
  v_lshlrev_b32 v6, 11, v6
  v_lshrrev_b32 v7, 4, v0
  v_lshlrev_b32 v7, 8, v7
  v_add_u32 v91, v6, v7
  v_add_u32 v93, s31, v5
  s_mov_b32 s34, 0
  s_mov_b32 s35, 15
  v_mov_b32 v16, 0
  v_mov_b32 v17, 0
  v_mov_b32 v18, 0
  v_mov_b32 v19, 0
  v_mov_b32 v20, 0
  v_mov_b32 v21, 0
  v_mov_b32 v22, 0
  v_mov_b32 v23, 0
  v_mov_b32 v24, 0
  v_mov_b32 v25, 0
  v_mov_b32 v26, 0
  v_mov_b32 v27, 0
  v_mov_b32 v28, 0
  v_mov_b32 v29, 0
  v_mov_b32 v30, 0
  v_mov_b32 v31, 0
  v_mov_b32 v32, 0
  v_mov_b32 v33, 0
  v_mov_b32 v34, 0
  v_mov_b32 v35, 0
  v_mov_b32 v36, 0
  v_mov_b32 v37, 0
  v_mov_b32 v38, 0
  v_mov_b32 v39, 0
  v_mov_b32 v40, 0
  v_mov_b32 v41, 0
  v_mov_b32 v42, 0
  v_mov_b32 v43, 0
  v_mov_b32 v44, 0
  v_mov_b32 v45, 0
  v_mov_b32 v46, 0
  v_mov_b32 v47, 0
  v_and_b32 v91, 7, v0
  v_lshlrev_b32 v91, 2, v91
  v_add_u32 v91, 131072, v91
  s_lshl_b32 s28, s22, 2
  s_add_u32 s28, s28, 131072
  v_mov_b32 v90, s28
  s_waitcnt vmcnt(0)
  s_bitcmp1_b32 s35, 0
  s_cbranch_scc0 concat_heads__mha_block__spectral_fnet__prompt_kernel_nc0_0
  ds_read_b128 v[64:67], v93 offset:0
  ds_read_b128 v[68:71], v93 offset:2048
  ds_read_b128 v[72:75], v93 offset:4096
  ds_read_b128 v[76:79], v93 offset:6144
  s_waitcnt lgkmcnt(0)
  v_max3_u32 v6, v64, v65, v66
  v_max3_u32 v6, v6, v67, v68
  v_max3_u32 v6, v6, v69, v70
  v_max3_u32 v6, v6, v71, v72
  v_max3_u32 v6, v6, v73, v74
  v_max3_u32 v6, v6, v75, v76
  v_max3_u32 v6, v6, v77, v78
  v_max_u32 v6, v6, v79
  v_cmp_eq_u32 vcc, -1, v6
  s_add_u32 s34, s34, 1
  s_nop 2
  s_cmp_eq_u64 vcc, 0
  s_cbranch_scc0 concat_heads__mha_block__spectral_fnet__prompt_kernel_nc0_0
  s_bitset0_b32 s35, 0
concat_heads__mha_block__spectral_fnet__prompt_kernel_nc0_0:
  s_bitcmp1_b32 s35, 1
  s_cbranch_scc0 concat_heads__mha_block__spectral_fnet__prompt_kernel_nc0_1
  ds_read_b128 v[64:67], v93 offset:8192
  ds_read_b128 v[68:71], v93 offset:10240
  ds_read_b128 v[72:75], v93 offset:12288
  ds_read_b128 v[76:79], v93 offset:14336
  s_waitcnt lgkmcnt(0)
  v_max3_u32 v6, v64, v65, v66
  v_max3_u32 v6, v6, v67, v68
  v_max3_u32 v6, v6, v69, v70
  v_max3_u32 v6, v6, v71, v72
  v_max3_u32 v6, v6, v73, v74
  v_max3_u32 v6, v6, v75, v76
  v_max3_u32 v6, v6, v77, v78
  v_max_u32 v6, v6, v79
  v_cmp_eq_u32 vcc, -1, v6
  s_add_u32 s34, s34, 1
  s_nop 2
  s_cmp_eq_u64 vcc, 0
  s_cbranch_scc0 concat_heads__mha_block__spectral_fnet__prompt_kernel_nc0_1
  s_bitset0_b32 s35, 1
concat_heads__mha_block__spectral_fnet__prompt_kernel_nc0_1:
  s_bitcmp1_b32 s35, 2
  s_cbranch_scc0 concat_heads__mha_block__spectral_fnet__prompt_kernel_nc0_2
  ds_read_b128 v[64:67], v93 offset:16384
  ds_read_b128 v[68:71], v93 offset:18432
  ds_read_b128 v[72:75], v93 offset:20480
  ds_read_b128 v[76:79], v93 offset:22528
  s_waitcnt lgkmcnt(0)
  v_max3_u32 v6, v64, v65, v66
  v_max3_u32 v6, v6, v67, v68
  v_max3_u32 v6, v6, v69, v70
  v_max3_u32 v6, v6, v71, v72
  v_max3_u32 v6, v6, v73, v74
  v_max3_u32 v6, v6, v75, v76
  v_max3_u32 v6, v6, v77, v78
  v_max_u32 v6, v6, v79
  v_cmp_eq_u32 vcc, -1, v6
  s_add_u32 s34, s34, 1
  s_nop 2
  s_cmp_eq_u64 vcc, 0
  s_cbranch_scc0 concat_heads__mha_block__spectral_fnet__prompt_kernel_nc0_2
  s_bitset0_b32 s35, 2
concat_heads__mha_block__spectral_fnet__prompt_kernel_nc0_2:
  s_bitcmp1_b32 s35, 3
  s_cbranch_scc0 concat_heads__mha_block__spectral_fnet__prompt_kernel_nc0_3
  ds_read_b128 v[64:67], v93 offset:24576
  ds_read_b128 v[68:71], v93 offset:26624
  ds_read_b128 v[72:75], v93 offset:28672
  ds_read_b128 v[76:79], v93 offset:30720
  s_waitcnt lgkmcnt(0)
  v_max3_u32 v6, v64, v65, v66
  v_max3_u32 v6, v6, v67, v68
  v_max3_u32 v6, v6, v69, v70
  v_max3_u32 v6, v6, v71, v72
  v_max3_u32 v6, v6, v73, v74
  v_max3_u32 v6, v6, v75, v76
  v_max3_u32 v6, v6, v77, v78
  v_max_u32 v6, v6, v79
  v_cmp_eq_u32 vcc, -1, v6
  s_add_u32 s34, s34, 1
  s_nop 2
  s_cmp_eq_u64 vcc, 0
  s_cbranch_scc0 concat_heads__mha_block__spectral_fnet__prompt_kernel_nc0_3
  s_bitset0_b32 s35, 3
concat_heads__mha_block__spectral_fnet__prompt_kernel_nc0_3:
  s_bitcmp1_b32 s35, 0
  s_cbranch_scc0 concat_heads__mha_block__spectral_fnet__prompt_kernel_nf0_0
  s_add_u32 m0, s31, 0
  s_add_u32 s29, s30, 0
  buffer_load_dwordx4 v5, s[12:15], s29 offen sc1 lds
  s_add_u32 m0, s31, 2048
  s_add_u32 s29, s30, 2048
  buffer_load_dwordx4 v5, s[12:15], s29 offen sc1 lds
  s_add_u32 m0, s31, 4096
  s_add_u32 s29, s30, 4096
  buffer_load_dwordx4 v5, s[12:15], s29 offen sc1 lds
  s_add_u32 m0, s31, 6144
  s_add_u32 s29, s30, 6144
  buffer_load_dwordx4 v5, s[12:15], s29 offen sc1 lds
concat_heads__mha_block__spectral_fnet__prompt_kernel_nf0_0:
  s_bitcmp1_b32 s35, 1
  s_cbranch_scc0 concat_heads__mha_block__spectral_fnet__prompt_kernel_nf0_1
  s_add_u32 m0, s31, 8192
  s_add_u32 s29, s30, 8192
  buffer_load_dwordx4 v5, s[12:15], s29 offen sc1 lds
  s_add_u32 m0, s31, 10240
  s_add_u32 s29, s30, 10240
  buffer_load_dwordx4 v5, s[12:15], s29 offen sc1 lds
  s_add_u32 m0, s31, 12288
  s_add_u32 s29, s30, 12288
  buffer_load_dwordx4 v5, s[12:15], s29 offen sc1 lds
  s_add_u32 m0, s31, 14336
  s_add_u32 s29, s30, 14336
  buffer_load_dwordx4 v5, s[12:15], s29 offen sc1 lds
concat_heads__mha_block__spectral_fnet__prompt_kernel_nf0_1:
  s_bitcmp1_b32 s35, 2
  s_cbranch_scc0 concat_heads__mha_block__spectral_fnet__prompt_kernel_nf0_2
  s_add_u32 m0, s31, 16384
  s_add_u32 s29, s30, 16384
  buffer_load_dwordx4 v5, s[12:15], s29 offen sc1 lds
  s_add_u32 m0, s31, 18432
  s_add_u32 s29, s30, 18432
  buffer_load_dwordx4 v5, s[12:15], s29 offen sc1 lds
  s_add_u32 m0, s31, 20480
  s_add_u32 s29, s30, 20480
  buffer_load_dwordx4 v5, s[12:15], s29 offen sc1 lds
  s_add_u32 m0, s31, 22528
  s_add_u32 s29, s30, 22528
  buffer_load_dwordx4 v5, s[12:15], s29 offen sc1 lds
concat_heads__mha_block__spectral_fnet__prompt_kernel_nf0_2:
  s_bitcmp1_b32 s35, 3
  s_cbranch_scc0 concat_heads__mha_block__spectral_fnet__prompt_kernel_nf0_3
  s_add_u32 m0, s31, 24576
  s_add_u32 s29, s30, 24576
  buffer_load_dwordx4 v5, s[12:15], s29 offen sc1 lds
  s_add_u32 m0, s31, 26624
  s_add_u32 s29, s30, 26624
  buffer_load_dwordx4 v5, s[12:15], s29 offen sc1 lds
  s_add_u32 m0, s31, 28672
  s_add_u32 s29, s30, 28672
  buffer_load_dwordx4 v5, s[12:15], s29 offen sc1 lds
  s_add_u32 m0, s31, 30720
  s_add_u32 s29, s30, 30720
  buffer_load_dwordx4 v5, s[12:15], s29 offen sc1 lds
concat_heads__mha_block__spectral_fnet__prompt_kernel_nf0_3:
  buffer_store_dwordx4 v[80:83], v94, s[16:19], 0 offen
  buffer_store_dwordx4 v[84:87], v94, s[16:19], 0 offen offset:32
  s_barrier
  v_mov_b32 v7, s35
  ds_write_b32 v90, v7
  s_waitcnt lgkmcnt(0)
  s_barrier
  ds_read_b32 v7, v91
  s_mov_b32 s53, 0
  s_waitcnt lgkmcnt(0)
  v_and_b32 v6, 1, v7
  v_cmp_ne_u32 vcc, 0, v6
  s_nop 3
  s_cmp_lg_u64 vcc, 0
  s_cselect_b32 s28, 1, 0
  s_or_b32 s53, s53, s28
  v_and_b32 v6, 2, v7
  v_cmp_ne_u32 vcc, 0, v6
  s_nop 3
  s_cmp_lg_u64 vcc, 0
  s_cselect_b32 s28, 2, 0
  s_or_b32 s53, s53, s28
  v_and_b32 v6, 4, v7
  v_cmp_ne_u32 vcc, 0, v6
  s_nop 3
  s_cmp_lg_u64 vcc, 0
  s_cselect_b32 s28, 4, 0
  s_or_b32 s53, s53, s28
  v_and_b32 v6, 8, v7
  v_cmp_ne_u32 vcc, 0, v6
  s_nop 3
  s_cmp_lg_u64 vcc, 0
  s_cselect_b32 s28, 8, 0
  s_or_b32 s53, s53, s28
  s_xor_b32 s54, s53, 15
  s_mov_b32 s55, 0
concat_heads__mha_block__spectral_fnet__prompt_kernel_grp:
  s_bitcmp1_b32 s54, 0
  s_cbranch_scc0 concat_heads__mha_block__spectral_fnet__prompt_kernel_sk0
  ds_read_b128 v[96:99], v88 offset:0
  ds_read_b128 v[100:103], v89 offset:0
  ds_read_b128 v[104:107], v88 offset:1024
  ds_read_b128 v[108:111], v89 offset:1024
  ds_read_b128 v[112:115], v88 offset:2048
  ds_read_b128 v[116:119], v89 offset:2048
  s_waitcnt lgkmcnt(4)
  v_mfma_f32_32x32x16_bf16 v[16:31], v[128:131], v[96:99], v[16:31]
  v_mfma_f32_32x32x16_bf16 v[32:47], v[128:131], v[100:103], v[32:47]
  ds_read_b128 v[120:123], v88 offset:3072
  ds_read_b128 v[124:127], v89 offset:3072
  s_waitcnt lgkmcnt(4)
  v_mfma_f32_32x32x16_bf16 v[16:31], v[132:135], v[104:107], v[16:31]
  v_mfma_f32_32x32x16_bf16 v[32:47], v[132:135], v[108:111], v[32:47]
  ds_read_b128 v[96:99], v88 offset:4096
  ds_read_b128 v[100:103], v89 offset:4096
  s_waitcnt lgkmcnt(4)
  v_mfma_f32_32x32x16_bf16 v[16:31], v[136:139], v[112:115], v[16:31]
  v_mfma_f32_32x32x16_bf16 v[32:47], v[136:139], v[116:119], v[32:47]
  ds_read_b128 v[104:107], v88 offset:5120
  ds_read_b128 v[108:111], v89 offset:5120
  s_waitcnt lgkmcnt(4)
  v_mfma_f32_32x32x16_bf16 v[16:31], v[140:143], v[120:123], v[16:31]
  v_mfma_f32_32x32x16_bf16 v[32:47], v[140:143], v[124:127], v[32:47]
  ds_read_b128 v[112:115], v88 offset:6144
  ds_read_b128 v[116:119], v89 offset:6144
  s_waitcnt lgkmcnt(4)
  v_mfma_f32_32x32x16_bf16 v[16:31], v[144:147], v[96:99], v[16:31]
  v_mfma_f32_32x32x16_bf16 v[32:47], v[144:147], v[100:103], v[32:47]
  ds_read_b128 v[120:123], v88 offset:7168
  ds_read_b128 v[124:127], v89 offset:7168
  s_waitcnt lgkmcnt(4)
  v_mfma_f32_32x32x16_bf16 v[16:31], v[148:151], v[104:107], v[16:31]
  v_mfma_f32_32x32x16_bf16 v[32:47], v[148:151], v[108:111], v[32:47]
  s_waitcnt lgkmcnt(2)
  v_mfma_f32_32x32x16_bf16 v[16:31], v[152:155], v[112:115], v[16:31]
  v_mfma_f32_32x32x16_bf16 v[32:47], v[152:155], v[116:119], v[32:47]
  s_waitcnt lgkmcnt(0)
  v_mfma_f32_32x32x16_bf16 v[16:31], v[156:159], v[120:123], v[16:31]
  v_mfma_f32_32x32x16_bf16 v[32:47], v[156:159], v[124:127], v[32:47]
concat_heads__mha_block__spectral_fnet__prompt_kernel_sk0:
  s_bitcmp1_b32 s54, 1
  s_cbranch_scc0 concat_heads__mha_block__spectral_fnet__prompt_kernel_sk1
  ds_read_b128 v[96:99], v88 offset:8192
  ds_read_b128 v[100:103], v89 offset:8192
  ds_read_b128 v[104:107], v88 offset:9216
  ds_read_b128 v[108:111], v89 offset:9216
  ds_read_b128 v[112:115], v88 offset:10240
  ds_read_b128 v[116:119], v89 offset:10240
  s_waitcnt lgkmcnt(4)
  v_mfma_f32_32x32x16_bf16 v[16:31], v[160:163], v[96:99], v[16:31]
  v_mfma_f32_32x32x16_bf16 v[32:47], v[160:163], v[100:103], v[32:47]
  ds_read_b128 v[120:123], v88 offset:11264
  ds_read_b128 v[124:127], v89 offset:11264
  s_waitcnt lgkmcnt(4)
  v_mfma_f32_32x32x16_bf16 v[16:31], v[164:167], v[104:107], v[16:31]
  v_mfma_f32_32x32x16_bf16 v[32:47], v[164:167], v[108:111], v[32:47]
  ds_read_b128 v[96:99], v88 offset:12288
  ds_read_b128 v[100:103], v89 offset:12288
  s_waitcnt lgkmcnt(4)
  v_mfma_f32_32x32x16_bf16 v[16:31], v[168:171], v[112:115], v[16:31]
  v_mfma_f32_32x32x16_bf16 v[32:47], v[168:171], v[116:119], v[32:47]
  ds_read_b128 v[104:107], v88 offset:13312
  ds_read_b128 v[108:111], v89 offset:13312
  s_waitcnt lgkmcnt(4)
  v_mfma_f32_32x32x16_bf16 v[16:31], v[172:175], v[120:123], v[16:31]
  v_mfma_f32_32x32x16_bf16 v[32:47], v[172:175], v[124:127], v[32:47]
  ds_read_b128 v[112:115], v88 offset:14336
  ds_read_b128 v[116:119], v89 offset:14336
  s_waitcnt lgkmcnt(4)
  v_mfma_f32_32x32x16_bf16 v[16:31], v[176:179], v[96:99], v[16:31]
  v_mfma_f32_32x32x16_bf16 v[32:47], v[176:179], v[100:103], v[32:47]
  ds_read_b128 v[120:123], v88 offset:15360
  ds_read_b128 v[124:127], v89 offset:15360
  s_waitcnt lgkmcnt(4)
  v_mfma_f32_32x32x16_bf16 v[16:31], v[180:183], v[104:107], v[16:31]
  v_mfma_f32_32x32x16_bf16 v[32:47], v[180:183], v[108:111], v[32:47]
  s_waitcnt lgkmcnt(2)
  v_mfma_f32_32x32x16_bf16 v[16:31], v[184:187], v[112:115], v[16:31]
  v_mfma_f32_32x32x16_bf16 v[32:47], v[184:187], v[116:119], v[32:47]
  s_waitcnt lgkmcnt(0)
  v_mfma_f32_32x32x16_bf16 v[16:31], v[188:191], v[120:123], v[16:31]
  v_mfma_f32_32x32x16_bf16 v[32:47], v[188:191], v[124:127], v[32:47]
concat_heads__mha_block__spectral_fnet__prompt_kernel_sk1:
  s_bitcmp1_b32 s54, 2
  s_cbranch_scc0 concat_heads__mha_block__spectral_fnet__prompt_kernel_sk2
  ds_read_b128 v[96:99], v88 offset:16384
  ds_read_b128 v[100:103], v89 offset:16384
  ds_read_b128 v[104:107], v88 offset:17408
  ds_read_b128 v[108:111], v89 offset:17408
  ds_read_b128 v[112:115], v88 offset:18432
  ds_read_b128 v[116:119], v89 offset:18432
  s_waitcnt lgkmcnt(4)
  v_mfma_f32_32x32x16_bf16 v[16:31], v[192:195], v[96:99], v[16:31]
  v_mfma_f32_32x32x16_bf16 v[32:47], v[192:195], v[100:103], v[32:47]
  ds_read_b128 v[120:123], v88 offset:19456
  ds_read_b128 v[124:127], v89 offset:19456
  s_waitcnt lgkmcnt(4)
  v_mfma_f32_32x32x16_bf16 v[16:31], v[196:199], v[104:107], v[16:31]
  v_mfma_f32_32x32x16_bf16 v[32:47], v[196:199], v[108:111], v[32:47]
  ds_read_b128 v[96:99], v88 offset:20480
  ds_read_b128 v[100:103], v89 offset:20480
  s_waitcnt lgkmcnt(4)
  v_mfma_f32_32x32x16_bf16 v[16:31], v[200:203], v[112:115], v[16:31]
  v_mfma_f32_32x32x16_bf16 v[32:47], v[200:203], v[116:119], v[32:47]
  ds_read_b128 v[104:107], v88 offset:21504
  ds_read_b128 v[108:111], v89 offset:21504
  s_waitcnt lgkmcnt(4)
  v_mfma_f32_32x32x16_bf16 v[16:31], v[204:207], v[120:123], v[16:31]
  v_mfma_f32_32x32x16_bf16 v[32:47], v[204:207], v[124:127], v[32:47]
  ds_read_b128 v[112:115], v88 offset:22528
  ds_read_b128 v[116:119], v89 offset:22528
  s_waitcnt lgkmcnt(4)
  v_mfma_f32_32x32x16_bf16 v[16:31], v[208:211], v[96:99], v[16:31]
  v_mfma_f32_32x32x16_bf16 v[32:47], v[208:211], v[100:103], v[32:47]
  ds_read_b128 v[120:123], v88 offset:23552
  ds_read_b128 v[124:127], v89 offset:23552
  s_waitcnt lgkmcnt(4)
  v_mfma_f32_32x32x16_bf16 v[16:31], v[212:215], v[104:107], v[16:31]
  v_mfma_f32_32x32x16_bf16 v[32:47], v[212:215], v[108:111], v[32:47]
  s_waitcnt lgkmcnt(2)
  v_mfma_f32_32x32x16_bf16 v[16:31], v[216:219], v[112:115], v[16:31]
  v_mfma_f32_32x32x16_bf16 v[32:47], v[216:219], v[116:119], v[32:47]
  s_waitcnt lgkmcnt(0)
  v_mfma_f32_32x32x16_bf16 v[16:31], v[220:223], v[120:123], v[16:31]
  v_mfma_f32_32x32x16_bf16 v[32:47], v[220:223], v[124:127], v[32:47]
concat_heads__mha_block__spectral_fnet__prompt_kernel_sk2:
  s_bitcmp1_b32 s54, 3
  s_cbranch_scc0 concat_heads__mha_block__spectral_fnet__prompt_kernel_sk3
  ds_read_b128 v[96:99], v88 offset:24576
  ds_read_b128 v[100:103], v89 offset:24576
  ds_read_b128 v[104:107], v88 offset:25600
  ds_read_b128 v[108:111], v89 offset:25600
  ds_read_b128 v[112:115], v88 offset:26624
  ds_read_b128 v[116:119], v89 offset:26624
  s_waitcnt lgkmcnt(4)
  v_mfma_f32_32x32x16_bf16 v[16:31], v[224:227], v[96:99], v[16:31]
  v_mfma_f32_32x32x16_bf16 v[32:47], v[224:227], v[100:103], v[32:47]
  ds_read_b128 v[120:123], v88 offset:27648
  ds_read_b128 v[124:127], v89 offset:27648
  s_waitcnt lgkmcnt(4)
  v_mfma_f32_32x32x16_bf16 v[16:31], v[228:231], v[104:107], v[16:31]
  v_mfma_f32_32x32x16_bf16 v[32:47], v[228:231], v[108:111], v[32:47]
  ds_read_b128 v[96:99], v88 offset:28672
  ds_read_b128 v[100:103], v89 offset:28672
  s_waitcnt lgkmcnt(4)
  v_mfma_f32_32x32x16_bf16 v[16:31], v[232:235], v[112:115], v[16:31]
  v_mfma_f32_32x32x16_bf16 v[32:47], v[232:235], v[116:119], v[32:47]
  ds_read_b128 v[104:107], v88 offset:29696
  ds_read_b128 v[108:111], v89 offset:29696
  s_waitcnt lgkmcnt(4)
  v_mfma_f32_32x32x16_bf16 v[16:31], v[236:239], v[120:123], v[16:31]
  v_mfma_f32_32x32x16_bf16 v[32:47], v[236:239], v[124:127], v[32:47]
  ds_read_b128 v[112:115], v88 offset:30720
  ds_read_b128 v[116:119], v89 offset:30720
  s_waitcnt lgkmcnt(4)
  v_mfma_f32_32x32x16_bf16 v[16:31], v[240:243], v[96:99], v[16:31]
  v_mfma_f32_32x32x16_bf16 v[32:47], v[240:243], v[100:103], v[32:47]
  ds_read_b128 v[120:123], v88 offset:31744
  ds_read_b128 v[124:127], v89 offset:31744
  s_waitcnt lgkmcnt(4)
  v_mfma_f32_32x32x16_bf16 v[16:31], v[244:247], v[104:107], v[16:31]
  v_mfma_f32_32x32x16_bf16 v[32:47], v[244:247], v[108:111], v[32:47]
  s_waitcnt lgkmcnt(2)
  v_mfma_f32_32x32x16_bf16 v[16:31], v[248:251], v[112:115], v[16:31]
  v_mfma_f32_32x32x16_bf16 v[32:47], v[248:251], v[116:119], v[32:47]
  s_waitcnt lgkmcnt(0)
  v_mfma_f32_32x32x16_bf16 v[16:31], v[252:255], v[120:123], v[16:31]
  v_mfma_f32_32x32x16_bf16 v[32:47], v[252:255], v[124:127], v[32:47]
concat_heads__mha_block__spectral_fnet__prompt_kernel_sk3:
  s_cmp_lg_u32 s55, 0
  s_cbranch_scc1 concat_heads__mha_block__spectral_fnet__prompt_kernel_grpdone
concat_heads__mha_block__spectral_fnet__prompt_kernel_late:
  s_cmp_eq_u32 s35, 0
  s_cbranch_scc1 concat_heads__mha_block__spectral_fnet__prompt_kernel_latedone
  s_waitcnt vmcnt(0)
  s_bitcmp1_b32 s35, 0
  s_cbranch_scc0 concat_heads__mha_block__spectral_fnet__prompt_kernel_nc1_0
  ds_read_b128 v[64:67], v93 offset:0
  ds_read_b128 v[68:71], v93 offset:2048
  ds_read_b128 v[72:75], v93 offset:4096
  ds_read_b128 v[76:79], v93 offset:6144
  s_waitcnt lgkmcnt(0)
  v_max3_u32 v6, v64, v65, v66
  v_max3_u32 v6, v6, v67, v68
  v_max3_u32 v6, v6, v69, v70
  v_max3_u32 v6, v6, v71, v72
  v_max3_u32 v6, v6, v73, v74
  v_max3_u32 v6, v6, v75, v76
  v_max3_u32 v6, v6, v77, v78
  v_max_u32 v6, v6, v79
  v_cmp_eq_u32 vcc, -1, v6
  s_add_u32 s34, s34, 1
  s_nop 2
  s_cmp_eq_u64 vcc, 0
  s_cbranch_scc0 concat_heads__mha_block__spectral_fnet__prompt_kernel_nc1_0
  s_bitset0_b32 s35, 0
concat_heads__mha_block__spectral_fnet__prompt_kernel_nc1_0:
  s_bitcmp1_b32 s35, 1
  s_cbranch_scc0 concat_heads__mha_block__spectral_fnet__prompt_kernel_nc1_1
  ds_read_b128 v[64:67], v93 offset:8192
  ds_read_b128 v[68:71], v93 offset:10240
  ds_read_b128 v[72:75], v93 offset:12288
  ds_read_b128 v[76:79], v93 offset:14336
  s_waitcnt lgkmcnt(0)
  v_max3_u32 v6, v64, v65, v66
  v_max3_u32 v6, v6, v67, v68
  v_max3_u32 v6, v6, v69, v70
  v_max3_u32 v6, v6, v71, v72
  v_max3_u32 v6, v6, v73, v74
  v_max3_u32 v6, v6, v75, v76
  v_max3_u32 v6, v6, v77, v78
  v_max_u32 v6, v6, v79
  v_cmp_eq_u32 vcc, -1, v6
  s_add_u32 s34, s34, 1
  s_nop 2
  s_cmp_eq_u64 vcc, 0
  s_cbranch_scc0 concat_heads__mha_block__spectral_fnet__prompt_kernel_nc1_1
  s_bitset0_b32 s35, 1
concat_heads__mha_block__spectral_fnet__prompt_kernel_nc1_1:
  s_bitcmp1_b32 s35, 2
  s_cbranch_scc0 concat_heads__mha_block__spectral_fnet__prompt_kernel_nc1_2
  ds_read_b128 v[64:67], v93 offset:16384
  ds_read_b128 v[68:71], v93 offset:18432
  ds_read_b128 v[72:75], v93 offset:20480
  ds_read_b128 v[76:79], v93 offset:22528
  s_waitcnt lgkmcnt(0)
  v_max3_u32 v6, v64, v65, v66
  v_max3_u32 v6, v6, v67, v68
  v_max3_u32 v6, v6, v69, v70
  v_max3_u32 v6, v6, v71, v72
  v_max3_u32 v6, v6, v73, v74
  v_max3_u32 v6, v6, v75, v76
  v_max3_u32 v6, v6, v77, v78
  v_max_u32 v6, v6, v79
  v_cmp_eq_u32 vcc, -1, v6
  s_add_u32 s34, s34, 1
  s_nop 2
  s_cmp_eq_u64 vcc, 0
  s_cbranch_scc0 concat_heads__mha_block__spectral_fnet__prompt_kernel_nc1_2
  s_bitset0_b32 s35, 2
concat_heads__mha_block__spectral_fnet__prompt_kernel_nc1_2:
  s_bitcmp1_b32 s35, 3
  s_cbranch_scc0 concat_heads__mha_block__spectral_fnet__prompt_kernel_nc1_3
  ds_read_b128 v[64:67], v93 offset:24576
  ds_read_b128 v[68:71], v93 offset:26624
  ds_read_b128 v[72:75], v93 offset:28672
  ds_read_b128 v[76:79], v93 offset:30720
  s_waitcnt lgkmcnt(0)
  v_max3_u32 v6, v64, v65, v66
  v_max3_u32 v6, v6, v67, v68
  v_max3_u32 v6, v6, v69, v70
  v_max3_u32 v6, v6, v71, v72
  v_max3_u32 v6, v6, v73, v74
  v_max3_u32 v6, v6, v75, v76
  v_max3_u32 v6, v6, v77, v78
  v_max_u32 v6, v6, v79
  v_cmp_eq_u32 vcc, -1, v6
  s_add_u32 s34, s34, 1
  s_nop 2
  s_cmp_eq_u64 vcc, 0
  s_cbranch_scc0 concat_heads__mha_block__spectral_fnet__prompt_kernel_nc1_3
  s_bitset0_b32 s35, 3
concat_heads__mha_block__spectral_fnet__prompt_kernel_nc1_3:
  s_cmp_eq_u32 s35, 0
  s_cbranch_scc1 concat_heads__mha_block__spectral_fnet__prompt_kernel_latedone
  s_cmp_ge_u32 s34, 0x20000
  s_cbranch_scc1 concat_heads__mha_block__spectral_fnet__prompt_kernel_latedone
  s_bitcmp1_b32 s35, 0
  s_cbranch_scc0 concat_heads__mha_block__spectral_fnet__prompt_kernel_nf1_0
  s_add_u32 m0, s31, 0
  s_add_u32 s29, s30, 0
  buffer_load_dwordx4 v5, s[12:15], s29 offen sc1 lds
  s_add_u32 m0, s31, 2048
  s_add_u32 s29, s30, 2048
  buffer_load_dwordx4 v5, s[12:15], s29 offen sc1 lds
  s_add_u32 m0, s31, 4096
  s_add_u32 s29, s30, 4096
  buffer_load_dwordx4 v5, s[12:15], s29 offen sc1 lds
  s_add_u32 m0, s31, 6144
  s_add_u32 s29, s30, 6144
  buffer_load_dwordx4 v5, s[12:15], s29 offen sc1 lds
concat_heads__mha_block__spectral_fnet__prompt_kernel_nf1_0:
  s_bitcmp1_b32 s35, 1
  s_cbranch_scc0 concat_heads__mha_block__spectral_fnet__prompt_kernel_nf1_1
  s_add_u32 m0, s31, 8192
  s_add_u32 s29, s30, 8192
  buffer_load_dwordx4 v5, s[12:15], s29 offen sc1 lds
  s_add_u32 m0, s31, 10240
  s_add_u32 s29, s30, 10240
  buffer_load_dwordx4 v5, s[12:15], s29 offen sc1 lds
  s_add_u32 m0, s31, 12288
  s_add_u32 s29, s30, 12288
  buffer_load_dwordx4 v5, s[12:15], s29 offen sc1 lds
  s_add_u32 m0, s31, 14336
  s_add_u32 s29, s30, 14336
  buffer_load_dwordx4 v5, s[12:15], s29 offen sc1 lds
concat_heads__mha_block__spectral_fnet__prompt_kernel_nf1_1:
  s_bitcmp1_b32 s35, 2
  s_cbranch_scc0 concat_heads__mha_block__spectral_fnet__prompt_kernel_nf1_2
  s_add_u32 m0, s31, 16384
  s_add_u32 s29, s30, 16384
  buffer_load_dwordx4 v5, s[12:15], s29 offen sc1 lds
  s_add_u32 m0, s31, 18432
  s_add_u32 s29, s30, 18432
  buffer_load_dwordx4 v5, s[12:15], s29 offen sc1 lds
  s_add_u32 m0, s31, 20480
  s_add_u32 s29, s30, 20480
  buffer_load_dwordx4 v5, s[12:15], s29 offen sc1 lds
  s_add_u32 m0, s31, 22528
  s_add_u32 s29, s30, 22528
  buffer_load_dwordx4 v5, s[12:15], s29 offen sc1 lds
concat_heads__mha_block__spectral_fnet__prompt_kernel_nf1_2:
  s_bitcmp1_b32 s35, 3
  s_cbranch_scc0 concat_heads__mha_block__spectral_fnet__prompt_kernel_nf1_3
  s_add_u32 m0, s31, 24576
  s_add_u32 s29, s30, 24576
  buffer_load_dwordx4 v5, s[12:15], s29 offen sc1 lds
  s_add_u32 m0, s31, 26624
  s_add_u32 s29, s30, 26624
  buffer_load_dwordx4 v5, s[12:15], s29 offen sc1 lds
  s_add_u32 m0, s31, 28672
  s_add_u32 s29, s30, 28672
  buffer_load_dwordx4 v5, s[12:15], s29 offen sc1 lds
  s_add_u32 m0, s31, 30720
  s_add_u32 s29, s30, 30720
  buffer_load_dwordx4 v5, s[12:15], s29 offen sc1 lds
concat_heads__mha_block__spectral_fnet__prompt_kernel_nf1_3:
  s_branch concat_heads__mha_block__spectral_fnet__prompt_kernel_late
concat_heads__mha_block__spectral_fnet__prompt_kernel_latedone:
  s_barrier
  s_mov_b32 s55, 1
  s_mov_b32 s54, s53
  s_cmp_lg_u32 s54, 0
  s_cbranch_scc1 concat_heads__mha_block__spectral_fnet__prompt_kernel_grp
concat_heads__mha_block__spectral_fnet__prompt_kernel_grpdone:
  s_lshl_b32 s28, s22, 12
  s_add_u32 s28, s28, 131072
  v_add_u32 v6, s28, v5
  s_xor_b32 s28, s28, 0x4000
  v_add_u32 v7, s28, v5
  s_nop 15
  s_cmp_eq_u32 s52, 0
  s_cbranch_scc1 concat_heads__mha_block__spectral_fnet__prompt_kernel_k0
  ds_write_b128 v6, v[16:19] offset:0
  ds_write_b128 v6, v[20:23] offset:1024
  ds_write_b128 v6, v[24:27] offset:2048
  ds_write_b128 v6, v[28:31] offset:3072
  v_mov_b32 v16, v32
  v_mov_b32 v17, v33
  v_mov_b32 v18, v34
  v_mov_b32 v19, v35
  v_mov_b32 v20, v36
  v_mov_b32 v21, v37
  v_mov_b32 v22, v38
  v_mov_b32 v23, v39
  v_mov_b32 v24, v40
  v_mov_b32 v25, v41
  v_mov_b32 v26, v42
  v_mov_b32 v27, v43
  v_mov_b32 v28, v44
  v_mov_b32 v29, v45
  v_mov_b32 v30, v46
  v_mov_b32 v31, v47
  s_branch concat_heads__mha_block__spectral_fnet__prompt_kernel_k1
concat_heads__mha_block__spectral_fnet__prompt_kernel_k0:
  ds_write_b128 v6, v[32:35] offset:0
  ds_write_b128 v6, v[36:39] offset:1024
  ds_write_b128 v6, v[40:43] offset:2048
  ds_write_b128 v6, v[44:47] offset:3072
concat_heads__mha_block__spectral_fnet__prompt_kernel_k1:
  s_waitcnt lgkmcnt(0)
  s_barrier
  ds_read_b128 v[96:99], v7 offset:0
  ds_read_b128 v[100:103], v7 offset:1024
  ds_read_b128 v[104:107], v7 offset:2048
  ds_read_b128 v[108:111], v7 offset:3072
  s_waitcnt lgkmcnt(0)
  v_add_f32 v16, v16, v96
  v_add_f32 v17, v17, v97
  v_add_f32 v18, v18, v98
  v_add_f32 v19, v19, v99
  v_add_f32 v20, v20, v100
  v_add_f32 v21, v21, v101
  v_add_f32 v22, v22, v102
  v_add_f32 v23, v23, v103
  v_add_f32 v24, v24, v104
  v_add_f32 v25, v25, v105
  v_add_f32 v26, v26, v106
  v_add_f32 v27, v27, v107
  v_add_f32 v28, v28, v108
  v_add_f32 v29, v29, v109
  v_add_f32 v30, v30, v110
  v_add_f32 v31, v31, v111
  v_cvt_pk_bf16_f32 v112, v16, v17
  v_cvt_pk_bf16_f32 v113, v18, v19
  v_cvt_pk_bf16_f32 v114, v20, v21
  v_cvt_pk_bf16_f32 v115, v22, v23
  v_cvt_pk_bf16_f32 v116, v24, v25
  v_cvt_pk_bf16_f32 v117, v26, v27
  v_cvt_pk_bf16_f32 v118, v28, v29
  v_cvt_pk_bf16_f32 v119, v30, v31
  buffer_store_dwordx4 v[112:115], v95, s[16:19], 0 offen
  buffer_store_dwordx4 v[116:119], v95, s[16:19], 0 offen offset:32
concat_heads__mha_block__spectral_fnet__prompt_kernel_nonce:
  s_cmp_lg_u32 s2, 0
  s_cbranch_scc1 concat_heads__mha_block__spectral_fnet__prompt_kernel_done
  s_cmp_lg_u32 s22, 0
  s_cbranch_scc1 concat_heads__mha_block__spectral_fnet__prompt_kernel_done
  v_mov_b32 v6, s89
  s_mov_b64 exec, 1
  buffer_store_dword v6, off, s[92:95], 0 sc1
concat_heads__mha_block__spectral_fnet__prompt_kernel_done:
  s_endpgm
.section .rodata,"a"
.p2align 6
.amdhsa_kernel concat_heads__mha_block__spectral_fnet__prompt_kernel
  .amdhsa_next_free_vgpr 256
  .amdhsa_next_free_sgpr 100
  .amdhsa_accum_offset 256
  .amdhsa_group_segment_fixed_size 0
  .amdhsa_kernarg_size 88
  .amdhsa_user_sgpr_count 2
  .amdhsa_user_sgpr_kernarg_segment_ptr 1
  .amdhsa_system_sgpr_workgroup_id_x 1
.end_amdhsa_kernel
```
